```python
import torch

def _softmax(x, axis=-1):
    return torch.softmax(x, dim=axis)

def _gelu(x):
    return torch.nn.functional.gelu(x, approximate='tanh')

def _silu(x):
    return torch.nn.functional.silu(x)

def _sigmoid(x):
    return torch.sigmoid(x)

def _layernorm(x, axis=-1, eps=1e-05):
    m = x.mean(dim=axis, keepdim=True)
    v = x.var(dim=axis, keepdim=True, unbiased=False)
    return (x - m) / torch.sqrt(v + eps)

def _scatter_add(tgt, idx, src, axis=0):
    return tgt.clone().index_add_(axis, idx, src)

def _segment_sum(src, seg, n):
    out = torch.zeros((n,) + src.shape[1:], dtype=src.dtype)
    return out.index_add_(0, seg, src)

def _pad(x, pw):
    flat = tuple((v for pair in reversed(pw) for v in pair))
    return torch.nn.functional.pad(x, flat)
kernel_name = 'adaLN_cond__memory_aug_recurrent_mem_tr__glu_gated_geglu__prompt'

def setup_inputs():

    _w = lambda a: (lambda t: t.to(torch.bfloat16) if t.is_floating_point() else t)(torch.as_tensor(a))

    def _A_setup():
        B, S, Dm = (1, 2048, 640)
        H, Dh = (32, 192)
        M, seg = (8, 32)
        seg = min(seg, S)
        S = S // seg * seg
        return {'x': _w((lambda *s: torch.randn(*s, dtype=torch.bfloat16) * 0.05)(B, S, Dm)), 'mem0': _w((lambda *s: torch.randn(*s, dtype=torch.bfloat16) * 0.8)(B, M, Dm)), 'Wq': _w((lambda *s: torch.randn(*s, dtype=torch.bfloat16) * 0.8)(Dm, H, Dh) * Dm ** (-0.5)), 'Wk': _w((lambda *s: torch.randn(*s, dtype=torch.bfloat16) * 0.8)(Dm, H, Dh) * Dm ** (-0.5)), 'Wv': _w((lambda *s: torch.randn(*s, dtype=torch.bfloat16) * 0.8)(Dm, H, Dh) * Dm ** (-0.5)), 'Wo': _w((lambda *s: torch.randn(*s, dtype=torch.bfloat16) * 0.8)(H, Dh, Dm) * (H * Dh) ** (-0.5)), 'seg_len': seg}
    _A_in = _A_setup()

    def _B_setup():
        B, S, Dm, Df = (1, 2048, 640, 1536)
        return {'x': _w((lambda *s: torch.randn(*s, dtype=torch.bfloat16) * 0.05)(B, S, Dm)), 'w_gate': _w((lambda *s: torch.randn(*s, dtype=torch.bfloat16) * 0.4)(Dm, Df) * Dm ** (-0.5)), 'w_up': _w((lambda *s: torch.randn(*s, dtype=torch.bfloat16) * 0.4)(Dm, Df) * Dm ** (-0.5)), 'w_down': _w((lambda *s: torch.randn(*s, dtype=torch.bfloat16) * 0.4)(Df, Dm) * Df ** (-0.5))}
    _B_in = _B_setup()
    return {'A_x': _A_in['x'], 'A_mem0': _A_in['mem0'], 'A_Wq': _A_in['Wq'], 'A_Wk': _A_in['Wk'], 'A_Wv': _A_in['Wv'], 'A_Wo': _A_in['Wo'], 'A_seg_len': _A_in['seg_len'], 'B_x': _B_in['x'], 'B_w_gate': _B_in['w_gate'], 'B_w_up': _B_in['w_up'], 'B_w_down': _B_in['w_down'], 'c': _w((lambda *s: torch.randn(*s, dtype=torch.bfloat16) * 0.2)(1, 640) * 8.0), 'w_mod': _w((lambda *s: torch.randn(*s, dtype=torch.bfloat16) * 0.2)(640, 6 * 640) * 640 ** (-0.5) * 8.0)}

def reference(A_x, A_mem0, A_Wq, A_Wk, A_Wv, A_Wo, A_seg_len, B_x, B_w_gate, B_w_up, B_w_down, c, w_mod):

    def _A_ref(x, mem0, Wq, Wk, Wv, Wo, seg_len):
        B, S, Dm = x.shape
        H, Dh = (Wq.shape[1], Wq.shape[2])
        M = mem0.shape[1]
        scale = Dh ** (-0.5)
        n_seg = S // seg_len
        L = M + seg_len
        idx = torch.arange(L)
        mask = (idx[:, None] < M) | (idx[:, None] >= idx[None, :])
        mem = mem0
        outs = []
        for s in range(n_seg):
            xs = x[:, s * seg_len:(s + 1) * seg_len, :].clone()
            h = torch.concatenate([mem, xs], axis=1)
            q = torch.einsum('btd,dhe->bhte', h, Wq)
            k = torch.einsum('btd,dhe->bhte', h, Wk)
            v = torch.einsum('btd,dhe->bhte', h, Wv)
            scores = torch.einsum('bhqe,bhke->bhqk', q, k) * scale
            scores = torch.where(mask[None, None], scores, -1000000000.0)
            p = _softmax(scores, axis=-1)
            o = torch.einsum('bhqk,bhke->bhqe', p, v)
            o = torch.einsum('bhte,hed->btd', o, Wo)
            mem = o[:, :M, :].clone()
            outs.append(o[:, M:, :])
        return torch.concatenate(outs, axis=1)

    def _B_ref(x, w_gate, w_up, w_down):
        g = torch.einsum('bsd,df->bsf', x, w_gate)
        u = torch.einsum('bsd,df->bsf', x, w_up)
        h = _gelu(g) * u
        return torch.einsum('bsf,fd->bsd', h, w_down)
    x = A_x
    mod = (_silu(c) @ w_mod).reshape(c.shape[0], 6, 1, -1)
    sa, ca, ga, sb, cb, gb = (mod[:, 0].clone(), mod[:, 1].clone(), mod[:, 2].clone(), mod[:, 3].clone(), mod[:, 4].clone(), mod[:, 5].clone())
    h = _layernorm(x, axis=-1) * (1 + ca) + sa
    x = x + ga * _A_ref(h, A_mem0, A_Wq, A_Wk, A_Wv, A_Wo, A_seg_len)
    h = _layernorm(x, axis=-1) * (1 + cb) + sb
    x = x + gb * _B_ref(h, B_w_gate, B_w_up, B_w_down)
    return x
```

```asm
; @launch kernel=mega_kernel grid=(256,1,1) block=(512,1,1) lds=155904
.amdgcn_target "amdgcn-amd-amdhsa--gfx950"
.text
.globl mega_kernel
.p2align 8
.type mega_kernel,@function
mega_kernel:
    s_cmp_ge_u32 s2, 256
    s_cbranch_scc1 MG_END
    s_load_dwordx2 s[52:53], s[0:1], 120
    s_load_dwordx2 s[96:97], s[0:1], 112
    v_lshrrev_b32 v1, 6, v0
    s_nop 0
    v_readfirstlane_b32 s40, v1
    v_and_b32 v1, 63, v0
    v_and_b32 v2, 15, v0
    v_lshrrev_b32 v3, 4, v1
    s_and_b32 s41, s40, 3
    s_lshr_b32 s39, s40, 2
    v_mov_b32 v4, 0
    v_mov_b32 v5, 0
    v_mov_b32 v6, 0
    v_mov_b32 v7, 0
    v_mov_b32 v8, 0
    v_mov_b32 v9, 0
    v_mov_b32 v10, 0
    v_mov_b32 v11, 0
    v_mov_b32 v12, 0
    v_mov_b32 v13, 0
    v_mov_b32 v14, 0
    v_mov_b32 v15, 0
    v_mov_b32 v128, 0
    v_mov_b32 v129, 0
    v_mov_b32 v130, 0
    v_mov_b32 v131, 0
    v_mov_b32 v132, 0
    v_mov_b32 v104, 0
    v_mov_b32 v105, 0
    v_mov_b32 v106, 0
    v_mov_b32 v107, 0
    v_mov_b32 v108, 0
    s_waitcnt lgkmcnt(0)
    s_mov_b32 s32, s52
    s_mov_b32 s33, s53
    s_mov_b32 s34, 268435456
    s_mov_b32 s35, 0x00020000
    s_mov_b32 s88, 0
    s_mov_b32 s85, 0
    s_getreg_b32 s46, hwreg(HW_REG_XCC_ID)
    s_and_b32 s46, s46, 7
    s_and_b32 s54, s2, 7
    s_lshr_b32 s55, s2, 3
    s_cmp_lg_u32 s46, s54
    s_cselect_b32 s46, 0x10001, 1
    s_cmp_lt_u32 s54, 4
    s_cselect_b32 s93, 1, 0
    s_and_b32 s54, s54, 3
    s_lshl_b32 s54, s54, 1
    s_lshr_b32 s42, s55, 4
    s_and_b32 s43, s55, 1
    s_lshr_b32 s44, s55, 1
    s_and_b32 s55, s55, 15
    s_cmp_eq_u32 s93, 1
    s_cselect_b32 s42, s42, s43
    s_cselect_b32 s55, s55, s44
    s_add_u32 s54, s54, s42
    s_mov_b32 s92, 1
    s_cmp_eq_u32 s93, 1
    s_cbranch_scc1 ARRIVE
    s_mov_b32 s46, 1
    s_cmp_lt_u32 s55, 8
    s_cbranch_scc1 ARRIVE
    s_lshl_b32 s42, s54, 3
    s_add_u32 s42, s42, s55
    s_sub_u32 s42, s42, 8
    v_lshlrev_b32 v10, 4, v0
    v_mov_b32 v4, -1
    v_mov_b32 v12, 0
    v_mov_b32 v5, -1
    v_mov_b32 v13, 0
    v_mov_b32 v6, -1
    v_mov_b32 v14, 0
    v_mov_b32 v7, -1
    v_mov_b32 v15, 0
    s_mul_i32 s43, s42, 40960
    s_add_u32 s43, s43, 20971520
    buffer_store_dwordx4 v[4:7], v10, s[32:35], s43 offen sc1
    s_add_u32 s43, s43, 8192
    buffer_store_dwordx4 v[4:7], v10, s[32:35], s43 offen sc1
    s_add_u32 s43, s43, 8192
    buffer_store_dwordx4 v[4:7], v10, s[32:35], s43 offen sc1
    s_add_u32 s43, s43, 8192
    buffer_store_dwordx4 v[4:7], v10, s[32:35], s43 offen sc1
    s_add_u32 s43, s43, 8192
    buffer_store_dwordx4 v[4:7], v10, s[32:35], s43 offen sc1
    s_add_u32 s44, s32, 0x19fffff
    s_and_b32 s44, s44, 0xffe00000
    s_sub_u32 s44, s44, s32
    s_mul_i32 s43, s42, 3
    s_add_u32 s45, s43, 0
    s_min_u32 s45, s45, 159
    s_lshl_b32 s45, s45, 13
    s_add_u32 s45, s45, s44
    buffer_store_dwordx4 v[4:7], v10, s[32:35], s45 offen sc1
    s_add_u32 s45, s43, 1
    s_min_u32 s45, s45, 159
    s_lshl_b32 s45, s45, 13
    s_add_u32 s45, s45, s44
    buffer_store_dwordx4 v[4:7], v10, s[32:35], s45 offen sc1
    s_add_u32 s45, s43, 2
    s_min_u32 s45, s45, 159
    s_lshl_b32 s45, s45, 13
    s_add_u32 s45, s45, s44
    buffer_store_dwordx4 v[4:7], v10, s[32:35], s45 offen sc1
    s_mul_i32 s43, s42, 1536
    s_add_u32 s43, s43, 65536
    v_cmp_gt_u32 vcc, 96, v0
    s_and_saveexec_b64 s[44:45], vcc
    s_cbranch_execz NOCZ
    buffer_store_dwordx4 v[12:15], v10, s[32:35], s43 offen sc1
NOCZ:
    s_mov_b64 exec, s[44:45]
    s_waitcnt vmcnt(0)
    s_barrier
ARRIVE:
    s_cmp_lg_u32 s40, 0
    s_cbranch_scc1 ARR2
    s_lshr_b32 s42, s2, 3
    s_and_b32 s42, s42, 3
    s_lshl_b32 s42, s42, 6
    v_mov_b32 v4, s42
    v_mov_b32 v5, s46
    s_mov_b64 exec, 1
    global_atomic_add v4, v5, s[96:97] sc1
    s_cmp_lg_u32 s2, 244
    s_cbranch_scc1 PRB_E
    s_add_u32 s44, s32, 0x19fffff
    s_and_b32 s44, s44, 0xffe00000
    s_sub_u32 s44, s44, s32
    v_mov_b32 v4, 0
    s_mov_b32 s70, -1
    s_mov_b32 s71, -1
    s_waitcnt vmcnt(0)
    s_add_u32 s45, s44, 1835008
    s_memtime s[48:49]
    s_waitcnt lgkmcnt(0)
    buffer_store_dword v4, v4, s[32:35], s45 offen sc1
    s_waitcnt vmcnt(0)
    s_memtime s[50:51]
    s_waitcnt lgkmcnt(0)
    s_sub_u32 s50, s50, s48
    s_min_u32 s70, s70, s50
    s_add_u32 s45, s44, 1843200
    s_memtime s[48:49]
    s_waitcnt lgkmcnt(0)
    buffer_store_dword v4, v4, s[32:35], s45 offen sc1
    s_waitcnt vmcnt(0)
    s_memtime s[50:51]
    s_waitcnt lgkmcnt(0)
    s_sub_u32 s50, s50, s48
    s_min_u32 s71, s71, s50
    s_add_u32 s45, s44, 1839104
    s_memtime s[48:49]
    s_waitcnt lgkmcnt(0)
    buffer_store_dword v4, v4, s[32:35], s45 offen sc1
    s_waitcnt vmcnt(0)
    s_memtime s[50:51]
    s_waitcnt lgkmcnt(0)
    s_sub_u32 s50, s50, s48
    s_min_u32 s70, s70, s50
    s_add_u32 s45, s44, 1847296
    s_memtime s[48:49]
    s_waitcnt lgkmcnt(0)
    buffer_store_dword v4, v4, s[32:35], s45 offen sc1
    s_waitcnt vmcnt(0)
    s_memtime s[50:51]
    s_waitcnt lgkmcnt(0)
    s_sub_u32 s50, s50, s48
    s_min_u32 s71, s71, s50
    s_add_u32 s45, s44, 1851392
    s_memtime s[48:49]
    s_waitcnt lgkmcnt(0)
    buffer_store_dword v4, v4, s[32:35], s45 offen sc1
    s_waitcnt vmcnt(0)
    s_memtime s[50:51]
    s_waitcnt lgkmcnt(0)
    s_sub_u32 s50, s50, s48
    s_min_u32 s70, s70, s50
    s_add_u32 s45, s44, 1859584
    s_memtime s[48:49]
    s_waitcnt lgkmcnt(0)
    buffer_store_dword v4, v4, s[32:35], s45 offen sc1
    s_waitcnt vmcnt(0)
    s_memtime s[50:51]
    s_waitcnt lgkmcnt(0)
    s_sub_u32 s50, s50, s48
    s_min_u32 s71, s71, s50
    s_add_u32 s45, s44, 1855488
    s_memtime s[48:49]
    s_waitcnt lgkmcnt(0)
    buffer_store_dword v4, v4, s[32:35], s45 offen sc1
    s_waitcnt vmcnt(0)
    s_memtime s[50:51]
    s_waitcnt lgkmcnt(0)
    s_sub_u32 s50, s50, s48
    s_min_u32 s70, s70, s50
    s_add_u32 s45, s44, 1863680
    s_memtime s[48:49]
    s_waitcnt lgkmcnt(0)
    buffer_store_dword v4, v4, s[32:35], s45 offen sc1
    s_waitcnt vmcnt(0)
    s_memtime s[50:51]
    s_waitcnt lgkmcnt(0)
    s_sub_u32 s50, s50, s48
    s_min_u32 s71, s71, s50
    s_getreg_b32 s45, hwreg(HW_REG_XCC_ID)
    s_bfe_u32 s45, s45, 0x10002
    s_mov_b32 s47, 1
    s_cmp_lt_u32 s71, s70
    s_cselect_b32 s46, 1, 0
    s_xor_b32 s46, s46, s45
    s_add_u32 s47, s47, s46
    v_mov_b32 v5, s47
    global_store_dword v4, v5, s[96:97] offset:32 sc1
PRB_E:
    s_mov_b64 exec, -1
ARR2:
    s_branch DISPATCH
FALLBACK:
    s_waitcnt vmcnt(0) lgkmcnt(0)
    s_barrier
    s_setprio 0
    v_lshrrev_b32 v1, 6, v0
    s_nop 0
    v_readfirstlane_b32 s40, v1
    v_and_b32 v1, 63, v0
    v_and_b32 v2, 15, v0
    v_lshrrev_b32 v3, 4, v1
    s_and_b32 s41, s40, 3
    s_lshr_b32 s39, s40, 2
    s_getreg_b32 s54, hwreg(HW_REG_XCC_ID)
    s_and_b32 s54, s54, 7
    s_cmp_lg_u32 s40, 0
    s_cbranch_scc1 RA_1
    v_mov_b32 v4, 1
    s_lshl_b32 s42, s54, 7
    s_add_u32 s42, s42, 65536
    v_mov_b32 v5, 0
    s_mov_b64 exec, 1
    buffer_atomic_add v4, v5, s[32:35], s42 offen sc0 sc1
    s_mov_b64 exec, 0xff
    v_lshlrev_b32 v6, 7, v1
    s_mov_b32 s42, 65536
RA_2:
    buffer_load_dword v7, v6, s[32:35], s42 offen sc1
    s_waitcnt vmcnt(0)
    v_readlane_b32 s8, v7, 0
    v_readlane_b32 s9, v7, 1
    v_readlane_b32 s10, v7, 2
    v_readlane_b32 s11, v7, 3
    v_readlane_b32 s12, v7, 4
    v_readlane_b32 s13, v7, 5
    v_readlane_b32 s14, v7, 6
    v_readlane_b32 s15, v7, 7
    s_add_u32 s43, s8, s9
    s_add_u32 s43, s43, s10
    s_add_u32 s43, s43, s11
    s_add_u32 s43, s43, s12
    s_add_u32 s43, s43, s13
    s_add_u32 s43, s43, s14
    s_add_u32 s43, s43, s15
    s_add_u32 s88, s88, 1
    s_cmp_ge_u32 s88, 0x40000
    s_cbranch_scc1 RA_3
    s_cmp_lt_u32 s43, 256
    s_cbranch_scc1 RA_2
RA_3:
    s_min_u32 s44, s8, s9
    s_min_u32 s44, s44, s10
    s_min_u32 s44, s44, s11
    s_min_u32 s44, s44, s12
    s_min_u32 s44, s44, s13
    s_min_u32 s44, s44, s14
    s_min_u32 s44, s44, s15
    s_mov_b32 s45, 0
    s_cmp_gt_u32 s54, 0
    s_cselect_b32 s42, s8, 0
    s_add_u32 s45, s45, s42
    s_cmp_gt_u32 s54, 1
    s_cselect_b32 s42, s9, 0
    s_add_u32 s45, s45, s42
    s_cmp_gt_u32 s54, 2
    s_cselect_b32 s42, s10, 0
    s_add_u32 s45, s45, s42
    s_cmp_gt_u32 s54, 3
    s_cselect_b32 s42, s11, 0
    s_add_u32 s45, s45, s42
    s_cmp_gt_u32 s54, 4
    s_cselect_b32 s42, s12, 0
    s_add_u32 s45, s45, s42
    s_cmp_gt_u32 s54, 5
    s_cselect_b32 s42, s13, 0
    s_add_u32 s45, s45, s42
    s_cmp_gt_u32 s54, 6
    s_cselect_b32 s42, s14, 0
    s_add_u32 s45, s45, s42
    s_mov_b64 exec, 1
    v_add_u32 v6, s45, v4
    v_mov_b32 v7, s44
    v_mov_b32 v5, 155648
    ds_write_b32 v5, v4 offset:16
    ds_write_b32 v5, v6 offset:20
    ds_write_b32 v5, v7 offset:24
    s_waitcnt lgkmcnt(0)
    s_mov_b64 exec, -1
RA_1:
    s_barrier
    v_mov_b32 v5, 155648
    ds_read_b32 v4, v5 offset:16
    ds_read_b32 v6, v5 offset:20
    ds_read_b32 v7, v5 offset:24
    s_waitcnt lgkmcnt(0)
    v_readfirstlane_b32 s55, v4
    v_readfirstlane_b32 s42, v6
    v_readfirstlane_b32 s43, v7
    s_cmp_ge_u32 s43, 32
    s_cselect_b32 s92, 1, 0
    s_cmp_eq_u32 s92, 1
    s_cbranch_scc1 RG_FAST
    s_and_b32 s54, s42, 7
    s_lshr_b32 s55, s42, 3
    s_cmp_lt_u32 s55, 16
    s_cselect_b32 s93, 1, 0
    s_and_b32 s55, s55, 15
    s_branch RG_END
RG_FAST:
    s_cmp_lt_u32 s54, 4
    s_cselect_b32 s93, 1, 0
    s_and_b32 s54, s54, 3
    s_lshl_b32 s54, s54, 1
    s_lshr_b32 s42, s55, 4
    s_and_b32 s43, s55, 1
    s_lshr_b32 s44, s55, 1
    s_and_b32 s55, s55, 15
    s_cmp_eq_u32 s93, 1
    s_cselect_b32 s42, s42, s43
    s_cselect_b32 s55, s55, s44
    s_add_u32 s54, s54, s42
RG_END:
DISPATCH:
    s_load_dwordx4 s[4:7], s[0:1], 16
    s_load_dwordx4 s[48:51], s[0:1], 32
    s_load_dwordx2 s[94:95], s[0:1], 8
    s_waitcnt lgkmcnt(0)
    s_mov_b32 s100, s54
    s_cmp_eq_u32 s93, 0
    s_cbranch_scc1 WENTRY0
    s_mov_b32 s8, s4
    s_mov_b32 s9, s5
    s_mov_b32 s10, 7864320
    s_mov_b32 s11, 0x00020000
    s_mov_b32 s12, s6
    s_mov_b32 s13, s7
    s_mov_b32 s14, 7864320
    s_mov_b32 s15, 0x00020000
    s_mov_b32 s16, s48
    s_mov_b32 s17, s49
    s_mov_b32 s18, 7864320
    s_mov_b32 s19, 0x00020000
    s_mov_b32 s28, s50
    s_mov_b32 s29, s51
    s_mov_b32 s30, 7864320
    s_mov_b32 s31, 0x00020000
    s_mov_b32 s36, s94
    s_mov_b32 s37, s95
    s_mov_b32 s38, 10240
    s_mov_b32 s39, 0x00020000
    s_lshr_b32 s56, s55, 3
    s_and_b32 s57, s55, 7
    s_lshl_b32 s58, s54, 1
    s_add_u32 s58, s58, s56
    s_lshr_b32 s59, s57, 2
    s_lshl_b32 s60, s58, 1
    s_add_u32 s59, s59, s60
    s_and_b32 s61, s57, 3
    s_mul_i32 s42, s59, 384
    s_mul_i32 s43, s61, 96
    s_add_u32 s62, s42, s43
    s_add_u32 s44, s61, 2
    s_and_b32 s44, s44, 3
    s_mul_i32 s43, s44, 96
    s_add_u32 s63, s42, s43
    s_cmp_ge_u32 s40, 3
    s_cselect_b32 s61, s44, s61
    s_and_b32 s41, s40, 3
    s_cmp_lt_u32 s40, 4
    s_cselect_b32 s24, s8, s12
    s_cselect_b32 s25, s9, s13
    s_mov_b32 s26, 7864320
    s_mov_b32 s27, 0x00020000
    s_mul_i32 s42, s41, 960
    s_add_u32 s43, s42, 0
    v_add_u32 v4, s43, v1
    v_mul_u32_u24 v5, 10923, v4
    v_lshrrev_b32 v5, 16, v5
    v_mul_u32_u24 v6, 6, v5
    v_sub_u32 v6, v4, v6
    v_mul_u32_u24 v5, 12288, v5
    v_lshl_add_u32 v5, v6, 4, v5
    s_mul_i32 s43, s40, 15360
    s_add_u32 m0, s43, 0
    s_nop 0
    buffer_load_dwordx4 v5, s[24:27], s62 offen lds
    s_add_u32 s43, s42, 64
    v_add_u32 v4, s43, v1
    v_mul_u32_u24 v5, 10923, v4
    v_lshrrev_b32 v5, 16, v5
    v_mul_u32_u24 v6, 6, v5
    v_sub_u32 v6, v4, v6
    v_mul_u32_u24 v5, 12288, v5
    v_lshl_add_u32 v5, v6, 4, v5
    s_mul_i32 s43, s40, 15360
    s_add_u32 m0, s43, 1024
    s_nop 0
    buffer_load_dwordx4 v5, s[24:27], s62 offen lds
    s_add_u32 s43, s42, 128
    v_add_u32 v4, s43, v1
    v_mul_u32_u24 v5, 10923, v4
    v_lshrrev_b32 v5, 16, v5
    v_mul_u32_u24 v6, 6, v5
    v_sub_u32 v6, v4, v6
    v_mul_u32_u24 v5, 12288, v5
    v_lshl_add_u32 v5, v6, 4, v5
    s_mul_i32 s43, s40, 15360
    s_add_u32 m0, s43, 2048
    s_nop 0
    buffer_load_dwordx4 v5, s[24:27], s62 offen lds
    s_add_u32 s43, s42, 192
    v_add_u32 v4, s43, v1
    v_mul_u32_u24 v5, 10923, v4
    v_lshrrev_b32 v5, 16, v5
    v_mul_u32_u24 v6, 6, v5
    v_sub_u32 v6, v4, v6
    v_mul_u32_u24 v5, 12288, v5
    v_lshl_add_u32 v5, v6, 4, v5
    s_mul_i32 s43, s40, 15360
    s_add_u32 m0, s43, 3072
    s_nop 0
    buffer_load_dwordx4 v5, s[24:27], s62 offen lds
    s_add_u32 s43, s42, 256
    v_add_u32 v4, s43, v1
    v_mul_u32_u24 v5, 10923, v4
    v_lshrrev_b32 v5, 16, v5
    v_mul_u32_u24 v6, 6, v5
    v_sub_u32 v6, v4, v6
    v_mul_u32_u24 v5, 12288, v5
    v_lshl_add_u32 v5, v6, 4, v5
    s_mul_i32 s43, s40, 15360
    s_add_u32 m0, s43, 4096
    s_nop 0
    buffer_load_dwordx4 v5, s[24:27], s62 offen lds
    s_add_u32 s43, s42, 320
    v_add_u32 v4, s43, v1
    v_mul_u32_u24 v5, 10923, v4
    v_lshrrev_b32 v5, 16, v5
    v_mul_u32_u24 v6, 6, v5
    v_sub_u32 v6, v4, v6
    v_mul_u32_u24 v5, 12288, v5
    v_lshl_add_u32 v5, v6, 4, v5
    s_mul_i32 s43, s40, 15360
    s_add_u32 m0, s43, 5120
    s_nop 0
    buffer_load_dwordx4 v5, s[24:27], s62 offen lds
    s_add_u32 s43, s42, 384
    v_add_u32 v4, s43, v1
    v_mul_u32_u24 v5, 10923, v4
    v_lshrrev_b32 v5, 16, v5
    v_mul_u32_u24 v6, 6, v5
    v_sub_u32 v6, v4, v6
    v_mul_u32_u24 v5, 12288, v5
    v_lshl_add_u32 v5, v6, 4, v5
    s_mul_i32 s43, s40, 15360
    s_add_u32 m0, s43, 6144
    s_nop 0
    buffer_load_dwordx4 v5, s[24:27], s62 offen lds
    s_add_u32 s43, s42, 448
    v_add_u32 v4, s43, v1
    v_mul_u32_u24 v5, 10923, v4
    v_lshrrev_b32 v5, 16, v5
    v_mul_u32_u24 v6, 6, v5
    v_sub_u32 v6, v4, v6
    v_mul_u32_u24 v5, 12288, v5
    v_lshl_add_u32 v5, v6, 4, v5
    s_mul_i32 s43, s40, 15360
    s_add_u32 m0, s43, 7168
    s_nop 0
    buffer_load_dwordx4 v5, s[24:27], s62 offen lds
    s_add_u32 s43, s42, 512
    v_add_u32 v4, s43, v1
    v_mul_u32_u24 v5, 10923, v4
    v_lshrrev_b32 v5, 16, v5
    v_mul_u32_u24 v6, 6, v5
    v_sub_u32 v6, v4, v6
    v_mul_u32_u24 v5, 12288, v5
    v_lshl_add_u32 v5, v6, 4, v5
    s_mul_i32 s43, s40, 15360
    s_add_u32 m0, s43, 8192
    s_nop 0
    buffer_load_dwordx4 v5, s[24:27], s62 offen lds
    s_add_u32 s43, s42, 576
    v_add_u32 v4, s43, v1
    v_mul_u32_u24 v5, 10923, v4
    v_lshrrev_b32 v5, 16, v5
    v_mul_u32_u24 v6, 6, v5
    v_sub_u32 v6, v4, v6
    v_mul_u32_u24 v5, 12288, v5
    v_lshl_add_u32 v5, v6, 4, v5
    s_mul_i32 s43, s40, 15360
    s_add_u32 m0, s43, 9216
    s_nop 0
    buffer_load_dwordx4 v5, s[24:27], s62 offen lds
    s_add_u32 s43, s42, 640
    v_add_u32 v4, s43, v1
    v_mul_u32_u24 v5, 10923, v4
    v_lshrrev_b32 v5, 16, v5
    v_mul_u32_u24 v6, 6, v5
    v_sub_u32 v6, v4, v6
    v_mul_u32_u24 v5, 12288, v5
    v_lshl_add_u32 v5, v6, 4, v5
    s_mul_i32 s43, s40, 15360
    s_add_u32 m0, s43, 10240
    s_nop 0
    buffer_load_dwordx4 v5, s[24:27], s62 offen lds
    s_add_u32 s43, s42, 704
    v_add_u32 v4, s43, v1
    v_mul_u32_u24 v5, 10923, v4
    v_lshrrev_b32 v5, 16, v5
    v_mul_u32_u24 v6, 6, v5
    v_sub_u32 v6, v4, v6
    v_mul_u32_u24 v5, 12288, v5
    v_lshl_add_u32 v5, v6, 4, v5
    s_mul_i32 s43, s40, 15360
    s_add_u32 m0, s43, 11264
    s_nop 0
    buffer_load_dwordx4 v5, s[24:27], s62 offen lds
    s_add_u32 s43, s42, 768
    v_add_u32 v4, s43, v1
    v_mul_u32_u24 v5, 10923, v4
    v_lshrrev_b32 v5, 16, v5
    v_mul_u32_u24 v6, 6, v5
    v_sub_u32 v6, v4, v6
    v_mul_u32_u24 v5, 12288, v5
    v_lshl_add_u32 v5, v6, 4, v5
    s_mul_i32 s43, s40, 15360
    s_add_u32 m0, s43, 12288
    s_nop 0
    buffer_load_dwordx4 v5, s[24:27], s62 offen lds
    s_add_u32 s43, s42, 832
    v_add_u32 v4, s43, v1
    v_mul_u32_u24 v5, 10923, v4
    v_lshrrev_b32 v5, 16, v5
    v_mul_u32_u24 v6, 6, v5
    v_sub_u32 v6, v4, v6
    v_mul_u32_u24 v5, 12288, v5
    v_lshl_add_u32 v5, v6, 4, v5
    s_mul_i32 s43, s40, 15360
    s_add_u32 m0, s43, 13312
    s_nop 0
    buffer_load_dwordx4 v5, s[24:27], s62 offen lds
    s_add_u32 s43, s42, 896
    v_add_u32 v4, s43, v1
    v_mul_u32_u24 v5, 10923, v4
    v_lshrrev_b32 v5, 16, v5
    v_mul_u32_u24 v6, 6, v5
    v_sub_u32 v6, v4, v6
    v_mul_u32_u24 v5, 12288, v5
    v_lshl_add_u32 v5, v6, 4, v5
    s_mul_i32 s43, s40, 15360
    s_add_u32 m0, s43, 14336
    s_nop 0
    buffer_load_dwordx4 v5, s[24:27], s62 offen lds
    v_lshlrev_b32 v15, 4, v1
    v_lshlrev_b32 v13, 3, v1
    s_cmp_ge_u32 s40, 4
    s_cbranch_scc1 C4_R2WO
    s_mov_b32 s24, s16
    s_mov_b32 s25, s17
    s_add_u32 s43, s42, 0
    v_add_u32 v4, s43, v1
    v_mul_u32_u24 v5, 10923, v4
    v_lshrrev_b32 v5, 16, v5
    v_mul_u32_u24 v6, 6, v5
    v_sub_u32 v6, v4, v6
    v_mul_u32_u24 v5, 12288, v5
    v_lshl_add_u32 v5, v6, 4, v5
    buffer_load_dwordx4 v[180:183], v5, s[24:27], s63 offen
    s_add_u32 s43, s42, 64
    v_add_u32 v4, s43, v1
    v_mul_u32_u24 v5, 10923, v4
    v_lshrrev_b32 v5, 16, v5
    v_mul_u32_u24 v6, 6, v5
    v_sub_u32 v6, v4, v6
    v_mul_u32_u24 v5, 12288, v5
    v_lshl_add_u32 v5, v6, 4, v5
    buffer_load_dwordx4 v[184:187], v5, s[24:27], s63 offen
    s_add_u32 s43, s42, 128
    v_add_u32 v4, s43, v1
    v_mul_u32_u24 v5, 10923, v4
    v_lshrrev_b32 v5, 16, v5
    v_mul_u32_u24 v6, 6, v5
    v_sub_u32 v6, v4, v6
    v_mul_u32_u24 v5, 12288, v5
    v_lshl_add_u32 v5, v6, 4, v5
    buffer_load_dwordx4 v[188:191], v5, s[24:27], s63 offen
    s_add_u32 s43, s42, 192
    v_add_u32 v4, s43, v1
    v_mul_u32_u24 v5, 10923, v4
    v_lshrrev_b32 v5, 16, v5
    v_mul_u32_u24 v6, 6, v5
    v_sub_u32 v6, v4, v6
    v_mul_u32_u24 v5, 12288, v5
    v_lshl_add_u32 v5, v6, 4, v5
    buffer_load_dwordx4 v[192:195], v5, s[24:27], s63 offen
    s_add_u32 s43, s42, 256
    v_add_u32 v4, s43, v1
    v_mul_u32_u24 v5, 10923, v4
    v_lshrrev_b32 v5, 16, v5
    v_mul_u32_u24 v6, 6, v5
    v_sub_u32 v6, v4, v6
    v_mul_u32_u24 v5, 12288, v5
    v_lshl_add_u32 v5, v6, 4, v5
    buffer_load_dwordx4 v[196:199], v5, s[24:27], s63 offen
    s_add_u32 s43, s42, 320
    v_add_u32 v4, s43, v1
    v_mul_u32_u24 v5, 10923, v4
    v_lshrrev_b32 v5, 16, v5
    v_mul_u32_u24 v6, 6, v5
    v_sub_u32 v6, v4, v6
    v_mul_u32_u24 v5, 12288, v5
    v_lshl_add_u32 v5, v6, 4, v5
    buffer_load_dwordx4 v[200:203], v5, s[24:27], s63 offen
    s_add_u32 s43, s42, 384
    v_add_u32 v4, s43, v1
    v_mul_u32_u24 v5, 10923, v4
    v_lshrrev_b32 v5, 16, v5
    v_mul_u32_u24 v6, 6, v5
    v_sub_u32 v6, v4, v6
    v_mul_u32_u24 v5, 12288, v5
    v_lshl_add_u32 v5, v6, 4, v5
    buffer_load_dwordx4 v[204:207], v5, s[24:27], s63 offen
    s_add_u32 s43, s42, 448
    v_add_u32 v4, s43, v1
    v_mul_u32_u24 v5, 10923, v4
    v_lshrrev_b32 v5, 16, v5
    v_mul_u32_u24 v6, 6, v5
    v_sub_u32 v6, v4, v6
    v_mul_u32_u24 v5, 12288, v5
    v_lshl_add_u32 v5, v6, 4, v5
    buffer_load_dwordx4 v[208:211], v5, s[24:27], s63 offen
    s_add_u32 s43, s42, 512
    v_add_u32 v4, s43, v1
    v_mul_u32_u24 v5, 10923, v4
    v_lshrrev_b32 v5, 16, v5
    v_mul_u32_u24 v6, 6, v5
    v_sub_u32 v6, v4, v6
    v_mul_u32_u24 v5, 12288, v5
    v_lshl_add_u32 v5, v6, 4, v5
    buffer_load_dwordx4 v[212:215], v5, s[24:27], s63 offen
    s_add_u32 s43, s42, 576
    v_add_u32 v4, s43, v1
    v_mul_u32_u24 v5, 10923, v4
    v_lshrrev_b32 v5, 16, v5
    v_mul_u32_u24 v6, 6, v5
    v_sub_u32 v6, v4, v6
    v_mul_u32_u24 v5, 12288, v5
    v_lshl_add_u32 v5, v6, 4, v5
    buffer_load_dwordx4 v[216:219], v5, s[24:27], s63 offen
    s_add_u32 s43, s42, 640
    v_add_u32 v4, s43, v1
    v_mul_u32_u24 v5, 10923, v4
    v_lshrrev_b32 v5, 16, v5
    v_mul_u32_u24 v6, 6, v5
    v_sub_u32 v6, v4, v6
    v_mul_u32_u24 v5, 12288, v5
    v_lshl_add_u32 v5, v6, 4, v5
    buffer_load_dwordx4 v[220:223], v5, s[24:27], s63 offen
    s_add_u32 s43, s42, 704
    v_add_u32 v4, s43, v1
    v_mul_u32_u24 v5, 10923, v4
    v_lshrrev_b32 v5, 16, v5
    v_mul_u32_u24 v6, 6, v5
    v_sub_u32 v6, v4, v6
    v_mul_u32_u24 v5, 12288, v5
    v_lshl_add_u32 v5, v6, 4, v5
    buffer_load_dwordx4 v[224:227], v5, s[24:27], s63 offen
    s_add_u32 s43, s42, 768
    v_add_u32 v4, s43, v1
    v_mul_u32_u24 v5, 10923, v4
    v_lshrrev_b32 v5, 16, v5
    v_mul_u32_u24 v6, 6, v5
    v_sub_u32 v6, v4, v6
    v_mul_u32_u24 v5, 12288, v5
    v_lshl_add_u32 v5, v6, 4, v5
    buffer_load_dwordx4 v[228:231], v5, s[24:27], s63 offen
    s_add_u32 s43, s42, 832
    v_add_u32 v4, s43, v1
    v_mul_u32_u24 v5, 10923, v4
    v_lshrrev_b32 v5, 16, v5
    v_mul_u32_u24 v6, 6, v5
    v_sub_u32 v6, v4, v6
    v_mul_u32_u24 v5, 12288, v5
    v_lshl_add_u32 v5, v6, 4, v5
    buffer_load_dwordx4 v[232:235], v5, s[24:27], s63 offen
    s_add_u32 s43, s42, 896
    v_add_u32 v4, s43, v1
    v_mul_u32_u24 v5, 10923, v4
    v_lshrrev_b32 v5, 16, v5
    v_mul_u32_u24 v6, 6, v5
    v_sub_u32 v6, v4, v6
    v_mul_u32_u24 v5, 12288, v5
    v_lshl_add_u32 v5, v6, 4, v5
    buffer_load_dwordx4 v[236:239], v5, s[24:27], s63 offen
    v_add_u32 v4, 0, v0
    v_min_u32 v4, 639, v4
    v_lshrrev_b32 v5, 6, v4
    v_bfe_u32 v6, v4, 3, 1
    v_mul_u32_u24 v6, 10, v6
    v_add_u32 v5, v5, v6
    v_bfe_u32 v6, v4, 4, 2
    v_and_b32 v7, 7, v4
    v_mul_u32_u24 v7, 1280, v7
    v_lshl_add_u32 v7, v5, 6, v7
    v_lshl_add_u32 v7, v6, 3, v7
    buffer_load_dwordx2 v[240:241], v7, s[36:39], 0 offen
    buffer_load_dwordx2 v[242:243], v7, s[36:39], 0 offen offset:32
    v_add_u32 v4, 512, v0
    v_min_u32 v4, 639, v4
    v_lshrrev_b32 v5, 6, v4
    v_bfe_u32 v6, v4, 3, 1
    v_mul_u32_u24 v6, 10, v6
    v_add_u32 v5, v5, v6
    v_bfe_u32 v6, v4, 4, 2
    v_and_b32 v7, 7, v4
    v_mul_u32_u24 v7, 1280, v7
    v_lshl_add_u32 v7, v5, 6, v7
    v_lshl_add_u32 v7, v6, 3, v7
    buffer_load_dwordx2 v[244:245], v7, s[36:39], 0 offen
    buffer_load_dwordx2 v[246:247], v7, s[36:39], 0 offen offset:32
    s_waitcnt vmcnt(19)
    s_branch C4_R2END
C4_R2WO:
    v_add_u32 v4, 0, v0
    v_min_u32 v4, 639, v4
    v_lshrrev_b32 v5, 6, v4
    v_bfe_u32 v6, v4, 3, 1
    v_mul_u32_u24 v6, 10, v6
    v_add_u32 v5, v5, v6
    v_bfe_u32 v6, v4, 4, 2
    v_and_b32 v7, 7, v4
    v_mul_u32_u24 v7, 1280, v7
    v_lshl_add_u32 v7, v5, 6, v7
    v_lshl_add_u32 v7, v6, 3, v7
    buffer_load_dwordx2 v[240:241], v7, s[36:39], 0 offen
    buffer_load_dwordx2 v[242:243], v7, s[36:39], 0 offen offset:32
    v_add_u32 v4, 512, v0
    v_min_u32 v4, 639, v4
    v_lshrrev_b32 v5, 6, v4
    v_bfe_u32 v6, v4, 3, 1
    v_mul_u32_u24 v6, 10, v6
    v_add_u32 v5, v5, v6
    v_bfe_u32 v6, v4, 4, 2
    v_and_b32 v7, 7, v4
    v_mul_u32_u24 v7, 1280, v7
    v_lshl_add_u32 v7, v5, 6, v7
    v_lshl_add_u32 v7, v6, 3, v7
    buffer_load_dwordx2 v[244:245], v7, s[36:39], 0 offen
    buffer_load_dwordx2 v[246:247], v7, s[36:39], 0 offen offset:32
    s_waitcnt vmcnt(4)
C4_R2END:
    s_barrier
    s_cmp_lt_u32 s40, 4
    s_cbranch_scc1 C4_R2W45
    s_cmp_ge_u32 s40, 6
    s_cbranch_scc1 C4_R2W45
    s_mul_i32 s44, s58, 491520
    s_mul_i32 s45, s57, 160
    s_add_u32 s44, s44, s45
    s_sub_u32 s42, s40, 4
    s_mul_i32 s42, s42, 1920
    s_add_u32 s43, s42, 0
    v_add_u32 v5, s43, v1
    v_mul_u32_u24 v6, 6554, v5
    v_lshrrev_b32 v6, 16, v6
    v_mul_u32_u24 v7, 10, v6
    v_sub_u32 v7, v5, v7
    v_mul_u32_u24 v6, 1280, v6
    v_lshl_add_u32 v6, v7, 4, v6
    buffer_load_dwordx4 v[100:103], v6, s[28:31], s44 offen
    s_add_u32 s43, s42, 64
    v_add_u32 v5, s43, v1
    v_mul_u32_u24 v6, 6554, v5
    v_lshrrev_b32 v6, 16, v6
    v_mul_u32_u24 v7, 10, v6
    v_sub_u32 v7, v5, v7
    v_mul_u32_u24 v6, 1280, v6
    v_lshl_add_u32 v6, v7, 4, v6
    buffer_load_dwordx4 v[104:107], v6, s[28:31], s44 offen
    s_add_u32 s43, s42, 128
    v_add_u32 v5, s43, v1
    v_mul_u32_u24 v6, 6554, v5
    v_lshrrev_b32 v6, 16, v6
    v_mul_u32_u24 v7, 10, v6
    v_sub_u32 v7, v5, v7
    v_mul_u32_u24 v6, 1280, v6
    v_lshl_add_u32 v6, v7, 4, v6
    buffer_load_dwordx4 v[108:111], v6, s[28:31], s44 offen
    s_add_u32 s43, s42, 192
    v_add_u32 v5, s43, v1
    v_mul_u32_u24 v6, 6554, v5
    v_lshrrev_b32 v6, 16, v6
    v_mul_u32_u24 v7, 10, v6
    v_sub_u32 v7, v5, v7
    v_mul_u32_u24 v6, 1280, v6
    v_lshl_add_u32 v6, v7, 4, v6
    buffer_load_dwordx4 v[112:115], v6, s[28:31], s44 offen
    s_add_u32 s43, s42, 256
    v_add_u32 v5, s43, v1
    v_mul_u32_u24 v6, 6554, v5
    v_lshrrev_b32 v6, 16, v6
    v_mul_u32_u24 v7, 10, v6
    v_sub_u32 v7, v5, v7
    v_mul_u32_u24 v6, 1280, v6
    v_lshl_add_u32 v6, v7, 4, v6
    buffer_load_dwordx4 v[116:119], v6, s[28:31], s44 offen
    s_add_u32 s43, s42, 320
    v_add_u32 v5, s43, v1
    v_mul_u32_u24 v6, 6554, v5
    v_lshrrev_b32 v6, 16, v6
    v_mul_u32_u24 v7, 10, v6
    v_sub_u32 v7, v5, v7
    v_mul_u32_u24 v6, 1280, v6
    v_lshl_add_u32 v6, v7, 4, v6
    buffer_load_dwordx4 v[120:123], v6, s[28:31], s44 offen
    s_add_u32 s43, s42, 384
    v_add_u32 v5, s43, v1
    v_mul_u32_u24 v6, 6554, v5
    v_lshrrev_b32 v6, 16, v6
    v_mul_u32_u24 v7, 10, v6
    v_sub_u32 v7, v5, v7
    v_mul_u32_u24 v6, 1280, v6
    v_lshl_add_u32 v6, v7, 4, v6
    buffer_load_dwordx4 v[124:127], v6, s[28:31], s44 offen
    s_add_u32 s43, s42, 448
    v_add_u32 v5, s43, v1
    v_mul_u32_u24 v6, 6554, v5
    v_lshrrev_b32 v6, 16, v6
    v_mul_u32_u24 v7, 10, v6
    v_sub_u32 v7, v5, v7
    v_mul_u32_u24 v6, 1280, v6
    v_lshl_add_u32 v6, v7, 4, v6
    buffer_load_dwordx4 v[128:131], v6, s[28:31], s44 offen
    s_add_u32 s43, s42, 512
    v_add_u32 v5, s43, v1
    v_mul_u32_u24 v6, 6554, v5
    v_lshrrev_b32 v6, 16, v6
    v_mul_u32_u24 v7, 10, v6
    v_sub_u32 v7, v5, v7
    v_mul_u32_u24 v6, 1280, v6
    v_lshl_add_u32 v6, v7, 4, v6
    buffer_load_dwordx4 v[132:135], v6, s[28:31], s44 offen
    s_add_u32 s43, s42, 576
    v_add_u32 v5, s43, v1
    v_mul_u32_u24 v6, 6554, v5
    v_lshrrev_b32 v6, 16, v6
    v_mul_u32_u24 v7, 10, v6
    v_sub_u32 v7, v5, v7
    v_mul_u32_u24 v6, 1280, v6
    v_lshl_add_u32 v6, v7, 4, v6
    buffer_load_dwordx4 v[136:139], v6, s[28:31], s44 offen
    s_add_u32 s43, s42, 640
    v_add_u32 v5, s43, v1
    v_mul_u32_u24 v6, 6554, v5
    v_lshrrev_b32 v6, 16, v6
    v_mul_u32_u24 v7, 10, v6
    v_sub_u32 v7, v5, v7
    v_mul_u32_u24 v6, 1280, v6
    v_lshl_add_u32 v6, v7, 4, v6
    buffer_load_dwordx4 v[140:143], v6, s[28:31], s44 offen
    s_add_u32 s43, s42, 704
    v_add_u32 v5, s43, v1
    v_mul_u32_u24 v6, 6554, v5
    v_lshrrev_b32 v6, 16, v6
    v_mul_u32_u24 v7, 10, v6
    v_sub_u32 v7, v5, v7
    v_mul_u32_u24 v6, 1280, v6
    v_lshl_add_u32 v6, v7, 4, v6
    buffer_load_dwordx4 v[144:147], v6, s[28:31], s44 offen
    s_add_u32 s43, s42, 768
    v_add_u32 v5, s43, v1
    v_mul_u32_u24 v6, 6554, v5
    v_lshrrev_b32 v6, 16, v6
    v_mul_u32_u24 v7, 10, v6
    v_sub_u32 v7, v5, v7
    v_mul_u32_u24 v6, 1280, v6
    v_lshl_add_u32 v6, v7, 4, v6
    buffer_load_dwordx4 v[148:151], v6, s[28:31], s44 offen
    s_add_u32 s43, s42, 832
    v_add_u32 v5, s43, v1
    v_mul_u32_u24 v6, 6554, v5
    v_lshrrev_b32 v6, 16, v6
    v_mul_u32_u24 v7, 10, v6
    v_sub_u32 v7, v5, v7
    v_mul_u32_u24 v6, 1280, v6
    v_lshl_add_u32 v6, v7, 4, v6
    buffer_load_dwordx4 v[152:155], v6, s[28:31], s44 offen
    s_add_u32 s43, s42, 896
    v_add_u32 v5, s43, v1
    v_mul_u32_u24 v6, 6554, v5
    v_lshrrev_b32 v6, 16, v6
    v_mul_u32_u24 v7, 10, v6
    v_sub_u32 v7, v5, v7
    v_mul_u32_u24 v6, 1280, v6
    v_lshl_add_u32 v6, v7, 4, v6
    buffer_load_dwordx4 v[156:159], v6, s[28:31], s44 offen
    s_add_u32 s43, s42, 960
    v_add_u32 v5, s43, v1
    v_mul_u32_u24 v6, 6554, v5
    v_lshrrev_b32 v6, 16, v6
    v_mul_u32_u24 v7, 10, v6
    v_sub_u32 v7, v5, v7
    v_mul_u32_u24 v6, 1280, v6
    v_lshl_add_u32 v6, v7, 4, v6
    buffer_load_dwordx4 v[160:163], v6, s[28:31], s44 offen
    s_add_u32 s43, s42, 1024
    v_add_u32 v5, s43, v1
    v_mul_u32_u24 v6, 6554, v5
    v_lshrrev_b32 v6, 16, v6
    v_mul_u32_u24 v7, 10, v6
    v_sub_u32 v7, v5, v7
    v_mul_u32_u24 v6, 1280, v6
    v_lshl_add_u32 v6, v7, 4, v6
    buffer_load_dwordx4 v[164:167], v6, s[28:31], s44 offen
    s_add_u32 s43, s42, 1088
    v_add_u32 v5, s43, v1
    v_mul_u32_u24 v6, 6554, v5
    v_lshrrev_b32 v6, 16, v6
    v_mul_u32_u24 v7, 10, v6
    v_sub_u32 v7, v5, v7
    v_mul_u32_u24 v6, 1280, v6
    v_lshl_add_u32 v6, v7, 4, v6
    buffer_load_dwordx4 v[168:171], v6, s[28:31], s44 offen
    s_add_u32 s43, s42, 1152
    v_add_u32 v5, s43, v1
    v_mul_u32_u24 v6, 6554, v5
    v_lshrrev_b32 v6, 16, v6
    v_mul_u32_u24 v7, 10, v6
    v_sub_u32 v7, v5, v7
    v_mul_u32_u24 v6, 1280, v6
    v_lshl_add_u32 v6, v7, 4, v6
    buffer_load_dwordx4 v[172:175], v6, s[28:31], s44 offen
    s_add_u32 s43, s42, 1216
    v_add_u32 v5, s43, v1
    v_mul_u32_u24 v6, 6554, v5
    v_lshrrev_b32 v6, 16, v6
    v_mul_u32_u24 v7, 10, v6
    v_sub_u32 v7, v5, v7
    v_mul_u32_u24 v6, 1280, v6
    v_lshl_add_u32 v6, v7, 4, v6
    buffer_load_dwordx4 v[176:179], v6, s[28:31], s44 offen
    s_add_u32 s43, s42, 1280
    v_add_u32 v5, s43, v1
    v_mul_u32_u24 v6, 6554, v5
    v_lshrrev_b32 v6, 16, v6
    v_mul_u32_u24 v7, 10, v6
    v_sub_u32 v7, v5, v7
    v_mul_u32_u24 v6, 1280, v6
    v_lshl_add_u32 v6, v7, 4, v6
    buffer_load_dwordx4 v[180:183], v6, s[28:31], s44 offen
    s_add_u32 s43, s42, 1344
    v_add_u32 v5, s43, v1
    v_mul_u32_u24 v6, 6554, v5
    v_lshrrev_b32 v6, 16, v6
    v_mul_u32_u24 v7, 10, v6
    v_sub_u32 v7, v5, v7
    v_mul_u32_u24 v6, 1280, v6
    v_lshl_add_u32 v6, v7, 4, v6
    buffer_load_dwordx4 v[184:187], v6, s[28:31], s44 offen
    s_add_u32 s43, s42, 1408
    v_add_u32 v5, s43, v1
    v_mul_u32_u24 v6, 6554, v5
    v_lshrrev_b32 v6, 16, v6
    v_mul_u32_u24 v7, 10, v6
    v_sub_u32 v7, v5, v7
    v_mul_u32_u24 v6, 1280, v6
    v_lshl_add_u32 v6, v7, 4, v6
    buffer_load_dwordx4 v[188:191], v6, s[28:31], s44 offen
    s_add_u32 s43, s42, 1472
    v_add_u32 v5, s43, v1
    v_mul_u32_u24 v6, 6554, v5
    v_lshrrev_b32 v6, 16, v6
    v_mul_u32_u24 v7, 10, v6
    v_sub_u32 v7, v5, v7
    v_mul_u32_u24 v6, 1280, v6
    v_lshl_add_u32 v6, v7, 4, v6
    buffer_load_dwordx4 v[192:195], v6, s[28:31], s44 offen
    s_add_u32 s43, s42, 1536
    v_add_u32 v5, s43, v1
    v_mul_u32_u24 v6, 6554, v5
    v_lshrrev_b32 v6, 16, v6
    v_mul_u32_u24 v7, 10, v6
    v_sub_u32 v7, v5, v7
    v_mul_u32_u24 v6, 1280, v6
    v_lshl_add_u32 v6, v7, 4, v6
    buffer_load_dwordx4 v[196:199], v6, s[28:31], s44 offen
    s_add_u32 s43, s42, 1600
    v_add_u32 v5, s43, v1
    v_mul_u32_u24 v6, 6554, v5
    v_lshrrev_b32 v6, 16, v6
    v_mul_u32_u24 v7, 10, v6
    v_sub_u32 v7, v5, v7
    v_mul_u32_u24 v6, 1280, v6
    v_lshl_add_u32 v6, v7, 4, v6
    buffer_load_dwordx4 v[200:203], v6, s[28:31], s44 offen
    s_add_u32 s43, s42, 1664
    v_add_u32 v5, s43, v1
    v_mul_u32_u24 v6, 6554, v5
    v_lshrrev_b32 v6, 16, v6
    v_mul_u32_u24 v7, 10, v6
    v_sub_u32 v7, v5, v7
    v_mul_u32_u24 v6, 1280, v6
    v_lshl_add_u32 v6, v7, 4, v6
    buffer_load_dwordx4 v[204:207], v6, s[28:31], s44 offen
    s_add_u32 s43, s42, 1728
    v_add_u32 v5, s43, v1
    v_mul_u32_u24 v6, 6554, v5
    v_lshrrev_b32 v6, 16, v6
    v_mul_u32_u24 v7, 10, v6
    v_sub_u32 v7, v5, v7
    v_mul_u32_u24 v6, 1280, v6
    v_lshl_add_u32 v6, v7, 4, v6
    buffer_load_dwordx4 v[208:211], v6, s[28:31], s44 offen
    s_add_u32 s43, s42, 1792
    v_add_u32 v5, s43, v1
    v_mul_u32_u24 v6, 6554, v5
    v_lshrrev_b32 v6, 16, v6
    v_mul_u32_u24 v7, 10, v6
    v_sub_u32 v7, v5, v7
    v_mul_u32_u24 v6, 1280, v6
    v_lshl_add_u32 v6, v7, 4, v6
    buffer_load_dwordx4 v[212:215], v6, s[28:31], s44 offen
    s_add_u32 s43, s42, 1856
    v_add_u32 v5, s43, v1
    v_mul_u32_u24 v6, 6554, v5
    v_lshrrev_b32 v6, 16, v6
    v_mul_u32_u24 v7, 10, v6
    v_sub_u32 v7, v5, v7
    v_mul_u32_u24 v6, 1280, v6
    v_lshl_add_u32 v6, v7, 4, v6
    buffer_load_dwordx4 v[216:219], v6, s[28:31], s44 offen
C4_R2W45:
    s_cmp_lg_u32 s40, 7
    s_cbranch_scc1 EP_END
    s_load_dwordx2 s[76:77], s[0:1], 112
    v_and_b32 v5, 3, v1
    v_lshlrev_b32 v5, 6, v5
    v_cmp_lt_u32 vcc, 3, v1
    v_cndmask_b32 v5, v5, 32, vcc
    v_and_b32 v4, 7, v1
    v_lshlrev_b32 v4, 7, v4
    s_mov_b32 s46, 69632
    s_mov_b32 s78, 0
    s_waitcnt vmcnt(0) lgkmcnt(0)
EP_1:
    s_sleep 8
    global_load_dword v6, v5, s[76:77] sc1
    buffer_load_dword v7, v4, s[32:35], s46 offen offset:0 sc1
    s_waitcnt vmcnt(0)
    v_readlane_b32 s42, v6, 0
    v_readlane_b32 s43, v6, 1
    v_readlane_b32 s44, v6, 2
    v_readlane_b32 s45, v6, 3
    s_add_u32 s42, s42, s43
    s_add_u32 s44, s44, s45
    s_add_u32 s42, s42, s44
    s_cmp_lg_u32 s85, 0
    s_cselect_b32 s42, 0, s42
    s_add_u32 s78, s78, 1
    s_cmp_ge_u32 s78, 0x40000
    s_cbranch_scc1 EP_2
    s_and_b32 s43, s42, 0xff
    s_cmp_eq_u32 s43, 0
    s_cbranch_scc0 EP_1
    s_lshr_b32 s43, s42, 16
    s_cmp_lg_u32 s43, 0
    s_cbranch_scc1 EP_2
    v_readlane_b32 s43, v6, 4
    s_cmp_eq_u32 s43, 0
    s_cbranch_scc1 EP_1
    v_cmp_eq_u32 vcc, 0, v7
    s_cmp_eq_u64 vcc, 0
    s_cbranch_scc0 EP_1
EP_2:
    s_lshr_b32 s42, s42, 16
    v_readlane_b32 s43, v6, 4
    v_mov_b32 v5, 155648
    v_mov_b32 v7, s43
    ds_write_b32 v5, v7 offset:36
    v_mov_b32 v6, s42
    v_mov_b32 v5, 155648
    ds_write_b32 v5, v6 offset:32
EP_END:
    v_lshrrev_b32 v4, 2, v2
    v_lshl_add_u32 v4, v3, 2, v4
    v_mul_u32_u24 v4, 96, v4
    v_and_b32 v5, 3, v2
    v_lshl_add_u32 v4, v5, 3, v4
    s_cmp_ge_u32 s40, 3
    s_cbranch_scc1 C4_NOSW
    s_lshl_b32 s42, s40, 5
    v_add_u32 v8, s42, v4
    v_add_u32 v9, 61440, v8
    ds_read_b64_tr_b16 v[20:21], v8 offset:0
    ds_read_b64_tr_b16 v[22:23], v8 offset:1536
    ds_read_b64_tr_b16 v[24:25], v8 offset:3072
    ds_read_b64_tr_b16 v[26:27], v8 offset:4608
    ds_read_b64_tr_b16 v[28:29], v8 offset:6144
    ds_read_b64_tr_b16 v[30:31], v8 offset:7680
    ds_read_b64_tr_b16 v[32:33], v8 offset:9216
    ds_read_b64_tr_b16 v[34:35], v8 offset:10752
    s_waitcnt lgkmcnt(0)
    ds_read_b64_tr_b16 v[36:37], v8 offset:12288
    ds_read_b64_tr_b16 v[38:39], v8 offset:13824
    ds_read_b64_tr_b16 v[40:41], v8 offset:15360
    ds_read_b64_tr_b16 v[42:43], v8 offset:16896
    ds_read_b64_tr_b16 v[44:45], v8 offset:18432
    ds_read_b64_tr_b16 v[46:47], v8 offset:19968
    ds_read_b64_tr_b16 v[48:49], v8 offset:21504
    ds_read_b64_tr_b16 v[50:51], v8 offset:23040
    s_waitcnt lgkmcnt(0)
    ds_read_b64_tr_b16 v[52:53], v8 offset:24576
    ds_read_b64_tr_b16 v[54:55], v8 offset:26112
    ds_read_b64_tr_b16 v[56:57], v8 offset:27648
    ds_read_b64_tr_b16 v[58:59], v8 offset:29184
    ds_read_b64_tr_b16 v[60:61], v8 offset:30720
    ds_read_b64_tr_b16 v[62:63], v8 offset:32256
    ds_read_b64_tr_b16 v[64:65], v8 offset:33792
    ds_read_b64_tr_b16 v[66:67], v8 offset:35328
    s_waitcnt lgkmcnt(0)
    ds_read_b64_tr_b16 v[68:69], v8 offset:36864
    ds_read_b64_tr_b16 v[70:71], v8 offset:38400
    ds_read_b64_tr_b16 v[72:73], v8 offset:39936
    ds_read_b64_tr_b16 v[74:75], v8 offset:41472
    ds_read_b64_tr_b16 v[76:77], v8 offset:43008
    ds_read_b64_tr_b16 v[78:79], v8 offset:44544
    ds_read_b64_tr_b16 v[80:81], v8 offset:46080
    ds_read_b64_tr_b16 v[82:83], v8 offset:47616
    s_waitcnt lgkmcnt(0)
    ds_read_b64_tr_b16 v[84:85], v8 offset:49152
    ds_read_b64_tr_b16 v[86:87], v8 offset:50688
    ds_read_b64_tr_b16 v[88:89], v8 offset:52224
    ds_read_b64_tr_b16 v[90:91], v8 offset:53760
    ds_read_b64_tr_b16 v[92:93], v8 offset:55296
    ds_read_b64_tr_b16 v[94:95], v8 offset:56832
    ds_read_b64_tr_b16 v[96:97], v8 offset:58368
    ds_read_b64_tr_b16 v[98:99], v8 offset:59904
    s_waitcnt lgkmcnt(0)
    ds_read_b64_tr_b16 v[100:101], v9 offset:0
    ds_read_b64_tr_b16 v[102:103], v9 offset:1536
    ds_read_b64_tr_b16 v[104:105], v9 offset:3072
    ds_read_b64_tr_b16 v[106:107], v9 offset:4608
    ds_read_b64_tr_b16 v[108:109], v9 offset:6144
    ds_read_b64_tr_b16 v[110:111], v9 offset:7680
    ds_read_b64_tr_b16 v[112:113], v9 offset:9216
    ds_read_b64_tr_b16 v[114:115], v9 offset:10752
    s_waitcnt lgkmcnt(0)
    ds_read_b64_tr_b16 v[116:117], v9 offset:12288
    ds_read_b64_tr_b16 v[118:119], v9 offset:13824
    ds_read_b64_tr_b16 v[120:121], v9 offset:15360
    ds_read_b64_tr_b16 v[122:123], v9 offset:16896
    ds_read_b64_tr_b16 v[124:125], v9 offset:18432
    ds_read_b64_tr_b16 v[126:127], v9 offset:19968
    ds_read_b64_tr_b16 v[128:129], v9 offset:21504
    ds_read_b64_tr_b16 v[130:131], v9 offset:23040
    s_waitcnt lgkmcnt(0)
    ds_read_b64_tr_b16 v[132:133], v9 offset:24576
    ds_read_b64_tr_b16 v[134:135], v9 offset:26112
    ds_read_b64_tr_b16 v[136:137], v9 offset:27648
    ds_read_b64_tr_b16 v[138:139], v9 offset:29184
    ds_read_b64_tr_b16 v[140:141], v9 offset:30720
    ds_read_b64_tr_b16 v[142:143], v9 offset:32256
    ds_read_b64_tr_b16 v[144:145], v9 offset:33792
    ds_read_b64_tr_b16 v[146:147], v9 offset:35328
    s_waitcnt lgkmcnt(0)
    ds_read_b64_tr_b16 v[148:149], v9 offset:36864
    ds_read_b64_tr_b16 v[150:151], v9 offset:38400
    ds_read_b64_tr_b16 v[152:153], v9 offset:39936
    ds_read_b64_tr_b16 v[154:155], v9 offset:41472
    ds_read_b64_tr_b16 v[156:157], v9 offset:43008
    ds_read_b64_tr_b16 v[158:159], v9 offset:44544
    ds_read_b64_tr_b16 v[160:161], v9 offset:46080
    ds_read_b64_tr_b16 v[162:163], v9 offset:47616
    s_waitcnt lgkmcnt(0)
    ds_read_b64_tr_b16 v[164:165], v9 offset:49152
    ds_read_b64_tr_b16 v[166:167], v9 offset:50688
    ds_read_b64_tr_b16 v[168:169], v9 offset:52224
    ds_read_b64_tr_b16 v[170:171], v9 offset:53760
    ds_read_b64_tr_b16 v[172:173], v9 offset:55296
    ds_read_b64_tr_b16 v[174:175], v9 offset:56832
    ds_read_b64_tr_b16 v[176:177], v9 offset:58368
    ds_read_b64_tr_b16 v[178:179], v9 offset:59904
    s_waitcnt lgkmcnt(0)
C4_NOSW:
    s_waitcnt lgkmcnt(0)
    s_barrier
    s_cmp_ge_u32 s40, 4
    s_cbranch_scc1 C4_NOVS
    s_and_b32 s43, s40, 3
    s_mul_i32 s43, s43, 15360
    v_add_u32 v5, s43, v15
    s_waitcnt vmcnt(18)
    ds_write_b128 v5, v[180:183] offset:0
    s_waitcnt vmcnt(17)
    ds_write_b128 v5, v[184:187] offset:1024
    s_waitcnt vmcnt(16)
    ds_write_b128 v5, v[188:191] offset:2048
    s_waitcnt vmcnt(15)
    ds_write_b128 v5, v[192:195] offset:3072
    s_waitcnt vmcnt(14)
    ds_write_b128 v5, v[196:199] offset:4096
    s_waitcnt vmcnt(13)
    ds_write_b128 v5, v[200:203] offset:5120
    s_waitcnt vmcnt(12)
    ds_write_b128 v5, v[204:207] offset:6144
    s_waitcnt vmcnt(11)
    ds_write_b128 v5, v[208:211] offset:7168
    s_waitcnt vmcnt(10)
    ds_write_b128 v5, v[212:215] offset:8192
    s_waitcnt vmcnt(9)
    ds_write_b128 v5, v[216:219] offset:9216
    s_waitcnt vmcnt(8)
    ds_write_b128 v5, v[220:223] offset:10240
    s_waitcnt vmcnt(7)
    ds_write_b128 v5, v[224:227] offset:11264
    s_waitcnt vmcnt(6)
    ds_write_b128 v5, v[228:231] offset:12288
    s_waitcnt vmcnt(5)
    ds_write_b128 v5, v[232:235] offset:13312
    s_waitcnt vmcnt(4)
    ds_write_b128 v5, v[236:239] offset:14336
C4_NOVS:
    s_waitcnt lgkmcnt(0)
    s_barrier
    s_sub_u32 s74, s40, 3
    s_mov_b32 s79, 99
    s_cmp_eq_u32 s40, 3
    s_cselect_b32 s79, 0, s79
    s_cmp_eq_u32 s40, 7
    s_cselect_b32 s79, 1, s79
    s_cmp_eq_u32 s40, 6
    s_cselect_b32 s79, 2, s79
    s_cmp_eq_u32 s79, 99
    s_cbranch_scc1 C4_NOVW
    v_lshrrev_b32 v4, 2, v2
    v_lshl_add_u32 v4, v3, 2, v4
    v_mul_u32_u24 v4, 96, v4
    v_and_b32 v5, 3, v2
    v_lshl_add_u32 v4, v5, 3, v4
    s_lshl_b32 s42, s79, 5
    v_add_u32 v8, s42, v4
    ds_read_b64_tr_b16 v[64:65], v8 offset:0
    ds_read_b64_tr_b16 v[66:67], v8 offset:1536
    ds_read_b64_tr_b16 v[68:69], v8 offset:3072
    ds_read_b64_tr_b16 v[70:71], v8 offset:4608
    ds_read_b64_tr_b16 v[72:73], v8 offset:6144
    ds_read_b64_tr_b16 v[74:75], v8 offset:7680
    ds_read_b64_tr_b16 v[76:77], v8 offset:9216
    ds_read_b64_tr_b16 v[78:79], v8 offset:10752
    s_waitcnt lgkmcnt(0)
    ds_read_b64_tr_b16 v[80:81], v8 offset:12288
    ds_read_b64_tr_b16 v[82:83], v8 offset:13824
    ds_read_b64_tr_b16 v[84:85], v8 offset:15360
    ds_read_b64_tr_b16 v[86:87], v8 offset:16896
    ds_read_b64_tr_b16 v[88:89], v8 offset:18432
    ds_read_b64_tr_b16 v[90:91], v8 offset:19968
    ds_read_b64_tr_b16 v[92:93], v8 offset:21504
    ds_read_b64_tr_b16 v[94:95], v8 offset:23040
    s_waitcnt lgkmcnt(0)
    ds_read_b64_tr_b16 v[96:97], v8 offset:24576
    ds_read_b64_tr_b16 v[98:99], v8 offset:26112
    ds_read_b64_tr_b16 v[100:101], v8 offset:27648
    ds_read_b64_tr_b16 v[102:103], v8 offset:29184
    ds_read_b64_tr_b16 v[104:105], v8 offset:30720
    ds_read_b64_tr_b16 v[106:107], v8 offset:32256
    ds_read_b64_tr_b16 v[108:109], v8 offset:33792
    ds_read_b64_tr_b16 v[110:111], v8 offset:35328
    s_waitcnt lgkmcnt(0)
    ds_read_b64_tr_b16 v[112:113], v8 offset:36864
    ds_read_b64_tr_b16 v[114:115], v8 offset:38400
    ds_read_b64_tr_b16 v[116:117], v8 offset:39936
    ds_read_b64_tr_b16 v[118:119], v8 offset:41472
    ds_read_b64_tr_b16 v[120:121], v8 offset:43008
    ds_read_b64_tr_b16 v[122:123], v8 offset:44544
    ds_read_b64_tr_b16 v[124:125], v8 offset:46080
    ds_read_b64_tr_b16 v[126:127], v8 offset:47616
    s_waitcnt lgkmcnt(0)
    ds_read_b64_tr_b16 v[128:129], v8 offset:49152
    ds_read_b64_tr_b16 v[130:131], v8 offset:50688
    ds_read_b64_tr_b16 v[132:133], v8 offset:52224
    ds_read_b64_tr_b16 v[134:135], v8 offset:53760
    ds_read_b64_tr_b16 v[136:137], v8 offset:55296
    ds_read_b64_tr_b16 v[138:139], v8 offset:56832
    ds_read_b64_tr_b16 v[140:141], v8 offset:58368
    ds_read_b64_tr_b16 v[142:143], v8 offset:59904
    s_waitcnt lgkmcnt(0)
C4_NOVW:
    s_waitcnt lgkmcnt(0)
    s_barrier
    s_cmp_lt_u32 s40, 3
    s_cbranch_scc1 C4_NOSI
    s_mul_i32 s42, s57, 5
    s_add_u32 s42, s42, s74
    s_lshl_b32 s42, s42, 9
    s_mul_i32 s43, s58, 2621440
    s_add_u32 s42, s42, s43
    s_add_u32 s42, s42, 137723904
    v_mov_b32 v4, -1
    v_mov_b32 v5, -1
    buffer_store_dwordx2 v[4:5], v13, s[32:35], s42 offen sc1
    s_add_u32 s42, s42, 20480
    buffer_store_dwordx2 v[4:5], v13, s[32:35], s42 offen sc1
    s_add_u32 s42, s42, 20480
    buffer_store_dwordx2 v[4:5], v13, s[32:35], s42 offen sc1
    s_add_u32 s42, s42, 20480
    buffer_store_dwordx2 v[4:5], v13, s[32:35], s42 offen sc1
    s_add_u32 s42, s42, 20480
    buffer_store_dwordx2 v[4:5], v13, s[32:35], s42 offen sc1
    s_add_u32 s42, s42, 20480
    buffer_store_dwordx2 v[4:5], v13, s[32:35], s42 offen sc1
    s_add_u32 s42, s42, 20480
    buffer_store_dwordx2 v[4:5], v13, s[32:35], s42 offen sc1
    s_add_u32 s42, s42, 20480
    buffer_store_dwordx2 v[4:5], v13, s[32:35], s42 offen sc1
    s_add_u32 s42, s42, 20480
C4_NOSI:
    v_mov_b32 v5, 155648
    ds_read_b32 v6, v5 offset:32
    s_mov_b32 s85, 1
    s_waitcnt lgkmcnt(0)
    v_readfirstlane_b32 s42, v6
    s_cmp_lg_u32 s42, 0
    s_cbranch_scc1 FALLBACK
    s_cmp_ge_u32 s40, 6
    s_cselect_b32 s46, 2, 0
    s_sub_u32 s46, s40, s46
    s_mul_i32 s46, s46, 7168
    s_cmp_eq_u32 s40, 4
    s_cbranch_scc1 STN_4
    s_cmp_eq_u32 s40, 5
    s_cbranch_scc1 STN_4
    s_add_u32 s43, s46, 0
    s_min_u32 s43, s43, 39936
    s_add_u32 m0, s43, 20480
    s_add_u32 s43, s43, 10485760
    buffer_load_dwordx4 v15, s[32:35], s43 offen lds
    s_add_u32 s43, s46, 1024
    s_min_u32 s43, s43, 39936
    s_add_u32 m0, s43, 20480
    s_add_u32 s43, s43, 10485760
    buffer_load_dwordx4 v15, s[32:35], s43 offen lds
    s_add_u32 s43, s46, 2048
    s_min_u32 s43, s43, 39936
    s_add_u32 m0, s43, 20480
    s_add_u32 s43, s43, 10485760
    buffer_load_dwordx4 v15, s[32:35], s43 offen lds
    s_add_u32 s43, s46, 3072
    s_min_u32 s43, s43, 39936
    s_add_u32 m0, s43, 20480
    s_add_u32 s43, s43, 10485760
    buffer_load_dwordx4 v15, s[32:35], s43 offen lds
    s_add_u32 s43, s46, 4096
    s_min_u32 s43, s43, 39936
    s_add_u32 m0, s43, 20480
    s_add_u32 s43, s43, 10485760
    buffer_load_dwordx4 v15, s[32:35], s43 offen lds
    s_add_u32 s43, s46, 5120
    s_min_u32 s43, s43, 39936
    s_add_u32 m0, s43, 20480
    s_add_u32 s43, s43, 10485760
    buffer_load_dwordx4 v15, s[32:35], s43 offen lds
    s_add_u32 s43, s46, 6144
    s_min_u32 s43, s43, 39936
    s_add_u32 m0, s43, 20480
    s_add_u32 s43, s43, 10485760
    buffer_load_dwordx4 v15, s[32:35], s43 offen lds
    s_add_u32 s43, s46, 0
    s_min_u32 s43, s43, 39936
    s_add_u32 m0, s43, 61440
    s_add_u32 s43, s43, 10526720
    buffer_load_dwordx4 v15, s[32:35], s43 offen lds
    s_add_u32 s43, s46, 1024
    s_min_u32 s43, s43, 39936
    s_add_u32 m0, s43, 61440
    s_add_u32 s43, s43, 10526720
    buffer_load_dwordx4 v15, s[32:35], s43 offen lds
    s_add_u32 s43, s46, 2048
    s_min_u32 s43, s43, 39936
    s_add_u32 m0, s43, 61440
    s_add_u32 s43, s43, 10526720
    buffer_load_dwordx4 v15, s[32:35], s43 offen lds
    s_add_u32 s43, s46, 3072
    s_min_u32 s43, s43, 39936
    s_add_u32 m0, s43, 61440
    s_add_u32 s43, s43, 10526720
    buffer_load_dwordx4 v15, s[32:35], s43 offen lds
    s_add_u32 s43, s46, 4096
    s_min_u32 s43, s43, 39936
    s_add_u32 m0, s43, 61440
    s_add_u32 s43, s43, 10526720
    buffer_load_dwordx4 v15, s[32:35], s43 offen lds
    s_add_u32 s43, s46, 5120
    s_min_u32 s43, s43, 39936
    s_add_u32 m0, s43, 61440
    s_add_u32 s43, s43, 10526720
    buffer_load_dwordx4 v15, s[32:35], s43 offen lds
    s_add_u32 s43, s46, 6144
    s_min_u32 s43, s43, 39936
    s_add_u32 m0, s43, 61440
    s_add_u32 s43, s43, 10526720
    buffer_load_dwordx4 v15, s[32:35], s43 offen lds
    s_add_u32 s43, s46, 0
    s_min_u32 s43, s43, 39936
    s_add_u32 m0, s43, 102400
    s_add_u32 s43, s43, 10567680
    buffer_load_dwordx4 v15, s[32:35], s43 offen lds
    s_add_u32 s43, s46, 1024
    s_min_u32 s43, s43, 39936
    s_add_u32 m0, s43, 102400
    s_add_u32 s43, s43, 10567680
    buffer_load_dwordx4 v15, s[32:35], s43 offen lds
    s_add_u32 s43, s46, 2048
    s_min_u32 s43, s43, 39936
    s_add_u32 m0, s43, 102400
    s_add_u32 s43, s43, 10567680
    buffer_load_dwordx4 v15, s[32:35], s43 offen lds
    s_add_u32 s43, s46, 3072
    s_min_u32 s43, s43, 39936
    s_add_u32 m0, s43, 102400
    s_add_u32 s43, s43, 10567680
    buffer_load_dwordx4 v15, s[32:35], s43 offen lds
    s_add_u32 s43, s46, 4096
    s_min_u32 s43, s43, 39936
    s_add_u32 m0, s43, 102400
    s_add_u32 s43, s43, 10567680
    buffer_load_dwordx4 v15, s[32:35], s43 offen lds
    s_add_u32 s43, s46, 5120
    s_min_u32 s43, s43, 39936
    s_add_u32 m0, s43, 102400
    s_add_u32 s43, s43, 10567680
    buffer_load_dwordx4 v15, s[32:35], s43 offen lds
    s_add_u32 s43, s46, 6144
    s_min_u32 s43, s43, 39936
    s_add_u32 m0, s43, 102400
    s_add_u32 s43, s43, 10567680
    buffer_load_dwordx4 v15, s[32:35], s43 offen lds
STN_4:
    s_cmp_lt_u32 s40, 3
    s_cselect_b32 s45, s40, s79
    s_lshr_b32 s42, s61, 1
    s_add_u32 s42, s42, 4
    s_and_b32 s43, s61, 1
    s_cmp_eq_u32 s45, 2
    s_cselect_b32 s42, s42, s61
    s_cselect_b32 s43, s43, s45
    s_lshl_b32 s42, s42, 10
    s_lshl_b32 s43, s43, 3
    s_add_u32 s42, s42, s43
    s_mul_i32 s43, s59, 12288
    s_add_u32 s44, s42, s43
    s_cmp_lt_u32 s40, 3
    s_cbranch_scc1 C4_ST_S
    s_cmp_eq_u32 s79, 99
    s_cbranch_scc1 C4_ST_N
C4_ST_V:
    s_waitcnt vmcnt(14)
    s_barrier
    v_add_u32 v4, 20480, v15
    ds_read_b128 v[144:147], v4 offset:0
    ds_read_b128 v[148:151], v4 offset:20480
    ds_read_b128 v[152:155], v4 offset:1024
    ds_read_b128 v[156:159], v4 offset:21504
    ds_read_b128 v[160:163], v4 offset:2048
    ds_read_b128 v[164:167], v4 offset:22528
    ds_read_b128 v[168:171], v4 offset:3072
    ds_read_b128 v[172:175], v4 offset:23552
    ds_read_b128 v[176:179], v4 offset:4096
    ds_read_b128 v[180:183], v4 offset:24576
    s_waitcnt lgkmcnt(8)
    v_mfma_f32_16x16x32_bf16 v[184:187], v[64:67], v[144:147], 0
    v_mfma_f32_16x16x32_bf16 v[188:191], v[64:67], v[148:151], 0
    ds_read_b128 v[144:147], v4 offset:5120
    ds_read_b128 v[148:151], v4 offset:25600
    s_waitcnt lgkmcnt(8)
    v_mfma_f32_16x16x32_bf16 v[184:187], v[68:71], v[152:155], v[184:187]
    v_mfma_f32_16x16x32_bf16 v[188:191], v[68:71], v[156:159], v[188:191]
    ds_read_b128 v[152:155], v4 offset:6144
    ds_read_b128 v[156:159], v4 offset:26624
    s_waitcnt lgkmcnt(8)
    v_mfma_f32_16x16x32_bf16 v[184:187], v[72:75], v[160:163], v[184:187]
    v_mfma_f32_16x16x32_bf16 v[188:191], v[72:75], v[164:167], v[188:191]
    ds_read_b128 v[160:163], v4 offset:7168
    ds_read_b128 v[164:167], v4 offset:27648
    s_waitcnt lgkmcnt(8)
    v_mfma_f32_16x16x32_bf16 v[184:187], v[76:79], v[168:171], v[184:187]
    v_mfma_f32_16x16x32_bf16 v[188:191], v[76:79], v[172:175], v[188:191]
    ds_read_b128 v[168:171], v4 offset:8192
    ds_read_b128 v[172:175], v4 offset:28672
    s_waitcnt lgkmcnt(8)
    v_mfma_f32_16x16x32_bf16 v[184:187], v[80:83], v[176:179], v[184:187]
    v_mfma_f32_16x16x32_bf16 v[188:191], v[80:83], v[180:183], v[188:191]
    ds_read_b128 v[176:179], v4 offset:9216
    ds_read_b128 v[180:183], v4 offset:29696
    s_waitcnt lgkmcnt(8)
    v_mfma_f32_16x16x32_bf16 v[184:187], v[84:87], v[144:147], v[184:187]
    v_mfma_f32_16x16x32_bf16 v[188:191], v[84:87], v[148:151], v[188:191]
    ds_read_b128 v[144:147], v4 offset:10240
    ds_read_b128 v[148:151], v4 offset:30720
    s_waitcnt lgkmcnt(8)
    v_mfma_f32_16x16x32_bf16 v[184:187], v[88:91], v[152:155], v[184:187]
    v_mfma_f32_16x16x32_bf16 v[188:191], v[88:91], v[156:159], v[188:191]
    ds_read_b128 v[152:155], v4 offset:11264
    ds_read_b128 v[156:159], v4 offset:31744
    s_waitcnt lgkmcnt(8)
    v_mfma_f32_16x16x32_bf16 v[184:187], v[92:95], v[160:163], v[184:187]
    v_mfma_f32_16x16x32_bf16 v[188:191], v[92:95], v[164:167], v[188:191]
    ds_read_b128 v[160:163], v4 offset:12288
    ds_read_b128 v[164:167], v4 offset:32768
    s_waitcnt lgkmcnt(8)
    v_mfma_f32_16x16x32_bf16 v[184:187], v[96:99], v[168:171], v[184:187]
    v_mfma_f32_16x16x32_bf16 v[188:191], v[96:99], v[172:175], v[188:191]
    ds_read_b128 v[168:171], v4 offset:13312
    ds_read_b128 v[172:175], v4 offset:33792
    s_waitcnt lgkmcnt(8)
    v_mfma_f32_16x16x32_bf16 v[184:187], v[100:103], v[176:179], v[184:187]
    v_mfma_f32_16x16x32_bf16 v[188:191], v[100:103], v[180:183], v[188:191]
    ds_read_b128 v[176:179], v4 offset:14336
    ds_read_b128 v[180:183], v4 offset:34816
    s_waitcnt lgkmcnt(8)
    v_mfma_f32_16x16x32_bf16 v[184:187], v[104:107], v[144:147], v[184:187]
    v_mfma_f32_16x16x32_bf16 v[188:191], v[104:107], v[148:151], v[188:191]
    ds_read_b128 v[144:147], v4 offset:15360
    ds_read_b128 v[148:151], v4 offset:35840
    s_waitcnt lgkmcnt(8)
    v_mfma_f32_16x16x32_bf16 v[184:187], v[108:111], v[152:155], v[184:187]
    v_mfma_f32_16x16x32_bf16 v[188:191], v[108:111], v[156:159], v[188:191]
    ds_read_b128 v[152:155], v4 offset:16384
    ds_read_b128 v[156:159], v4 offset:36864
    s_waitcnt lgkmcnt(8)
    v_mfma_f32_16x16x32_bf16 v[184:187], v[112:115], v[160:163], v[184:187]
    v_mfma_f32_16x16x32_bf16 v[188:191], v[112:115], v[164:167], v[188:191]
    ds_read_b128 v[160:163], v4 offset:17408
    ds_read_b128 v[164:167], v4 offset:37888
    s_waitcnt lgkmcnt(8)
    v_mfma_f32_16x16x32_bf16 v[184:187], v[116:119], v[168:171], v[184:187]
    v_mfma_f32_16x16x32_bf16 v[188:191], v[116:119], v[172:175], v[188:191]
    ds_read_b128 v[168:171], v4 offset:18432
    ds_read_b128 v[172:175], v4 offset:38912
    s_waitcnt lgkmcnt(8)
    v_mfma_f32_16x16x32_bf16 v[184:187], v[120:123], v[176:179], v[184:187]
    v_mfma_f32_16x16x32_bf16 v[188:191], v[120:123], v[180:183], v[188:191]
    ds_read_b128 v[176:179], v4 offset:19456
    ds_read_b128 v[180:183], v4 offset:39936
    s_waitcnt lgkmcnt(8)
    v_mfma_f32_16x16x32_bf16 v[184:187], v[124:127], v[144:147], v[184:187]
    v_mfma_f32_16x16x32_bf16 v[188:191], v[124:127], v[148:151], v[188:191]
    s_waitcnt lgkmcnt(6)
    v_mfma_f32_16x16x32_bf16 v[184:187], v[128:131], v[152:155], v[184:187]
    v_mfma_f32_16x16x32_bf16 v[188:191], v[128:131], v[156:159], v[188:191]
    s_waitcnt lgkmcnt(4)
    v_mfma_f32_16x16x32_bf16 v[184:187], v[132:135], v[160:163], v[184:187]
    v_mfma_f32_16x16x32_bf16 v[188:191], v[132:135], v[164:167], v[188:191]
    s_waitcnt lgkmcnt(2)
    v_mfma_f32_16x16x32_bf16 v[184:187], v[136:139], v[168:171], v[184:187]
    v_mfma_f32_16x16x32_bf16 v[188:191], v[136:139], v[172:175], v[188:191]
    s_waitcnt lgkmcnt(0)
    v_mfma_f32_16x16x32_bf16 v[184:187], v[140:143], v[176:179], v[184:187]
    v_mfma_f32_16x16x32_bf16 v[188:191], v[140:143], v[180:183], v[188:191]
    s_nop 7
    s_nop 1
    v_cvt_pk_bf16_f32 v184, v184, v185
    v_cvt_pk_bf16_f32 v185, v186, v187
    v_cvt_pk_bf16_f32 v188, v188, v189
    v_cvt_pk_bf16_f32 v189, v190, v191
    s_add_u32 s8, s44, 87031808
    s_add_u32 s9, s44, 87037952
    s_cmp_eq_u32 s92, 0
    s_cbranch_scc1 PB_5
    buffer_store_dwordx2 v[184:185], v15, s[32:35], s8 offen
    buffer_store_dwordx2 v[188:189], v15, s[32:35], s9 offen
    s_branch PB_6
PB_5:
    buffer_store_dwordx2 v[184:185], v15, s[32:35], s8 offen sc1
    buffer_store_dwordx2 v[188:189], v15, s[32:35], s9 offen sc1
PB_6:
    s_waitcnt vmcnt(9)
    s_barrier
    s_add_u32 s43, s46, 0
    s_min_u32 s43, s43, 39936
    s_add_u32 m0, s43, 20480
    s_add_u32 s43, s43, 10608640
    buffer_load_dwordx4 v15, s[32:35], s43 offen lds
    s_add_u32 s43, s46, 1024
    s_min_u32 s43, s43, 39936
    s_add_u32 m0, s43, 20480
    s_add_u32 s43, s43, 10608640
    buffer_load_dwordx4 v15, s[32:35], s43 offen lds
    s_add_u32 s43, s46, 2048
    s_min_u32 s43, s43, 39936
    s_add_u32 m0, s43, 20480
    s_add_u32 s43, s43, 10608640
    buffer_load_dwordx4 v15, s[32:35], s43 offen lds
    s_add_u32 s43, s46, 3072
    s_min_u32 s43, s43, 39936
    s_add_u32 m0, s43, 20480
    s_add_u32 s43, s43, 10608640
    buffer_load_dwordx4 v15, s[32:35], s43 offen lds
    s_add_u32 s43, s46, 4096
    s_min_u32 s43, s43, 39936
    s_add_u32 m0, s43, 20480
    s_add_u32 s43, s43, 10608640
    buffer_load_dwordx4 v15, s[32:35], s43 offen lds
    s_add_u32 s43, s46, 5120
    s_min_u32 s43, s43, 39936
    s_add_u32 m0, s43, 20480
    s_add_u32 s43, s43, 10608640
    buffer_load_dwordx4 v15, s[32:35], s43 offen lds
    s_add_u32 s43, s46, 6144
    s_min_u32 s43, s43, 39936
    s_add_u32 m0, s43, 20480
    s_add_u32 s43, s43, 10608640
    buffer_load_dwordx4 v15, s[32:35], s43 offen lds
    v_add_u32 v4, 61440, v15
    ds_read_b128 v[144:147], v4 offset:0
    ds_read_b128 v[148:151], v4 offset:20480
    ds_read_b128 v[152:155], v4 offset:1024
    ds_read_b128 v[156:159], v4 offset:21504
    ds_read_b128 v[160:163], v4 offset:2048
    ds_read_b128 v[164:167], v4 offset:22528
    ds_read_b128 v[168:171], v4 offset:3072
    ds_read_b128 v[172:175], v4 offset:23552
    ds_read_b128 v[176:179], v4 offset:4096
    ds_read_b128 v[180:183], v4 offset:24576
    s_waitcnt lgkmcnt(8)
    v_mfma_f32_16x16x32_bf16 v[184:187], v[64:67], v[144:147], 0
    v_mfma_f32_16x16x32_bf16 v[188:191], v[64:67], v[148:151], 0
    ds_read_b128 v[144:147], v4 offset:5120
    ds_read_b128 v[148:151], v4 offset:25600
    s_waitcnt lgkmcnt(8)
    v_mfma_f32_16x16x32_bf16 v[184:187], v[68:71], v[152:155], v[184:187]
    v_mfma_f32_16x16x32_bf16 v[188:191], v[68:71], v[156:159], v[188:191]
    ds_read_b128 v[152:155], v4 offset:6144
    ds_read_b128 v[156:159], v4 offset:26624
    s_waitcnt lgkmcnt(8)
    v_mfma_f32_16x16x32_bf16 v[184:187], v[72:75], v[160:163], v[184:187]
    v_mfma_f32_16x16x32_bf16 v[188:191], v[72:75], v[164:167], v[188:191]
    ds_read_b128 v[160:163], v4 offset:7168
    ds_read_b128 v[164:167], v4 offset:27648
    s_waitcnt lgkmcnt(8)
    v_mfma_f32_16x16x32_bf16 v[184:187], v[76:79], v[168:171], v[184:187]
    v_mfma_f32_16x16x32_bf16 v[188:191], v[76:79], v[172:175], v[188:191]
    ds_read_b128 v[168:171], v4 offset:8192
    ds_read_b128 v[172:175], v4 offset:28672
    s_waitcnt lgkmcnt(8)
    v_mfma_f32_16x16x32_bf16 v[184:187], v[80:83], v[176:179], v[184:187]
    v_mfma_f32_16x16x32_bf16 v[188:191], v[80:83], v[180:183], v[188:191]
    ds_read_b128 v[176:179], v4 offset:9216
    ds_read_b128 v[180:183], v4 offset:29696
    s_waitcnt lgkmcnt(8)
    v_mfma_f32_16x16x32_bf16 v[184:187], v[84:87], v[144:147], v[184:187]
    v_mfma_f32_16x16x32_bf16 v[188:191], v[84:87], v[148:151], v[188:191]
    ds_read_b128 v[144:147], v4 offset:10240
    ds_read_b128 v[148:151], v4 offset:30720
    s_waitcnt lgkmcnt(8)
    v_mfma_f32_16x16x32_bf16 v[184:187], v[88:91], v[152:155], v[184:187]
    v_mfma_f32_16x16x32_bf16 v[188:191], v[88:91], v[156:159], v[188:191]
    ds_read_b128 v[152:155], v4 offset:11264
    ds_read_b128 v[156:159], v4 offset:31744
    s_waitcnt lgkmcnt(8)
    v_mfma_f32_16x16x32_bf16 v[184:187], v[92:95], v[160:163], v[184:187]
    v_mfma_f32_16x16x32_bf16 v[188:191], v[92:95], v[164:167], v[188:191]
    ds_read_b128 v[160:163], v4 offset:12288
    ds_read_b128 v[164:167], v4 offset:32768
    s_waitcnt lgkmcnt(8)
    v_mfma_f32_16x16x32_bf16 v[184:187], v[96:99], v[168:171], v[184:187]
    v_mfma_f32_16x16x32_bf16 v[188:191], v[96:99], v[172:175], v[188:191]
    ds_read_b128 v[168:171], v4 offset:13312
    ds_read_b128 v[172:175], v4 offset:33792
    s_waitcnt lgkmcnt(8)
    v_mfma_f32_16x16x32_bf16 v[184:187], v[100:103], v[176:179], v[184:187]
    v_mfma_f32_16x16x32_bf16 v[188:191], v[100:103], v[180:183], v[188:191]
    ds_read_b128 v[176:179], v4 offset:14336
    ds_read_b128 v[180:183], v4 offset:34816
    s_waitcnt lgkmcnt(8)
    v_mfma_f32_16x16x32_bf16 v[184:187], v[104:107], v[144:147], v[184:187]
    v_mfma_f32_16x16x32_bf16 v[188:191], v[104:107], v[148:151], v[188:191]
    ds_read_b128 v[144:147], v4 offset:15360
    ds_read_b128 v[148:151], v4 offset:35840
    s_waitcnt lgkmcnt(8)
    v_mfma_f32_16x16x32_bf16 v[184:187], v[108:111], v[152:155], v[184:187]
    v_mfma_f32_16x16x32_bf16 v[188:191], v[108:111], v[156:159], v[188:191]
    ds_read_b128 v[152:155], v4 offset:16384
    ds_read_b128 v[156:159], v4 offset:36864
    s_waitcnt lgkmcnt(8)
    v_mfma_f32_16x16x32_bf16 v[184:187], v[112:115], v[160:163], v[184:187]
    v_mfma_f32_16x16x32_bf16 v[188:191], v[112:115], v[164:167], v[188:191]
    ds_read_b128 v[160:163], v4 offset:17408
    ds_read_b128 v[164:167], v4 offset:37888
    s_waitcnt lgkmcnt(8)
    v_mfma_f32_16x16x32_bf16 v[184:187], v[116:119], v[168:171], v[184:187]
    v_mfma_f32_16x16x32_bf16 v[188:191], v[116:119], v[172:175], v[188:191]
    ds_read_b128 v[168:171], v4 offset:18432
    ds_read_b128 v[172:175], v4 offset:38912
    s_waitcnt lgkmcnt(8)
    v_mfma_f32_16x16x32_bf16 v[184:187], v[120:123], v[176:179], v[184:187]
    v_mfma_f32_16x16x32_bf16 v[188:191], v[120:123], v[180:183], v[188:191]
    ds_read_b128 v[176:179], v4 offset:19456
    ds_read_b128 v[180:183], v4 offset:39936
    s_waitcnt lgkmcnt(8)
    v_mfma_f32_16x16x32_bf16 v[184:187], v[124:127], v[144:147], v[184:187]
    v_mfma_f32_16x16x32_bf16 v[188:191], v[124:127], v[148:151], v[188:191]
    s_waitcnt lgkmcnt(6)
    v_mfma_f32_16x16x32_bf16 v[184:187], v[128:131], v[152:155], v[184:187]
    v_mfma_f32_16x16x32_bf16 v[188:191], v[128:131], v[156:159], v[188:191]
    s_waitcnt lgkmcnt(4)
    v_mfma_f32_16x16x32_bf16 v[184:187], v[132:135], v[160:163], v[184:187]
    v_mfma_f32_16x16x32_bf16 v[188:191], v[132:135], v[164:167], v[188:191]
    s_waitcnt lgkmcnt(2)
    v_mfma_f32_16x16x32_bf16 v[184:187], v[136:139], v[168:171], v[184:187]
    v_mfma_f32_16x16x32_bf16 v[188:191], v[136:139], v[172:175], v[188:191]
    s_waitcnt lgkmcnt(0)
    v_mfma_f32_16x16x32_bf16 v[184:187], v[140:143], v[176:179], v[184:187]
    v_mfma_f32_16x16x32_bf16 v[188:191], v[140:143], v[180:183], v[188:191]
    s_nop 7
    s_nop 1
    v_cvt_pk_bf16_f32 v184, v184, v185
    v_cvt_pk_bf16_f32 v185, v186, v187
    v_cvt_pk_bf16_f32 v188, v188, v189
    v_cvt_pk_bf16_f32 v189, v190, v191
    s_add_u32 s8, s44, 87425024
    s_add_u32 s9, s44, 87431168
    s_cmp_eq_u32 s92, 0
    s_cbranch_scc1 PB_7
    buffer_store_dwordx2 v[184:185], v15, s[32:35], s8 offen
    buffer_store_dwordx2 v[188:189], v15, s[32:35], s9 offen
    s_branch PB_8
PB_7:
    buffer_store_dwordx2 v[184:185], v15, s[32:35], s8 offen sc1
    buffer_store_dwordx2 v[188:189], v15, s[32:35], s9 offen sc1
PB_8:
    s_waitcnt vmcnt(11)
    s_barrier
    v_add_u32 v4, 102400, v15
    ds_read_b128 v[144:147], v4 offset:0
    ds_read_b128 v[148:151], v4 offset:20480
    ds_read_b128 v[152:155], v4 offset:1024
    ds_read_b128 v[156:159], v4 offset:21504
    ds_read_b128 v[160:163], v4 offset:2048
    ds_read_b128 v[164:167], v4 offset:22528
    ds_read_b128 v[168:171], v4 offset:3072
    ds_read_b128 v[172:175], v4 offset:23552
    ds_read_b128 v[176:179], v4 offset:4096
    ds_read_b128 v[180:183], v4 offset:24576
    s_waitcnt lgkmcnt(8)
    v_mfma_f32_16x16x32_bf16 v[184:187], v[64:67], v[144:147], 0
    v_mfma_f32_16x16x32_bf16 v[188:191], v[64:67], v[148:151], 0
    ds_read_b128 v[144:147], v4 offset:5120
    ds_read_b128 v[148:151], v4 offset:25600
    s_waitcnt lgkmcnt(8)
    v_mfma_f32_16x16x32_bf16 v[184:187], v[68:71], v[152:155], v[184:187]
    v_mfma_f32_16x16x32_bf16 v[188:191], v[68:71], v[156:159], v[188:191]
    ds_read_b128 v[152:155], v4 offset:6144
    ds_read_b128 v[156:159], v4 offset:26624
    s_waitcnt lgkmcnt(8)
    v_mfma_f32_16x16x32_bf16 v[184:187], v[72:75], v[160:163], v[184:187]
    v_mfma_f32_16x16x32_bf16 v[188:191], v[72:75], v[164:167], v[188:191]
    ds_read_b128 v[160:163], v4 offset:7168
    ds_read_b128 v[164:167], v4 offset:27648
    s_waitcnt lgkmcnt(8)
    v_mfma_f32_16x16x32_bf16 v[184:187], v[76:79], v[168:171], v[184:187]
    v_mfma_f32_16x16x32_bf16 v[188:191], v[76:79], v[172:175], v[188:191]
    ds_read_b128 v[168:171], v4 offset:8192
    ds_read_b128 v[172:175], v4 offset:28672
    s_waitcnt lgkmcnt(8)
    v_mfma_f32_16x16x32_bf16 v[184:187], v[80:83], v[176:179], v[184:187]
    v_mfma_f32_16x16x32_bf16 v[188:191], v[80:83], v[180:183], v[188:191]
    ds_read_b128 v[176:179], v4 offset:9216
    ds_read_b128 v[180:183], v4 offset:29696
    s_waitcnt lgkmcnt(8)
    v_mfma_f32_16x16x32_bf16 v[184:187], v[84:87], v[144:147], v[184:187]
    v_mfma_f32_16x16x32_bf16 v[188:191], v[84:87], v[148:151], v[188:191]
    ds_read_b128 v[144:147], v4 offset:10240
    ds_read_b128 v[148:151], v4 offset:30720
    s_waitcnt lgkmcnt(8)
    v_mfma_f32_16x16x32_bf16 v[184:187], v[88:91], v[152:155], v[184:187]
    v_mfma_f32_16x16x32_bf16 v[188:191], v[88:91], v[156:159], v[188:191]
    ds_read_b128 v[152:155], v4 offset:11264
    ds_read_b128 v[156:159], v4 offset:31744
    s_waitcnt lgkmcnt(8)
    v_mfma_f32_16x16x32_bf16 v[184:187], v[92:95], v[160:163], v[184:187]
    v_mfma_f32_16x16x32_bf16 v[188:191], v[92:95], v[164:167], v[188:191]
    ds_read_b128 v[160:163], v4 offset:12288
    ds_read_b128 v[164:167], v4 offset:32768
    s_waitcnt lgkmcnt(8)
    v_mfma_f32_16x16x32_bf16 v[184:187], v[96:99], v[168:171], v[184:187]
    v_mfma_f32_16x16x32_bf16 v[188:191], v[96:99], v[172:175], v[188:191]
    ds_read_b128 v[168:171], v4 offset:13312
    ds_read_b128 v[172:175], v4 offset:33792
    s_waitcnt lgkmcnt(8)
    v_mfma_f32_16x16x32_bf16 v[184:187], v[100:103], v[176:179], v[184:187]
    v_mfma_f32_16x16x32_bf16 v[188:191], v[100:103], v[180:183], v[188:191]
    ds_read_b128 v[176:179], v4 offset:14336
    ds_read_b128 v[180:183], v4 offset:34816
    s_waitcnt lgkmcnt(8)
    v_mfma_f32_16x16x32_bf16 v[184:187], v[104:107], v[144:147], v[184:187]
    v_mfma_f32_16x16x32_bf16 v[188:191], v[104:107], v[148:151], v[188:191]
    ds_read_b128 v[144:147], v4 offset:15360
    ds_read_b128 v[148:151], v4 offset:35840
    s_waitcnt lgkmcnt(8)
    v_mfma_f32_16x16x32_bf16 v[184:187], v[108:111], v[152:155], v[184:187]
    v_mfma_f32_16x16x32_bf16 v[188:191], v[108:111], v[156:159], v[188:191]
    ds_read_b128 v[152:155], v4 offset:16384
    ds_read_b128 v[156:159], v4 offset:36864
    s_waitcnt lgkmcnt(8)
    v_mfma_f32_16x16x32_bf16 v[184:187], v[112:115], v[160:163], v[184:187]
    v_mfma_f32_16x16x32_bf16 v[188:191], v[112:115], v[164:167], v[188:191]
    ds_read_b128 v[160:163], v4 offset:17408
    ds_read_b128 v[164:167], v4 offset:37888
    s_waitcnt lgkmcnt(8)
    v_mfma_f32_16x16x32_bf16 v[184:187], v[116:119], v[168:171], v[184:187]
    v_mfma_f32_16x16x32_bf16 v[188:191], v[116:119], v[172:175], v[188:191]
    ds_read_b128 v[168:171], v4 offset:18432
    ds_read_b128 v[172:175], v4 offset:38912
    s_waitcnt lgkmcnt(8)
    v_mfma_f32_16x16x32_bf16 v[184:187], v[120:123], v[176:179], v[184:187]
    v_mfma_f32_16x16x32_bf16 v[188:191], v[120:123], v[180:183], v[188:191]
    ds_read_b128 v[176:179], v4 offset:19456
    ds_read_b128 v[180:183], v4 offset:39936
    s_waitcnt lgkmcnt(8)
    v_mfma_f32_16x16x32_bf16 v[184:187], v[124:127], v[144:147], v[184:187]
    v_mfma_f32_16x16x32_bf16 v[188:191], v[124:127], v[148:151], v[188:191]
    s_waitcnt lgkmcnt(6)
    v_mfma_f32_16x16x32_bf16 v[184:187], v[128:131], v[152:155], v[184:187]
    v_mfma_f32_16x16x32_bf16 v[188:191], v[128:131], v[156:159], v[188:191]
    s_waitcnt lgkmcnt(4)
    v_mfma_f32_16x16x32_bf16 v[184:187], v[132:135], v[160:163], v[184:187]
    v_mfma_f32_16x16x32_bf16 v[188:191], v[132:135], v[164:167], v[188:191]
    s_waitcnt lgkmcnt(2)
    v_mfma_f32_16x16x32_bf16 v[184:187], v[136:139], v[168:171], v[184:187]
    v_mfma_f32_16x16x32_bf16 v[188:191], v[136:139], v[172:175], v[188:191]
    s_waitcnt lgkmcnt(0)
    v_mfma_f32_16x16x32_bf16 v[184:187], v[140:143], v[176:179], v[184:187]
    v_mfma_f32_16x16x32_bf16 v[188:191], v[140:143], v[180:183], v[188:191]
    s_nop 7
    s_nop 1
    v_cvt_pk_bf16_f32 v184, v184, v185
    v_cvt_pk_bf16_f32 v185, v186, v187
    v_cvt_pk_bf16_f32 v188, v188, v189
    v_cvt_pk_bf16_f32 v189, v190, v191
    s_add_u32 s8, s44, 87818240
    s_add_u32 s9, s44, 87824384
    s_cmp_eq_u32 s92, 0
    s_cbranch_scc1 PB_9
    buffer_store_dwordx2 v[184:185], v15, s[32:35], s8 offen
    buffer_store_dwordx2 v[188:189], v15, s[32:35], s9 offen
    s_branch PB_10
PB_9:
    buffer_store_dwordx2 v[184:185], v15, s[32:35], s8 offen sc1
    buffer_store_dwordx2 v[188:189], v15, s[32:35], s9 offen sc1
PB_10:
    s_waitcnt vmcnt(4)
    s_barrier
    v_add_u32 v4, 20480, v15
    ds_read_b128 v[144:147], v4 offset:0
    ds_read_b128 v[148:151], v4 offset:20480
    ds_read_b128 v[152:155], v4 offset:1024
    ds_read_b128 v[156:159], v4 offset:21504
    ds_read_b128 v[160:163], v4 offset:2048
    ds_read_b128 v[164:167], v4 offset:22528
    ds_read_b128 v[168:171], v4 offset:3072
    ds_read_b128 v[172:175], v4 offset:23552
    ds_read_b128 v[176:179], v4 offset:4096
    ds_read_b128 v[180:183], v4 offset:24576
    s_waitcnt lgkmcnt(8)
    v_mfma_f32_16x16x32_bf16 v[184:187], v[64:67], v[144:147], 0
    v_mfma_f32_16x16x32_bf16 v[188:191], v[64:67], v[148:151], 0
    ds_read_b128 v[144:147], v4 offset:5120
    ds_read_b128 v[148:151], v4 offset:25600
    s_waitcnt lgkmcnt(8)
    v_mfma_f32_16x16x32_bf16 v[184:187], v[68:71], v[152:155], v[184:187]
    v_mfma_f32_16x16x32_bf16 v[188:191], v[68:71], v[156:159], v[188:191]
    ds_read_b128 v[152:155], v4 offset:6144
    ds_read_b128 v[156:159], v4 offset:26624
    s_waitcnt lgkmcnt(8)
    v_mfma_f32_16x16x32_bf16 v[184:187], v[72:75], v[160:163], v[184:187]
    v_mfma_f32_16x16x32_bf16 v[188:191], v[72:75], v[164:167], v[188:191]
    ds_read_b128 v[160:163], v4 offset:7168
    ds_read_b128 v[164:167], v4 offset:27648
    s_waitcnt lgkmcnt(8)
    v_mfma_f32_16x16x32_bf16 v[184:187], v[76:79], v[168:171], v[184:187]
    v_mfma_f32_16x16x32_bf16 v[188:191], v[76:79], v[172:175], v[188:191]
    ds_read_b128 v[168:171], v4 offset:8192
    ds_read_b128 v[172:175], v4 offset:28672
    s_waitcnt lgkmcnt(8)
    v_mfma_f32_16x16x32_bf16 v[184:187], v[80:83], v[176:179], v[184:187]
    v_mfma_f32_16x16x32_bf16 v[188:191], v[80:83], v[180:183], v[188:191]
    ds_read_b128 v[176:179], v4 offset:9216
    ds_read_b128 v[180:183], v4 offset:29696
    s_waitcnt lgkmcnt(8)
    v_mfma_f32_16x16x32_bf16 v[184:187], v[84:87], v[144:147], v[184:187]
    v_mfma_f32_16x16x32_bf16 v[188:191], v[84:87], v[148:151], v[188:191]
    ds_read_b128 v[144:147], v4 offset:10240
    ds_read_b128 v[148:151], v4 offset:30720
    s_waitcnt lgkmcnt(8)
    v_mfma_f32_16x16x32_bf16 v[184:187], v[88:91], v[152:155], v[184:187]
    v_mfma_f32_16x16x32_bf16 v[188:191], v[88:91], v[156:159], v[188:191]
    ds_read_b128 v[152:155], v4 offset:11264
    ds_read_b128 v[156:159], v4 offset:31744
    s_waitcnt lgkmcnt(8)
    v_mfma_f32_16x16x32_bf16 v[184:187], v[92:95], v[160:163], v[184:187]
    v_mfma_f32_16x16x32_bf16 v[188:191], v[92:95], v[164:167], v[188:191]
    ds_read_b128 v[160:163], v4 offset:12288
    ds_read_b128 v[164:167], v4 offset:32768
    s_waitcnt lgkmcnt(8)
    v_mfma_f32_16x16x32_bf16 v[184:187], v[96:99], v[168:171], v[184:187]
    v_mfma_f32_16x16x32_bf16 v[188:191], v[96:99], v[172:175], v[188:191]
    ds_read_b128 v[168:171], v4 offset:13312
    ds_read_b128 v[172:175], v4 offset:33792
    s_waitcnt lgkmcnt(8)
    v_mfma_f32_16x16x32_bf16 v[184:187], v[100:103], v[176:179], v[184:187]
    v_mfma_f32_16x16x32_bf16 v[188:191], v[100:103], v[180:183], v[188:191]
    ds_read_b128 v[176:179], v4 offset:14336
    ds_read_b128 v[180:183], v4 offset:34816
    s_waitcnt lgkmcnt(8)
    v_mfma_f32_16x16x32_bf16 v[184:187], v[104:107], v[144:147], v[184:187]
    v_mfma_f32_16x16x32_bf16 v[188:191], v[104:107], v[148:151], v[188:191]
    ds_read_b128 v[144:147], v4 offset:15360
    ds_read_b128 v[148:151], v4 offset:35840
    s_waitcnt lgkmcnt(8)
    v_mfma_f32_16x16x32_bf16 v[184:187], v[108:111], v[152:155], v[184:187]
    v_mfma_f32_16x16x32_bf16 v[188:191], v[108:111], v[156:159], v[188:191]
    ds_read_b128 v[152:155], v4 offset:16384
    ds_read_b128 v[156:159], v4 offset:36864
    s_waitcnt lgkmcnt(8)
    v_mfma_f32_16x16x32_bf16 v[184:187], v[112:115], v[160:163], v[184:187]
    v_mfma_f32_16x16x32_bf16 v[188:191], v[112:115], v[164:167], v[188:191]
    ds_read_b128 v[160:163], v4 offset:17408
    ds_read_b128 v[164:167], v4 offset:37888
    s_waitcnt lgkmcnt(8)
    v_mfma_f32_16x16x32_bf16 v[184:187], v[116:119], v[168:171], v[184:187]
    v_mfma_f32_16x16x32_bf16 v[188:191], v[116:119], v[172:175], v[188:191]
    ds_read_b128 v[168:171], v4 offset:18432
    ds_read_b128 v[172:175], v4 offset:38912
    s_waitcnt lgkmcnt(8)
    v_mfma_f32_16x16x32_bf16 v[184:187], v[120:123], v[176:179], v[184:187]
    v_mfma_f32_16x16x32_bf16 v[188:191], v[120:123], v[180:183], v[188:191]
    ds_read_b128 v[176:179], v4 offset:19456
    ds_read_b128 v[180:183], v4 offset:39936
    s_waitcnt lgkmcnt(8)
    v_mfma_f32_16x16x32_bf16 v[184:187], v[124:127], v[144:147], v[184:187]
    v_mfma_f32_16x16x32_bf16 v[188:191], v[124:127], v[148:151], v[188:191]
    s_waitcnt lgkmcnt(6)
    v_mfma_f32_16x16x32_bf16 v[184:187], v[128:131], v[152:155], v[184:187]
    v_mfma_f32_16x16x32_bf16 v[188:191], v[128:131], v[156:159], v[188:191]
    s_waitcnt lgkmcnt(4)
    v_mfma_f32_16x16x32_bf16 v[184:187], v[132:135], v[160:163], v[184:187]
    v_mfma_f32_16x16x32_bf16 v[188:191], v[132:135], v[164:167], v[188:191]
    s_waitcnt lgkmcnt(2)
    v_mfma_f32_16x16x32_bf16 v[184:187], v[136:139], v[168:171], v[184:187]
    v_mfma_f32_16x16x32_bf16 v[188:191], v[136:139], v[172:175], v[188:191]
    s_waitcnt lgkmcnt(0)
    v_mfma_f32_16x16x32_bf16 v[184:187], v[140:143], v[176:179], v[184:187]
    v_mfma_f32_16x16x32_bf16 v[188:191], v[140:143], v[180:183], v[188:191]
    s_nop 7
    s_nop 1
    v_cvt_pk_bf16_f32 v184, v184, v185
    v_cvt_pk_bf16_f32 v185, v186, v187
    v_cvt_pk_bf16_f32 v188, v188, v189
    v_cvt_pk_bf16_f32 v189, v190, v191
    s_add_u32 s8, s44, 88211456
    s_add_u32 s9, s44, 88217600
    s_cmp_eq_u32 s92, 0
    s_cbranch_scc1 PB_11
    buffer_store_dwordx2 v[184:185], v15, s[32:35], s8 offen
    buffer_store_dwordx2 v[188:189], v15, s[32:35], s9 offen
    s_branch PB_12
PB_11:
    buffer_store_dwordx2 v[184:185], v15, s[32:35], s8 offen sc1
    buffer_store_dwordx2 v[188:189], v15, s[32:35], s9 offen sc1
PB_12:
    s_branch C4_ST_E
C4_ST_S:
    s_waitcnt vmcnt(14)
    s_barrier
    v_add_u32 v4, 20480, v15
    ds_read_b128 v[180:183], v4 offset:0
    ds_read_b128 v[184:187], v4 offset:20480
    ds_read_b128 v[188:191], v4 offset:1024
    ds_read_b128 v[192:195], v4 offset:21504
    ds_read_b128 v[196:199], v4 offset:2048
    ds_read_b128 v[200:203], v4 offset:22528
    ds_read_b128 v[204:207], v4 offset:3072
    ds_read_b128 v[208:211], v4 offset:23552
    ds_read_b128 v[212:215], v4 offset:4096
    ds_read_b128 v[216:219], v4 offset:24576
    s_waitcnt lgkmcnt(8)
    v_mfma_f32_16x16x32_bf16 v[220:223], v[20:23], v[180:183], 0
    v_mfma_f32_16x16x32_bf16 v[228:231], v[100:103], v[180:183], 0
    v_mfma_f32_16x16x32_bf16 v[224:227], v[20:23], v[184:187], 0
    v_mfma_f32_16x16x32_bf16 v[232:235], v[100:103], v[184:187], 0
    ds_read_b128 v[180:183], v4 offset:5120
    ds_read_b128 v[184:187], v4 offset:25600
    s_waitcnt lgkmcnt(8)
    v_mfma_f32_16x16x32_bf16 v[220:223], v[24:27], v[188:191], v[220:223]
    v_mfma_f32_16x16x32_bf16 v[228:231], v[104:107], v[188:191], v[228:231]
    v_mfma_f32_16x16x32_bf16 v[224:227], v[24:27], v[192:195], v[224:227]
    v_mfma_f32_16x16x32_bf16 v[232:235], v[104:107], v[192:195], v[232:235]
    ds_read_b128 v[188:191], v4 offset:6144
    ds_read_b128 v[192:195], v4 offset:26624
    s_waitcnt lgkmcnt(8)
    v_mfma_f32_16x16x32_bf16 v[220:223], v[28:31], v[196:199], v[220:223]
    v_mfma_f32_16x16x32_bf16 v[228:231], v[108:111], v[196:199], v[228:231]
    v_mfma_f32_16x16x32_bf16 v[224:227], v[28:31], v[200:203], v[224:227]
    v_mfma_f32_16x16x32_bf16 v[232:235], v[108:111], v[200:203], v[232:235]
    ds_read_b128 v[196:199], v4 offset:7168
    ds_read_b128 v[200:203], v4 offset:27648
    s_waitcnt lgkmcnt(8)
    v_mfma_f32_16x16x32_bf16 v[220:223], v[32:35], v[204:207], v[220:223]
    v_mfma_f32_16x16x32_bf16 v[228:231], v[112:115], v[204:207], v[228:231]
    v_mfma_f32_16x16x32_bf16 v[224:227], v[32:35], v[208:211], v[224:227]
    v_mfma_f32_16x16x32_bf16 v[232:235], v[112:115], v[208:211], v[232:235]
    ds_read_b128 v[204:207], v4 offset:8192
    ds_read_b128 v[208:211], v4 offset:28672
    s_waitcnt lgkmcnt(8)
    v_mfma_f32_16x16x32_bf16 v[220:223], v[36:39], v[212:215], v[220:223]
    v_mfma_f32_16x16x32_bf16 v[228:231], v[116:119], v[212:215], v[228:231]
    v_mfma_f32_16x16x32_bf16 v[224:227], v[36:39], v[216:219], v[224:227]
    v_mfma_f32_16x16x32_bf16 v[232:235], v[116:119], v[216:219], v[232:235]
    ds_read_b128 v[212:215], v4 offset:9216
    ds_read_b128 v[216:219], v4 offset:29696
    s_waitcnt lgkmcnt(8)
    v_mfma_f32_16x16x32_bf16 v[220:223], v[40:43], v[180:183], v[220:223]
    v_mfma_f32_16x16x32_bf16 v[228:231], v[120:123], v[180:183], v[228:231]
    v_mfma_f32_16x16x32_bf16 v[224:227], v[40:43], v[184:187], v[224:227]
    v_mfma_f32_16x16x32_bf16 v[232:235], v[120:123], v[184:187], v[232:235]
    ds_read_b128 v[180:183], v4 offset:10240
    ds_read_b128 v[184:187], v4 offset:30720
    s_waitcnt lgkmcnt(8)
    v_mfma_f32_16x16x32_bf16 v[220:223], v[44:47], v[188:191], v[220:223]
    v_mfma_f32_16x16x32_bf16 v[228:231], v[124:127], v[188:191], v[228:231]
    v_mfma_f32_16x16x32_bf16 v[224:227], v[44:47], v[192:195], v[224:227]
    v_mfma_f32_16x16x32_bf16 v[232:235], v[124:127], v[192:195], v[232:235]
    ds_read_b128 v[188:191], v4 offset:11264
    ds_read_b128 v[192:195], v4 offset:31744
    s_waitcnt lgkmcnt(8)
    v_mfma_f32_16x16x32_bf16 v[220:223], v[48:51], v[196:199], v[220:223]
    v_mfma_f32_16x16x32_bf16 v[228:231], v[128:131], v[196:199], v[228:231]
    v_mfma_f32_16x16x32_bf16 v[224:227], v[48:51], v[200:203], v[224:227]
    v_mfma_f32_16x16x32_bf16 v[232:235], v[128:131], v[200:203], v[232:235]
    ds_read_b128 v[196:199], v4 offset:12288
    ds_read_b128 v[200:203], v4 offset:32768
    s_waitcnt lgkmcnt(8)
    v_mfma_f32_16x16x32_bf16 v[220:223], v[52:55], v[204:207], v[220:223]
    v_mfma_f32_16x16x32_bf16 v[228:231], v[132:135], v[204:207], v[228:231]
    v_mfma_f32_16x16x32_bf16 v[224:227], v[52:55], v[208:211], v[224:227]
    v_mfma_f32_16x16x32_bf16 v[232:235], v[132:135], v[208:211], v[232:235]
    ds_read_b128 v[204:207], v4 offset:13312
    ds_read_b128 v[208:211], v4 offset:33792
    s_waitcnt lgkmcnt(8)
    v_mfma_f32_16x16x32_bf16 v[220:223], v[56:59], v[212:215], v[220:223]
    v_mfma_f32_16x16x32_bf16 v[228:231], v[136:139], v[212:215], v[228:231]
    v_mfma_f32_16x16x32_bf16 v[224:227], v[56:59], v[216:219], v[224:227]
    v_mfma_f32_16x16x32_bf16 v[232:235], v[136:139], v[216:219], v[232:235]
    ds_read_b128 v[212:215], v4 offset:14336
    ds_read_b128 v[216:219], v4 offset:34816
    s_waitcnt lgkmcnt(8)
    v_mfma_f32_16x16x32_bf16 v[220:223], v[60:63], v[180:183], v[220:223]
    v_mfma_f32_16x16x32_bf16 v[228:231], v[140:143], v[180:183], v[228:231]
    v_mfma_f32_16x16x32_bf16 v[224:227], v[60:63], v[184:187], v[224:227]
    v_mfma_f32_16x16x32_bf16 v[232:235], v[140:143], v[184:187], v[232:235]
    ds_read_b128 v[180:183], v4 offset:15360
    ds_read_b128 v[184:187], v4 offset:35840
    s_waitcnt lgkmcnt(8)
    v_mfma_f32_16x16x32_bf16 v[220:223], v[64:67], v[188:191], v[220:223]
    v_mfma_f32_16x16x32_bf16 v[228:231], v[144:147], v[188:191], v[228:231]
    v_mfma_f32_16x16x32_bf16 v[224:227], v[64:67], v[192:195], v[224:227]
    v_mfma_f32_16x16x32_bf16 v[232:235], v[144:147], v[192:195], v[232:235]
    ds_read_b128 v[188:191], v4 offset:16384
    ds_read_b128 v[192:195], v4 offset:36864
    s_waitcnt lgkmcnt(8)
    v_mfma_f32_16x16x32_bf16 v[220:223], v[68:71], v[196:199], v[220:223]
    v_mfma_f32_16x16x32_bf16 v[228:231], v[148:151], v[196:199], v[228:231]
    v_mfma_f32_16x16x32_bf16 v[224:227], v[68:71], v[200:203], v[224:227]
    v_mfma_f32_16x16x32_bf16 v[232:235], v[148:151], v[200:203], v[232:235]
    ds_read_b128 v[196:199], v4 offset:17408
    ds_read_b128 v[200:203], v4 offset:37888
    s_waitcnt lgkmcnt(8)
    v_mfma_f32_16x16x32_bf16 v[220:223], v[72:75], v[204:207], v[220:223]
    v_mfma_f32_16x16x32_bf16 v[228:231], v[152:155], v[204:207], v[228:231]
    v_mfma_f32_16x16x32_bf16 v[224:227], v[72:75], v[208:211], v[224:227]
    v_mfma_f32_16x16x32_bf16 v[232:235], v[152:155], v[208:211], v[232:235]
    ds_read_b128 v[204:207], v4 offset:18432
    ds_read_b128 v[208:211], v4 offset:38912
    s_waitcnt lgkmcnt(8)
    v_mfma_f32_16x16x32_bf16 v[220:223], v[76:79], v[212:215], v[220:223]
    v_mfma_f32_16x16x32_bf16 v[228:231], v[156:159], v[212:215], v[228:231]
    v_mfma_f32_16x16x32_bf16 v[224:227], v[76:79], v[216:219], v[224:227]
    v_mfma_f32_16x16x32_bf16 v[232:235], v[156:159], v[216:219], v[232:235]
    ds_read_b128 v[212:215], v4 offset:19456
    ds_read_b128 v[216:219], v4 offset:39936
    s_waitcnt lgkmcnt(8)
    v_mfma_f32_16x16x32_bf16 v[220:223], v[80:83], v[180:183], v[220:223]
    v_mfma_f32_16x16x32_bf16 v[228:231], v[160:163], v[180:183], v[228:231]
    v_mfma_f32_16x16x32_bf16 v[224:227], v[80:83], v[184:187], v[224:227]
    v_mfma_f32_16x16x32_bf16 v[232:235], v[160:163], v[184:187], v[232:235]
    s_waitcnt lgkmcnt(6)
    v_mfma_f32_16x16x32_bf16 v[220:223], v[84:87], v[188:191], v[220:223]
    v_mfma_f32_16x16x32_bf16 v[228:231], v[164:167], v[188:191], v[228:231]
    v_mfma_f32_16x16x32_bf16 v[224:227], v[84:87], v[192:195], v[224:227]
    v_mfma_f32_16x16x32_bf16 v[232:235], v[164:167], v[192:195], v[232:235]
    s_waitcnt lgkmcnt(4)
    v_mfma_f32_16x16x32_bf16 v[220:223], v[88:91], v[196:199], v[220:223]
    v_mfma_f32_16x16x32_bf16 v[228:231], v[168:171], v[196:199], v[228:231]
    v_mfma_f32_16x16x32_bf16 v[224:227], v[88:91], v[200:203], v[224:227]
    v_mfma_f32_16x16x32_bf16 v[232:235], v[168:171], v[200:203], v[232:235]
    s_waitcnt lgkmcnt(2)
    v_mfma_f32_16x16x32_bf16 v[220:223], v[92:95], v[204:207], v[220:223]
    v_mfma_f32_16x16x32_bf16 v[228:231], v[172:175], v[204:207], v[228:231]
    v_mfma_f32_16x16x32_bf16 v[224:227], v[92:95], v[208:211], v[224:227]
    v_mfma_f32_16x16x32_bf16 v[232:235], v[172:175], v[208:211], v[232:235]
    s_waitcnt lgkmcnt(0)
    v_mfma_f32_16x16x32_bf16 v[220:223], v[96:99], v[212:215], v[220:223]
    v_mfma_f32_16x16x32_bf16 v[228:231], v[176:179], v[212:215], v[228:231]
    v_mfma_f32_16x16x32_bf16 v[224:227], v[96:99], v[216:219], v[224:227]
    v_mfma_f32_16x16x32_bf16 v[232:235], v[176:179], v[216:219], v[232:235]
    s_nop 7
    s_nop 1
    v_cvt_pk_bf16_f32 v220, v220, v221
    v_cvt_pk_bf16_f32 v221, v222, v223
    v_cvt_pk_bf16_f32 v224, v224, v225
    v_cvt_pk_bf16_f32 v225, v226, v227
    v_cvt_pk_bf16_f32 v228, v228, v229
    v_cvt_pk_bf16_f32 v229, v230, v231
    v_cvt_pk_bf16_f32 v232, v232, v233
    v_cvt_pk_bf16_f32 v233, v234, v235
    s_add_u32 s8, s44, 34603008
    s_add_u32 s9, s44, 34609152
    s_add_u32 s10, s44, 60817408
    s_add_u32 s11, s44, 60823552
    s_cmp_eq_u32 s92, 0
    s_cbranch_scc1 PB_13
    buffer_store_dwordx2 v[220:221], v15, s[32:35], s8 offen
    buffer_store_dwordx2 v[224:225], v15, s[32:35], s9 offen
    buffer_store_dwordx2 v[228:229], v15, s[32:35], s10 offen
    buffer_store_dwordx2 v[232:233], v15, s[32:35], s11 offen
    s_branch PB_14
PB_13:
    buffer_store_dwordx2 v[220:221], v15, s[32:35], s8 offen sc1
    buffer_store_dwordx2 v[224:225], v15, s[32:35], s9 offen sc1
    buffer_store_dwordx2 v[228:229], v15, s[32:35], s10 offen sc1
    buffer_store_dwordx2 v[232:233], v15, s[32:35], s11 offen sc1
PB_14:
    s_waitcnt vmcnt(11)
    s_barrier
    s_add_u32 s43, s46, 0
    s_min_u32 s43, s43, 39936
    s_add_u32 m0, s43, 20480
    s_add_u32 s43, s43, 10608640
    buffer_load_dwordx4 v15, s[32:35], s43 offen lds
    s_add_u32 s43, s46, 1024
    s_min_u32 s43, s43, 39936
    s_add_u32 m0, s43, 20480
    s_add_u32 s43, s43, 10608640
    buffer_load_dwordx4 v15, s[32:35], s43 offen lds
    s_add_u32 s43, s46, 2048
    s_min_u32 s43, s43, 39936
    s_add_u32 m0, s43, 20480
    s_add_u32 s43, s43, 10608640
    buffer_load_dwordx4 v15, s[32:35], s43 offen lds
    s_add_u32 s43, s46, 3072
    s_min_u32 s43, s43, 39936
    s_add_u32 m0, s43, 20480
    s_add_u32 s43, s43, 10608640
    buffer_load_dwordx4 v15, s[32:35], s43 offen lds
    s_add_u32 s43, s46, 4096
    s_min_u32 s43, s43, 39936
    s_add_u32 m0, s43, 20480
    s_add_u32 s43, s43, 10608640
    buffer_load_dwordx4 v15, s[32:35], s43 offen lds
    s_add_u32 s43, s46, 5120
    s_min_u32 s43, s43, 39936
    s_add_u32 m0, s43, 20480
    s_add_u32 s43, s43, 10608640
    buffer_load_dwordx4 v15, s[32:35], s43 offen lds
    s_add_u32 s43, s46, 6144
    s_min_u32 s43, s43, 39936
    s_add_u32 m0, s43, 20480
    s_add_u32 s43, s43, 10608640
    buffer_load_dwordx4 v15, s[32:35], s43 offen lds
    v_add_u32 v4, 61440, v15
    ds_read_b128 v[180:183], v4 offset:0
    ds_read_b128 v[184:187], v4 offset:20480
    ds_read_b128 v[188:191], v4 offset:1024
    ds_read_b128 v[192:195], v4 offset:21504
    ds_read_b128 v[196:199], v4 offset:2048
    ds_read_b128 v[200:203], v4 offset:22528
    ds_read_b128 v[204:207], v4 offset:3072
    ds_read_b128 v[208:211], v4 offset:23552
    ds_read_b128 v[212:215], v4 offset:4096
    ds_read_b128 v[216:219], v4 offset:24576
    s_waitcnt lgkmcnt(8)
    v_mfma_f32_16x16x32_bf16 v[220:223], v[20:23], v[180:183], 0
    v_mfma_f32_16x16x32_bf16 v[228:231], v[100:103], v[180:183], 0
    v_mfma_f32_16x16x32_bf16 v[224:227], v[20:23], v[184:187], 0
    v_mfma_f32_16x16x32_bf16 v[232:235], v[100:103], v[184:187], 0
    ds_read_b128 v[180:183], v4 offset:5120
    ds_read_b128 v[184:187], v4 offset:25600
    s_waitcnt lgkmcnt(8)
    v_mfma_f32_16x16x32_bf16 v[220:223], v[24:27], v[188:191], v[220:223]
    v_mfma_f32_16x16x32_bf16 v[228:231], v[104:107], v[188:191], v[228:231]
    v_mfma_f32_16x16x32_bf16 v[224:227], v[24:27], v[192:195], v[224:227]
    v_mfma_f32_16x16x32_bf16 v[232:235], v[104:107], v[192:195], v[232:235]
    ds_read_b128 v[188:191], v4 offset:6144
    ds_read_b128 v[192:195], v4 offset:26624
    s_waitcnt lgkmcnt(8)
    v_mfma_f32_16x16x32_bf16 v[220:223], v[28:31], v[196:199], v[220:223]
    v_mfma_f32_16x16x32_bf16 v[228:231], v[108:111], v[196:199], v[228:231]
    v_mfma_f32_16x16x32_bf16 v[224:227], v[28:31], v[200:203], v[224:227]
    v_mfma_f32_16x16x32_bf16 v[232:235], v[108:111], v[200:203], v[232:235]
    ds_read_b128 v[196:199], v4 offset:7168
    ds_read_b128 v[200:203], v4 offset:27648
    s_waitcnt lgkmcnt(8)
    v_mfma_f32_16x16x32_bf16 v[220:223], v[32:35], v[204:207], v[220:223]
    v_mfma_f32_16x16x32_bf16 v[228:231], v[112:115], v[204:207], v[228:231]
    v_mfma_f32_16x16x32_bf16 v[224:227], v[32:35], v[208:211], v[224:227]
    v_mfma_f32_16x16x32_bf16 v[232:235], v[112:115], v[208:211], v[232:235]
    ds_read_b128 v[204:207], v4 offset:8192
    ds_read_b128 v[208:211], v4 offset:28672
    s_waitcnt lgkmcnt(8)
    v_mfma_f32_16x16x32_bf16 v[220:223], v[36:39], v[212:215], v[220:223]
    v_mfma_f32_16x16x32_bf16 v[228:231], v[116:119], v[212:215], v[228:231]
    v_mfma_f32_16x16x32_bf16 v[224:227], v[36:39], v[216:219], v[224:227]
    v_mfma_f32_16x16x32_bf16 v[232:235], v[116:119], v[216:219], v[232:235]
    ds_read_b128 v[212:215], v4 offset:9216
    ds_read_b128 v[216:219], v4 offset:29696
    s_waitcnt lgkmcnt(8)
    v_mfma_f32_16x16x32_bf16 v[220:223], v[40:43], v[180:183], v[220:223]
    v_mfma_f32_16x16x32_bf16 v[228:231], v[120:123], v[180:183], v[228:231]
    v_mfma_f32_16x16x32_bf16 v[224:227], v[40:43], v[184:187], v[224:227]
    v_mfma_f32_16x16x32_bf16 v[232:235], v[120:123], v[184:187], v[232:235]
    ds_read_b128 v[180:183], v4 offset:10240
    ds_read_b128 v[184:187], v4 offset:30720
    s_waitcnt lgkmcnt(8)
    v_mfma_f32_16x16x32_bf16 v[220:223], v[44:47], v[188:191], v[220:223]
    v_mfma_f32_16x16x32_bf16 v[228:231], v[124:127], v[188:191], v[228:231]
    v_mfma_f32_16x16x32_bf16 v[224:227], v[44:47], v[192:195], v[224:227]
    v_mfma_f32_16x16x32_bf16 v[232:235], v[124:127], v[192:195], v[232:235]
    ds_read_b128 v[188:191], v4 offset:11264
    ds_read_b128 v[192:195], v4 offset:31744
    s_waitcnt lgkmcnt(8)
    v_mfma_f32_16x16x32_bf16 v[220:223], v[48:51], v[196:199], v[220:223]
    v_mfma_f32_16x16x32_bf16 v[228:231], v[128:131], v[196:199], v[228:231]
    v_mfma_f32_16x16x32_bf16 v[224:227], v[48:51], v[200:203], v[224:227]
    v_mfma_f32_16x16x32_bf16 v[232:235], v[128:131], v[200:203], v[232:235]
    ds_read_b128 v[196:199], v4 offset:12288
    ds_read_b128 v[200:203], v4 offset:32768
    s_waitcnt lgkmcnt(8)
    v_mfma_f32_16x16x32_bf16 v[220:223], v[52:55], v[204:207], v[220:223]
    v_mfma_f32_16x16x32_bf16 v[228:231], v[132:135], v[204:207], v[228:231]
    v_mfma_f32_16x16x32_bf16 v[224:227], v[52:55], v[208:211], v[224:227]
    v_mfma_f32_16x16x32_bf16 v[232:235], v[132:135], v[208:211], v[232:235]
    ds_read_b128 v[204:207], v4 offset:13312
    ds_read_b128 v[208:211], v4 offset:33792
    s_waitcnt lgkmcnt(8)
    v_mfma_f32_16x16x32_bf16 v[220:223], v[56:59], v[212:215], v[220:223]
    v_mfma_f32_16x16x32_bf16 v[228:231], v[136:139], v[212:215], v[228:231]
    v_mfma_f32_16x16x32_bf16 v[224:227], v[56:59], v[216:219], v[224:227]
    v_mfma_f32_16x16x32_bf16 v[232:235], v[136:139], v[216:219], v[232:235]
    ds_read_b128 v[212:215], v4 offset:14336
    ds_read_b128 v[216:219], v4 offset:34816
    s_waitcnt lgkmcnt(8)
    v_mfma_f32_16x16x32_bf16 v[220:223], v[60:63], v[180:183], v[220:223]
    v_mfma_f32_16x16x32_bf16 v[228:231], v[140:143], v[180:183], v[228:231]
    v_mfma_f32_16x16x32_bf16 v[224:227], v[60:63], v[184:187], v[224:227]
    v_mfma_f32_16x16x32_bf16 v[232:235], v[140:143], v[184:187], v[232:235]
    ds_read_b128 v[180:183], v4 offset:15360
    ds_read_b128 v[184:187], v4 offset:35840
    s_waitcnt lgkmcnt(8)
    v_mfma_f32_16x16x32_bf16 v[220:223], v[64:67], v[188:191], v[220:223]
    v_mfma_f32_16x16x32_bf16 v[228:231], v[144:147], v[188:191], v[228:231]
    v_mfma_f32_16x16x32_bf16 v[224:227], v[64:67], v[192:195], v[224:227]
    v_mfma_f32_16x16x32_bf16 v[232:235], v[144:147], v[192:195], v[232:235]
    ds_read_b128 v[188:191], v4 offset:16384
    ds_read_b128 v[192:195], v4 offset:36864
    s_waitcnt lgkmcnt(8)
    v_mfma_f32_16x16x32_bf16 v[220:223], v[68:71], v[196:199], v[220:223]
    v_mfma_f32_16x16x32_bf16 v[228:231], v[148:151], v[196:199], v[228:231]
    v_mfma_f32_16x16x32_bf16 v[224:227], v[68:71], v[200:203], v[224:227]
    v_mfma_f32_16x16x32_bf16 v[232:235], v[148:151], v[200:203], v[232:235]
    ds_read_b128 v[196:199], v4 offset:17408
    ds_read_b128 v[200:203], v4 offset:37888
    s_waitcnt lgkmcnt(8)
    v_mfma_f32_16x16x32_bf16 v[220:223], v[72:75], v[204:207], v[220:223]
    v_mfma_f32_16x16x32_bf16 v[228:231], v[152:155], v[204:207], v[228:231]
    v_mfma_f32_16x16x32_bf16 v[224:227], v[72:75], v[208:211], v[224:227]
    v_mfma_f32_16x16x32_bf16 v[232:235], v[152:155], v[208:211], v[232:235]
    ds_read_b128 v[204:207], v4 offset:18432
    ds_read_b128 v[208:211], v4 offset:38912
    s_waitcnt lgkmcnt(8)
    v_mfma_f32_16x16x32_bf16 v[220:223], v[76:79], v[212:215], v[220:223]
    v_mfma_f32_16x16x32_bf16 v[228:231], v[156:159], v[212:215], v[228:231]
    v_mfma_f32_16x16x32_bf16 v[224:227], v[76:79], v[216:219], v[224:227]
    v_mfma_f32_16x16x32_bf16 v[232:235], v[156:159], v[216:219], v[232:235]
    ds_read_b128 v[212:215], v4 offset:19456
    ds_read_b128 v[216:219], v4 offset:39936
    s_waitcnt lgkmcnt(8)
    v_mfma_f32_16x16x32_bf16 v[220:223], v[80:83], v[180:183], v[220:223]
    v_mfma_f32_16x16x32_bf16 v[228:231], v[160:163], v[180:183], v[228:231]
    v_mfma_f32_16x16x32_bf16 v[224:227], v[80:83], v[184:187], v[224:227]
    v_mfma_f32_16x16x32_bf16 v[232:235], v[160:163], v[184:187], v[232:235]
    s_waitcnt lgkmcnt(6)
    v_mfma_f32_16x16x32_bf16 v[220:223], v[84:87], v[188:191], v[220:223]
    v_mfma_f32_16x16x32_bf16 v[228:231], v[164:167], v[188:191], v[228:231]
    v_mfma_f32_16x16x32_bf16 v[224:227], v[84:87], v[192:195], v[224:227]
    v_mfma_f32_16x16x32_bf16 v[232:235], v[164:167], v[192:195], v[232:235]
    s_waitcnt lgkmcnt(4)
    v_mfma_f32_16x16x32_bf16 v[220:223], v[88:91], v[196:199], v[220:223]
    v_mfma_f32_16x16x32_bf16 v[228:231], v[168:171], v[196:199], v[228:231]
    v_mfma_f32_16x16x32_bf16 v[224:227], v[88:91], v[200:203], v[224:227]
    v_mfma_f32_16x16x32_bf16 v[232:235], v[168:171], v[200:203], v[232:235]
    s_waitcnt lgkmcnt(2)
    v_mfma_f32_16x16x32_bf16 v[220:223], v[92:95], v[204:207], v[220:223]
    v_mfma_f32_16x16x32_bf16 v[228:231], v[172:175], v[204:207], v[228:231]
    v_mfma_f32_16x16x32_bf16 v[224:227], v[92:95], v[208:211], v[224:227]
    v_mfma_f32_16x16x32_bf16 v[232:235], v[172:175], v[208:211], v[232:235]
    s_waitcnt lgkmcnt(0)
    v_mfma_f32_16x16x32_bf16 v[220:223], v[96:99], v[212:215], v[220:223]
    v_mfma_f32_16x16x32_bf16 v[228:231], v[176:179], v[212:215], v[228:231]
    v_mfma_f32_16x16x32_bf16 v[224:227], v[96:99], v[216:219], v[224:227]
    v_mfma_f32_16x16x32_bf16 v[232:235], v[176:179], v[216:219], v[232:235]
    s_nop 7
    s_nop 1
    v_cvt_pk_bf16_f32 v220, v220, v221
    v_cvt_pk_bf16_f32 v221, v222, v223
    v_cvt_pk_bf16_f32 v224, v224, v225
    v_cvt_pk_bf16_f32 v225, v226, v227
    v_cvt_pk_bf16_f32 v228, v228, v229
    v_cvt_pk_bf16_f32 v229, v230, v231
    v_cvt_pk_bf16_f32 v232, v232, v233
    v_cvt_pk_bf16_f32 v233, v234, v235
    s_add_u32 s8, s44, 34996224
    s_add_u32 s9, s44, 35002368
    s_add_u32 s10, s44, 61210624
    s_add_u32 s11, s44, 61216768
    s_cmp_eq_u32 s92, 0
    s_cbranch_scc1 PB_15
    buffer_store_dwordx2 v[220:221], v15, s[32:35], s8 offen
    buffer_store_dwordx2 v[224:225], v15, s[32:35], s9 offen
    buffer_store_dwordx2 v[228:229], v15, s[32:35], s10 offen
    buffer_store_dwordx2 v[232:233], v15, s[32:35], s11 offen
    s_branch PB_16
PB_15:
    buffer_store_dwordx2 v[220:221], v15, s[32:35], s8 offen sc1
    buffer_store_dwordx2 v[224:225], v15, s[32:35], s9 offen sc1
    buffer_store_dwordx2 v[228:229], v15, s[32:35], s10 offen sc1
    buffer_store_dwordx2 v[232:233], v15, s[32:35], s11 offen sc1
PB_16:
    s_waitcnt vmcnt(15)
    s_barrier
    v_add_u32 v4, 102400, v15
    ds_read_b128 v[180:183], v4 offset:0
    ds_read_b128 v[184:187], v4 offset:20480
    ds_read_b128 v[188:191], v4 offset:1024
    ds_read_b128 v[192:195], v4 offset:21504
    ds_read_b128 v[196:199], v4 offset:2048
    ds_read_b128 v[200:203], v4 offset:22528
    ds_read_b128 v[204:207], v4 offset:3072
    ds_read_b128 v[208:211], v4 offset:23552
    ds_read_b128 v[212:215], v4 offset:4096
    ds_read_b128 v[216:219], v4 offset:24576
    s_waitcnt lgkmcnt(8)
    v_mfma_f32_16x16x32_bf16 v[220:223], v[20:23], v[180:183], 0
    v_mfma_f32_16x16x32_bf16 v[228:231], v[100:103], v[180:183], 0
    v_mfma_f32_16x16x32_bf16 v[224:227], v[20:23], v[184:187], 0
    v_mfma_f32_16x16x32_bf16 v[232:235], v[100:103], v[184:187], 0
    ds_read_b128 v[180:183], v4 offset:5120
    ds_read_b128 v[184:187], v4 offset:25600
    s_waitcnt lgkmcnt(8)
    v_mfma_f32_16x16x32_bf16 v[220:223], v[24:27], v[188:191], v[220:223]
    v_mfma_f32_16x16x32_bf16 v[228:231], v[104:107], v[188:191], v[228:231]
    v_mfma_f32_16x16x32_bf16 v[224:227], v[24:27], v[192:195], v[224:227]
    v_mfma_f32_16x16x32_bf16 v[232:235], v[104:107], v[192:195], v[232:235]
    ds_read_b128 v[188:191], v4 offset:6144
    ds_read_b128 v[192:195], v4 offset:26624
    s_waitcnt lgkmcnt(8)
    v_mfma_f32_16x16x32_bf16 v[220:223], v[28:31], v[196:199], v[220:223]
    v_mfma_f32_16x16x32_bf16 v[228:231], v[108:111], v[196:199], v[228:231]
    v_mfma_f32_16x16x32_bf16 v[224:227], v[28:31], v[200:203], v[224:227]
    v_mfma_f32_16x16x32_bf16 v[232:235], v[108:111], v[200:203], v[232:235]
    ds_read_b128 v[196:199], v4 offset:7168
    ds_read_b128 v[200:203], v4 offset:27648
    s_waitcnt lgkmcnt(8)
    v_mfma_f32_16x16x32_bf16 v[220:223], v[32:35], v[204:207], v[220:223]
    v_mfma_f32_16x16x32_bf16 v[228:231], v[112:115], v[204:207], v[228:231]
    v_mfma_f32_16x16x32_bf16 v[224:227], v[32:35], v[208:211], v[224:227]
    v_mfma_f32_16x16x32_bf16 v[232:235], v[112:115], v[208:211], v[232:235]
    ds_read_b128 v[204:207], v4 offset:8192
    ds_read_b128 v[208:211], v4 offset:28672
    s_waitcnt lgkmcnt(8)
    v_mfma_f32_16x16x32_bf16 v[220:223], v[36:39], v[212:215], v[220:223]
    v_mfma_f32_16x16x32_bf16 v[228:231], v[116:119], v[212:215], v[228:231]
    v_mfma_f32_16x16x32_bf16 v[224:227], v[36:39], v[216:219], v[224:227]
    v_mfma_f32_16x16x32_bf16 v[232:235], v[116:119], v[216:219], v[232:235]
    ds_read_b128 v[212:215], v4 offset:9216
    ds_read_b128 v[216:219], v4 offset:29696
    s_waitcnt lgkmcnt(8)
    v_mfma_f32_16x16x32_bf16 v[220:223], v[40:43], v[180:183], v[220:223]
    v_mfma_f32_16x16x32_bf16 v[228:231], v[120:123], v[180:183], v[228:231]
    v_mfma_f32_16x16x32_bf16 v[224:227], v[40:43], v[184:187], v[224:227]
    v_mfma_f32_16x16x32_bf16 v[232:235], v[120:123], v[184:187], v[232:235]
    ds_read_b128 v[180:183], v4 offset:10240
    ds_read_b128 v[184:187], v4 offset:30720
    s_waitcnt lgkmcnt(8)
    v_mfma_f32_16x16x32_bf16 v[220:223], v[44:47], v[188:191], v[220:223]
    v_mfma_f32_16x16x32_bf16 v[228:231], v[124:127], v[188:191], v[228:231]
    v_mfma_f32_16x16x32_bf16 v[224:227], v[44:47], v[192:195], v[224:227]
    v_mfma_f32_16x16x32_bf16 v[232:235], v[124:127], v[192:195], v[232:235]
    ds_read_b128 v[188:191], v4 offset:11264
    ds_read_b128 v[192:195], v4 offset:31744
    s_waitcnt lgkmcnt(8)
    v_mfma_f32_16x16x32_bf16 v[220:223], v[48:51], v[196:199], v[220:223]
    v_mfma_f32_16x16x32_bf16 v[228:231], v[128:131], v[196:199], v[228:231]
    v_mfma_f32_16x16x32_bf16 v[224:227], v[48:51], v[200:203], v[224:227]
    v_mfma_f32_16x16x32_bf16 v[232:235], v[128:131], v[200:203], v[232:235]
    ds_read_b128 v[196:199], v4 offset:12288
    ds_read_b128 v[200:203], v4 offset:32768
    s_waitcnt lgkmcnt(8)
    v_mfma_f32_16x16x32_bf16 v[220:223], v[52:55], v[204:207], v[220:223]
    v_mfma_f32_16x16x32_bf16 v[228:231], v[132:135], v[204:207], v[228:231]
    v_mfma_f32_16x16x32_bf16 v[224:227], v[52:55], v[208:211], v[224:227]
    v_mfma_f32_16x16x32_bf16 v[232:235], v[132:135], v[208:211], v[232:235]
    ds_read_b128 v[204:207], v4 offset:13312
    ds_read_b128 v[208:211], v4 offset:33792
    s_waitcnt lgkmcnt(8)
    v_mfma_f32_16x16x32_bf16 v[220:223], v[56:59], v[212:215], v[220:223]
    v_mfma_f32_16x16x32_bf16 v[228:231], v[136:139], v[212:215], v[228:231]
    v_mfma_f32_16x16x32_bf16 v[224:227], v[56:59], v[216:219], v[224:227]
    v_mfma_f32_16x16x32_bf16 v[232:235], v[136:139], v[216:219], v[232:235]
    ds_read_b128 v[212:215], v4 offset:14336
    ds_read_b128 v[216:219], v4 offset:34816
    s_waitcnt lgkmcnt(8)
    v_mfma_f32_16x16x32_bf16 v[220:223], v[60:63], v[180:183], v[220:223]
    v_mfma_f32_16x16x32_bf16 v[228:231], v[140:143], v[180:183], v[228:231]
    v_mfma_f32_16x16x32_bf16 v[224:227], v[60:63], v[184:187], v[224:227]
    v_mfma_f32_16x16x32_bf16 v[232:235], v[140:143], v[184:187], v[232:235]
    ds_read_b128 v[180:183], v4 offset:15360
    ds_read_b128 v[184:187], v4 offset:35840
    s_waitcnt lgkmcnt(8)
    v_mfma_f32_16x16x32_bf16 v[220:223], v[64:67], v[188:191], v[220:223]
    v_mfma_f32_16x16x32_bf16 v[228:231], v[144:147], v[188:191], v[228:231]
    v_mfma_f32_16x16x32_bf16 v[224:227], v[64:67], v[192:195], v[224:227]
    v_mfma_f32_16x16x32_bf16 v[232:235], v[144:147], v[192:195], v[232:235]
    ds_read_b128 v[188:191], v4 offset:16384
    ds_read_b128 v[192:195], v4 offset:36864
    s_waitcnt lgkmcnt(8)
    v_mfma_f32_16x16x32_bf16 v[220:223], v[68:71], v[196:199], v[220:223]
    v_mfma_f32_16x16x32_bf16 v[228:231], v[148:151], v[196:199], v[228:231]
    v_mfma_f32_16x16x32_bf16 v[224:227], v[68:71], v[200:203], v[224:227]
    v_mfma_f32_16x16x32_bf16 v[232:235], v[148:151], v[200:203], v[232:235]
    ds_read_b128 v[196:199], v4 offset:17408
    ds_read_b128 v[200:203], v4 offset:37888
    s_waitcnt lgkmcnt(8)
    v_mfma_f32_16x16x32_bf16 v[220:223], v[72:75], v[204:207], v[220:223]
    v_mfma_f32_16x16x32_bf16 v[228:231], v[152:155], v[204:207], v[228:231]
    v_mfma_f32_16x16x32_bf16 v[224:227], v[72:75], v[208:211], v[224:227]
    v_mfma_f32_16x16x32_bf16 v[232:235], v[152:155], v[208:211], v[232:235]
    ds_read_b128 v[204:207], v4 offset:18432
    ds_read_b128 v[208:211], v4 offset:38912
    s_waitcnt lgkmcnt(8)
    v_mfma_f32_16x16x32_bf16 v[220:223], v[76:79], v[212:215], v[220:223]
    v_mfma_f32_16x16x32_bf16 v[228:231], v[156:159], v[212:215], v[228:231]
    v_mfma_f32_16x16x32_bf16 v[224:227], v[76:79], v[216:219], v[224:227]
    v_mfma_f32_16x16x32_bf16 v[232:235], v[156:159], v[216:219], v[232:235]
    ds_read_b128 v[212:215], v4 offset:19456
    ds_read_b128 v[216:219], v4 offset:39936
    s_waitcnt lgkmcnt(8)
    v_mfma_f32_16x16x32_bf16 v[220:223], v[80:83], v[180:183], v[220:223]
    v_mfma_f32_16x16x32_bf16 v[228:231], v[160:163], v[180:183], v[228:231]
    v_mfma_f32_16x16x32_bf16 v[224:227], v[80:83], v[184:187], v[224:227]
    v_mfma_f32_16x16x32_bf16 v[232:235], v[160:163], v[184:187], v[232:235]
    s_waitcnt lgkmcnt(6)
    v_mfma_f32_16x16x32_bf16 v[220:223], v[84:87], v[188:191], v[220:223]
    v_mfma_f32_16x16x32_bf16 v[228:231], v[164:167], v[188:191], v[228:231]
    v_mfma_f32_16x16x32_bf16 v[224:227], v[84:87], v[192:195], v[224:227]
    v_mfma_f32_16x16x32_bf16 v[232:235], v[164:167], v[192:195], v[232:235]
    s_waitcnt lgkmcnt(4)
    v_mfma_f32_16x16x32_bf16 v[220:223], v[88:91], v[196:199], v[220:223]
    v_mfma_f32_16x16x32_bf16 v[228:231], v[168:171], v[196:199], v[228:231]
    v_mfma_f32_16x16x32_bf16 v[224:227], v[88:91], v[200:203], v[224:227]
    v_mfma_f32_16x16x32_bf16 v[232:235], v[168:171], v[200:203], v[232:235]
    s_waitcnt lgkmcnt(2)
    v_mfma_f32_16x16x32_bf16 v[220:223], v[92:95], v[204:207], v[220:223]
    v_mfma_f32_16x16x32_bf16 v[228:231], v[172:175], v[204:207], v[228:231]
    v_mfma_f32_16x16x32_bf16 v[224:227], v[92:95], v[208:211], v[224:227]
    v_mfma_f32_16x16x32_bf16 v[232:235], v[172:175], v[208:211], v[232:235]
    s_waitcnt lgkmcnt(0)
    v_mfma_f32_16x16x32_bf16 v[220:223], v[96:99], v[212:215], v[220:223]
    v_mfma_f32_16x16x32_bf16 v[228:231], v[176:179], v[212:215], v[228:231]
    v_mfma_f32_16x16x32_bf16 v[224:227], v[96:99], v[216:219], v[224:227]
    v_mfma_f32_16x16x32_bf16 v[232:235], v[176:179], v[216:219], v[232:235]
    s_nop 7
    s_nop 1
    v_cvt_pk_bf16_f32 v220, v220, v221
    v_cvt_pk_bf16_f32 v221, v222, v223
    v_cvt_pk_bf16_f32 v224, v224, v225
    v_cvt_pk_bf16_f32 v225, v226, v227
    v_cvt_pk_bf16_f32 v228, v228, v229
    v_cvt_pk_bf16_f32 v229, v230, v231
    v_cvt_pk_bf16_f32 v232, v232, v233
    v_cvt_pk_bf16_f32 v233, v234, v235
    s_add_u32 s8, s44, 35389440
    s_add_u32 s9, s44, 35395584
    s_add_u32 s10, s44, 61603840
    s_add_u32 s11, s44, 61609984
    s_cmp_eq_u32 s92, 0
    s_cbranch_scc1 PB_17
    buffer_store_dwordx2 v[220:221], v15, s[32:35], s8 offen
    buffer_store_dwordx2 v[224:225], v15, s[32:35], s9 offen
    buffer_store_dwordx2 v[228:229], v15, s[32:35], s10 offen
    buffer_store_dwordx2 v[232:233], v15, s[32:35], s11 offen
    s_branch PB_18
PB_17:
    buffer_store_dwordx2 v[220:221], v15, s[32:35], s8 offen sc1
    buffer_store_dwordx2 v[224:225], v15, s[32:35], s9 offen sc1
    buffer_store_dwordx2 v[228:229], v15, s[32:35], s10 offen sc1
    buffer_store_dwordx2 v[232:233], v15, s[32:35], s11 offen sc1
PB_18:
    s_waitcnt vmcnt(8)
    s_barrier
    v_add_u32 v4, 20480, v15
    ds_read_b128 v[180:183], v4 offset:0
    ds_read_b128 v[184:187], v4 offset:20480
    ds_read_b128 v[188:191], v4 offset:1024
    ds_read_b128 v[192:195], v4 offset:21504
    ds_read_b128 v[196:199], v4 offset:2048
    ds_read_b128 v[200:203], v4 offset:22528
    ds_read_b128 v[204:207], v4 offset:3072
    ds_read_b128 v[208:211], v4 offset:23552
    ds_read_b128 v[212:215], v4 offset:4096
    ds_read_b128 v[216:219], v4 offset:24576
    s_waitcnt lgkmcnt(8)
    v_mfma_f32_16x16x32_bf16 v[220:223], v[20:23], v[180:183], 0
    v_mfma_f32_16x16x32_bf16 v[228:231], v[100:103], v[180:183], 0
    v_mfma_f32_16x16x32_bf16 v[224:227], v[20:23], v[184:187], 0
    v_mfma_f32_16x16x32_bf16 v[232:235], v[100:103], v[184:187], 0
    ds_read_b128 v[180:183], v4 offset:5120
    ds_read_b128 v[184:187], v4 offset:25600
    s_waitcnt lgkmcnt(8)
    v_mfma_f32_16x16x32_bf16 v[220:223], v[24:27], v[188:191], v[220:223]
    v_mfma_f32_16x16x32_bf16 v[228:231], v[104:107], v[188:191], v[228:231]
    v_mfma_f32_16x16x32_bf16 v[224:227], v[24:27], v[192:195], v[224:227]
    v_mfma_f32_16x16x32_bf16 v[232:235], v[104:107], v[192:195], v[232:235]
    ds_read_b128 v[188:191], v4 offset:6144
    ds_read_b128 v[192:195], v4 offset:26624
    s_waitcnt lgkmcnt(8)
    v_mfma_f32_16x16x32_bf16 v[220:223], v[28:31], v[196:199], v[220:223]
    v_mfma_f32_16x16x32_bf16 v[228:231], v[108:111], v[196:199], v[228:231]
    v_mfma_f32_16x16x32_bf16 v[224:227], v[28:31], v[200:203], v[224:227]
    v_mfma_f32_16x16x32_bf16 v[232:235], v[108:111], v[200:203], v[232:235]
    ds_read_b128 v[196:199], v4 offset:7168
    ds_read_b128 v[200:203], v4 offset:27648
    s_waitcnt lgkmcnt(8)
    v_mfma_f32_16x16x32_bf16 v[220:223], v[32:35], v[204:207], v[220:223]
    v_mfma_f32_16x16x32_bf16 v[228:231], v[112:115], v[204:207], v[228:231]
    v_mfma_f32_16x16x32_bf16 v[224:227], v[32:35], v[208:211], v[224:227]
    v_mfma_f32_16x16x32_bf16 v[232:235], v[112:115], v[208:211], v[232:235]
    ds_read_b128 v[204:207], v4 offset:8192
    ds_read_b128 v[208:211], v4 offset:28672
    s_waitcnt lgkmcnt(8)
    v_mfma_f32_16x16x32_bf16 v[220:223], v[36:39], v[212:215], v[220:223]
    v_mfma_f32_16x16x32_bf16 v[228:231], v[116:119], v[212:215], v[228:231]
    v_mfma_f32_16x16x32_bf16 v[224:227], v[36:39], v[216:219], v[224:227]
    v_mfma_f32_16x16x32_bf16 v[232:235], v[116:119], v[216:219], v[232:235]
    ds_read_b128 v[212:215], v4 offset:9216
    ds_read_b128 v[216:219], v4 offset:29696
    s_waitcnt lgkmcnt(8)
    v_mfma_f32_16x16x32_bf16 v[220:223], v[40:43], v[180:183], v[220:223]
    v_mfma_f32_16x16x32_bf16 v[228:231], v[120:123], v[180:183], v[228:231]
    v_mfma_f32_16x16x32_bf16 v[224:227], v[40:43], v[184:187], v[224:227]
    v_mfma_f32_16x16x32_bf16 v[232:235], v[120:123], v[184:187], v[232:235]
    ds_read_b128 v[180:183], v4 offset:10240
    ds_read_b128 v[184:187], v4 offset:30720
    s_waitcnt lgkmcnt(8)
    v_mfma_f32_16x16x32_bf16 v[220:223], v[44:47], v[188:191], v[220:223]
    v_mfma_f32_16x16x32_bf16 v[228:231], v[124:127], v[188:191], v[228:231]
    v_mfma_f32_16x16x32_bf16 v[224:227], v[44:47], v[192:195], v[224:227]
    v_mfma_f32_16x16x32_bf16 v[232:235], v[124:127], v[192:195], v[232:235]
    ds_read_b128 v[188:191], v4 offset:11264
    ds_read_b128 v[192:195], v4 offset:31744
    s_waitcnt lgkmcnt(8)
    v_mfma_f32_16x16x32_bf16 v[220:223], v[48:51], v[196:199], v[220:223]
    v_mfma_f32_16x16x32_bf16 v[228:231], v[128:131], v[196:199], v[228:231]
    v_mfma_f32_16x16x32_bf16 v[224:227], v[48:51], v[200:203], v[224:227]
    v_mfma_f32_16x16x32_bf16 v[232:235], v[128:131], v[200:203], v[232:235]
    ds_read_b128 v[196:199], v4 offset:12288
    ds_read_b128 v[200:203], v4 offset:32768
    s_waitcnt lgkmcnt(8)
    v_mfma_f32_16x16x32_bf16 v[220:223], v[52:55], v[204:207], v[220:223]
    v_mfma_f32_16x16x32_bf16 v[228:231], v[132:135], v[204:207], v[228:231]
    v_mfma_f32_16x16x32_bf16 v[224:227], v[52:55], v[208:211], v[224:227]
    v_mfma_f32_16x16x32_bf16 v[232:235], v[132:135], v[208:211], v[232:235]
    ds_read_b128 v[204:207], v4 offset:13312
    ds_read_b128 v[208:211], v4 offset:33792
    s_waitcnt lgkmcnt(8)
    v_mfma_f32_16x16x32_bf16 v[220:223], v[56:59], v[212:215], v[220:223]
    v_mfma_f32_16x16x32_bf16 v[228:231], v[136:139], v[212:215], v[228:231]
    v_mfma_f32_16x16x32_bf16 v[224:227], v[56:59], v[216:219], v[224:227]
    v_mfma_f32_16x16x32_bf16 v[232:235], v[136:139], v[216:219], v[232:235]
    ds_read_b128 v[212:215], v4 offset:14336
    ds_read_b128 v[216:219], v4 offset:34816
    s_waitcnt lgkmcnt(8)
    v_mfma_f32_16x16x32_bf16 v[220:223], v[60:63], v[180:183], v[220:223]
    v_mfma_f32_16x16x32_bf16 v[228:231], v[140:143], v[180:183], v[228:231]
    v_mfma_f32_16x16x32_bf16 v[224:227], v[60:63], v[184:187], v[224:227]
    v_mfma_f32_16x16x32_bf16 v[232:235], v[140:143], v[184:187], v[232:235]
    ds_read_b128 v[180:183], v4 offset:15360
    ds_read_b128 v[184:187], v4 offset:35840
    s_waitcnt lgkmcnt(8)
    v_mfma_f32_16x16x32_bf16 v[220:223], v[64:67], v[188:191], v[220:223]
    v_mfma_f32_16x16x32_bf16 v[228:231], v[144:147], v[188:191], v[228:231]
    v_mfma_f32_16x16x32_bf16 v[224:227], v[64:67], v[192:195], v[224:227]
    v_mfma_f32_16x16x32_bf16 v[232:235], v[144:147], v[192:195], v[232:235]
    ds_read_b128 v[188:191], v4 offset:16384
    ds_read_b128 v[192:195], v4 offset:36864
    s_waitcnt lgkmcnt(8)
    v_mfma_f32_16x16x32_bf16 v[220:223], v[68:71], v[196:199], v[220:223]
    v_mfma_f32_16x16x32_bf16 v[228:231], v[148:151], v[196:199], v[228:231]
    v_mfma_f32_16x16x32_bf16 v[224:227], v[68:71], v[200:203], v[224:227]
    v_mfma_f32_16x16x32_bf16 v[232:235], v[148:151], v[200:203], v[232:235]
    ds_read_b128 v[196:199], v4 offset:17408
    ds_read_b128 v[200:203], v4 offset:37888
    s_waitcnt lgkmcnt(8)
    v_mfma_f32_16x16x32_bf16 v[220:223], v[72:75], v[204:207], v[220:223]
    v_mfma_f32_16x16x32_bf16 v[228:231], v[152:155], v[204:207], v[228:231]
    v_mfma_f32_16x16x32_bf16 v[224:227], v[72:75], v[208:211], v[224:227]
    v_mfma_f32_16x16x32_bf16 v[232:235], v[152:155], v[208:211], v[232:235]
    ds_read_b128 v[204:207], v4 offset:18432
    ds_read_b128 v[208:211], v4 offset:38912
    s_waitcnt lgkmcnt(8)
    v_mfma_f32_16x16x32_bf16 v[220:223], v[76:79], v[212:215], v[220:223]
    v_mfma_f32_16x16x32_bf16 v[228:231], v[156:159], v[212:215], v[228:231]
    v_mfma_f32_16x16x32_bf16 v[224:227], v[76:79], v[216:219], v[224:227]
    v_mfma_f32_16x16x32_bf16 v[232:235], v[156:159], v[216:219], v[232:235]
    ds_read_b128 v[212:215], v4 offset:19456
    ds_read_b128 v[216:219], v4 offset:39936
    s_waitcnt lgkmcnt(8)
    v_mfma_f32_16x16x32_bf16 v[220:223], v[80:83], v[180:183], v[220:223]
    v_mfma_f32_16x16x32_bf16 v[228:231], v[160:163], v[180:183], v[228:231]
    v_mfma_f32_16x16x32_bf16 v[224:227], v[80:83], v[184:187], v[224:227]
    v_mfma_f32_16x16x32_bf16 v[232:235], v[160:163], v[184:187], v[232:235]
    s_waitcnt lgkmcnt(6)
    v_mfma_f32_16x16x32_bf16 v[220:223], v[84:87], v[188:191], v[220:223]
    v_mfma_f32_16x16x32_bf16 v[228:231], v[164:167], v[188:191], v[228:231]
    v_mfma_f32_16x16x32_bf16 v[224:227], v[84:87], v[192:195], v[224:227]
    v_mfma_f32_16x16x32_bf16 v[232:235], v[164:167], v[192:195], v[232:235]
    s_waitcnt lgkmcnt(4)
    v_mfma_f32_16x16x32_bf16 v[220:223], v[88:91], v[196:199], v[220:223]
    v_mfma_f32_16x16x32_bf16 v[228:231], v[168:171], v[196:199], v[228:231]
    v_mfma_f32_16x16x32_bf16 v[224:227], v[88:91], v[200:203], v[224:227]
    v_mfma_f32_16x16x32_bf16 v[232:235], v[168:171], v[200:203], v[232:235]
    s_waitcnt lgkmcnt(2)
    v_mfma_f32_16x16x32_bf16 v[220:223], v[92:95], v[204:207], v[220:223]
    v_mfma_f32_16x16x32_bf16 v[228:231], v[172:175], v[204:207], v[228:231]
    v_mfma_f32_16x16x32_bf16 v[224:227], v[92:95], v[208:211], v[224:227]
    v_mfma_f32_16x16x32_bf16 v[232:235], v[172:175], v[208:211], v[232:235]
    s_waitcnt lgkmcnt(0)
    v_mfma_f32_16x16x32_bf16 v[220:223], v[96:99], v[212:215], v[220:223]
    v_mfma_f32_16x16x32_bf16 v[228:231], v[176:179], v[212:215], v[228:231]
    v_mfma_f32_16x16x32_bf16 v[224:227], v[96:99], v[216:219], v[224:227]
    v_mfma_f32_16x16x32_bf16 v[232:235], v[176:179], v[216:219], v[232:235]
    s_nop 7
    s_nop 1
    v_cvt_pk_bf16_f32 v220, v220, v221
    v_cvt_pk_bf16_f32 v221, v222, v223
    v_cvt_pk_bf16_f32 v224, v224, v225
    v_cvt_pk_bf16_f32 v225, v226, v227
    v_cvt_pk_bf16_f32 v228, v228, v229
    v_cvt_pk_bf16_f32 v229, v230, v231
    v_cvt_pk_bf16_f32 v232, v232, v233
    v_cvt_pk_bf16_f32 v233, v234, v235
    s_add_u32 s8, s44, 35782656
    s_add_u32 s9, s44, 35788800
    s_add_u32 s10, s44, 61997056
    s_add_u32 s11, s44, 62003200
    s_cmp_eq_u32 s92, 0
    s_cbranch_scc1 PB_19
    buffer_store_dwordx2 v[220:221], v15, s[32:35], s8 offen
    buffer_store_dwordx2 v[224:225], v15, s[32:35], s9 offen
    buffer_store_dwordx2 v[228:229], v15, s[32:35], s10 offen
    buffer_store_dwordx2 v[232:233], v15, s[32:35], s11 offen
    s_branch PB_20
PB_19:
    buffer_store_dwordx2 v[220:221], v15, s[32:35], s8 offen sc1
    buffer_store_dwordx2 v[224:225], v15, s[32:35], s9 offen sc1
    buffer_store_dwordx2 v[228:229], v15, s[32:35], s10 offen sc1
    buffer_store_dwordx2 v[232:233], v15, s[32:35], s11 offen sc1
PB_20:
    s_branch C4_ST_E
C4_ST_N:
    s_barrier
    s_barrier
    s_barrier
    s_barrier
C4_ST_E:
    s_waitcnt vmcnt(0)
    s_barrier
    s_cmp_lg_u32 s40, 0
    s_cbranch_scc1 C4_ST_X
    s_lshl_b32 s42, s54, 7
    s_add_u32 s42, s42, 118784
    v_mov_b32 v4, 3
    v_mov_b32 v5, 0
    s_mov_b64 exec, 1
    s_cmp_eq_u32 s92, 0
    s_cbranch_scc1 PB_21
    buffer_atomic_add v4, v5, s[32:35], s42 offen offset:0
    s_branch PB_22
PB_21:
    buffer_atomic_add v4, v5, s[32:35], s42 offen offset:0 sc1
PB_22:
    s_mov_b64 exec, -1
C4_ST_X:
    s_cmp_eq_u32 s40, 4
    s_cbranch_scc1 C4_WOW
    s_cmp_lg_u32 s40, 5
    s_cbranch_scc1 C4_WOW2
C4_WOW:
    s_sub_u32 s42, s40, 4
    s_mul_i32 s42, s42, 30720
    s_add_u32 s42, s42, 20480
    v_add_u32 v5, s42, v15
    s_waitcnt vmcnt(0)
    ds_write_b128 v5, v[100:103] offset:0
    ds_write_b128 v5, v[104:107] offset:1024
    ds_write_b128 v5, v[108:111] offset:2048
    ds_write_b128 v5, v[112:115] offset:3072
    ds_write_b128 v5, v[116:119] offset:4096
    ds_write_b128 v5, v[120:123] offset:5120
    ds_write_b128 v5, v[124:127] offset:6144
    ds_write_b128 v5, v[128:131] offset:7168
    ds_write_b128 v5, v[132:135] offset:8192
    ds_write_b128 v5, v[136:139] offset:9216
    ds_write_b128 v5, v[140:143] offset:10240
    ds_write_b128 v5, v[144:147] offset:11264
    ds_write_b128 v5, v[148:151] offset:12288
    ds_write_b128 v5, v[152:155] offset:13312
    ds_write_b128 v5, v[156:159] offset:14336
    ds_write_b128 v5, v[160:163] offset:15360
    ds_write_b128 v5, v[164:167] offset:16384
    ds_write_b128 v5, v[168:171] offset:17408
    ds_write_b128 v5, v[172:175] offset:18432
    ds_write_b128 v5, v[176:179] offset:19456
    ds_write_b128 v5, v[180:183] offset:20480
    ds_write_b128 v5, v[184:187] offset:21504
    ds_write_b128 v5, v[188:191] offset:22528
    ds_write_b128 v5, v[192:195] offset:23552
    ds_write_b128 v5, v[196:199] offset:24576
    ds_write_b128 v5, v[200:203] offset:25600
    ds_write_b128 v5, v[204:207] offset:26624
    ds_write_b128 v5, v[208:211] offset:27648
    ds_write_b128 v5, v[212:215] offset:28672
    ds_write_b128 v5, v[216:219] offset:29696
C4_WOW2:
    s_waitcnt lgkmcnt(0)
    s_barrier
    s_cmp_lt_u32 s40, 3
    s_cbranch_scc1 C4_NOZW
    v_lshrrev_b32 v5, 2, v2
    v_lshl_add_u32 v5, v3, 2, v5
    v_mul_u32_u24 v5, 160, v5
    v_and_b32 v6, 3, v2
    v_lshl_add_u32 v5, v6, 3, v5
    s_lshl_b32 s42, s74, 5
    s_add_u32 s42, s42, 20480
    v_add_u32 v5, s42, v5
    ds_read_b64_tr_b16 v[16:17], v5 offset:0
    ds_read_b64_tr_b16 v[18:19], v5 offset:2560
    ds_read_b64_tr_b16 v[20:21], v5 offset:7680
    ds_read_b64_tr_b16 v[22:23], v5 offset:10240
    ds_read_b64_tr_b16 v[24:25], v5 offset:15360
    ds_read_b64_tr_b16 v[26:27], v5 offset:17920
    ds_read_b64_tr_b16 v[28:29], v5 offset:23040
    ds_read_b64_tr_b16 v[30:31], v5 offset:25600
    ds_read_b64_tr_b16 v[32:33], v5 offset:5120
    ds_read_b64_tr_b16 v[34:35], v5 offset:12800
    ds_read_b64_tr_b16 v[36:37], v5 offset:20480
    ds_read_b64_tr_b16 v[38:39], v5 offset:28160
    s_waitcnt lgkmcnt(0)
    ds_read_b64_tr_b16 v[40:41], v5 offset:30720
    ds_read_b64_tr_b16 v[42:43], v5 offset:33280
    ds_read_b64_tr_b16 v[44:45], v5 offset:38400
    ds_read_b64_tr_b16 v[46:47], v5 offset:40960
    ds_read_b64_tr_b16 v[48:49], v5 offset:46080
    ds_read_b64_tr_b16 v[50:51], v5 offset:48640
    ds_read_b64_tr_b16 v[52:53], v5 offset:53760
    ds_read_b64_tr_b16 v[54:55], v5 offset:56320
    ds_read_b64_tr_b16 v[56:57], v5 offset:35840
    ds_read_b64_tr_b16 v[58:59], v5 offset:43520
    ds_read_b64_tr_b16 v[60:61], v5 offset:51200
    ds_read_b64_tr_b16 v[62:63], v5 offset:58880
    s_waitcnt lgkmcnt(0)
C4_NOZW:
    s_waitcnt lgkmcnt(0)
    s_barrier
    v_mov_b32 v11, 155648
    ds_read_b32 v11, v11 offset:36
    s_waitcnt lgkmcnt(0)
    v_readfirstlane_b32 s101, v11
    s_cmp_eq_u32 s101, 2
    s_cselect_b32 s101, 8192, 0
    v_mov_b32 v11, 0
    v_cmp_gt_u32 vcc, 8, v2
    s_mov_b64 s[64:65], vcc
    s_mov_b32 s66, -1
    s_mov_b32 s67, 0
    s_mov_b32 s98, 0
    s_mov_b32 s99, -1
    ds_write_b32 v11, v11 offset:8
    ds_write_b32 v11, v11 offset:12
    ds_write_b32 v11, v11 offset:16
    ds_write_b32 v11, v11 offset:20
    ds_write_b32 v11, v11 offset:32
    ds_write_b32 v11, v11 offset:40
    ds_write_b32 v11, v11 offset:44
    v_mov_b32 v4, 0
    v_mov_b32 v5, 0
    v_mov_b32 v6, 0
    v_mov_b32 v7, 0
    v_lshlrev_b32 v8, 4, v0
    v_add_u32 v8, 143360, v8
    s_cmp_ge_u32 s40, 6
    s_cbranch_scc1 C4_NOZX
    ds_write_b128 v8, v[4:7]
    ds_write_b128 v8, v[4:7] offset:6144
C4_NOZX:
    v_lshlrev_b32 v6, 4, v0
    s_waitcnt vmcnt(0)
    ds_write_b128 v6, v[240:243] offset:4096
    s_cmp_ge_u32 s40, 2
    s_cbranch_scc1 C4_M0S
    ds_write_b128 v6, v[244:247] offset:12288
C4_M0S:
    v_mov_b32 v11, 0
    s_lshr_b32 s68, s54, 1
    s_mul_i32 s68, s68, 40960
    s_add_u32 s68, s68, 20971520
    s_mul_i32 s42, s58, 24576
    s_add_u32 s70, s42, 60817408
    s_add_u32 s71, s42, 87031808
    s_add_u32 s16, s42, 34603008
    s_sub_u32 s46, s40, 4
    s_mul_i32 s46, s46, 6144
    s_lshl_b32 s77, s54, 7
    s_add_u32 s77, s77, 118784
    s_lshl_b32 s50, s54, 4
    s_add_u32 s50, s50, s55
    s_lshl_b32 s50, s50, 7
    s_add_u32 s50, s50, 136192
    v_mov_b32 v255, 1
    s_cmp_lt_u32 s40, 4
    s_cbranch_scc1 C4_NOPD
    buffer_load_dword v254, v11, s[32:35], s77 offen sc1
C4_T1W0:
    s_waitcnt vmcnt(0)
    v_readfirstlane_b32 s42, v254
    s_cmp_ge_u32 s42, 48
    s_cbranch_scc1 C4_T1W0_OK
    s_add_u32 s88, s88, 1
    s_cmp_ge_u32 s88, 0x40000
    s_cbranch_scc1 C4_T1W0_OK
    s_sleep 1
    buffer_load_dword v254, v11, s[32:35], s77 offen sc1
    s_branch C4_T1W0
C4_T1W0_OK:
    s_mov_b32 s45, 20480
    s_add_u32 s43, s70, s46
    s_add_u32 s47, s45, s46
    s_add_u32 m0, s47, 0
    s_nop 0
    buffer_load_dwordx4 v15, s[32:35], s43 offen lds
    s_add_u32 m0, s47, 1024
    s_add_u32 s43, s43, 1024
    buffer_load_dwordx4 v15, s[32:35], s43 offen lds
    s_add_u32 m0, s47, 2048
    s_add_u32 s43, s43, 1024
    buffer_load_dwordx4 v15, s[32:35], s43 offen lds
    s_add_u32 m0, s47, 3072
    s_add_u32 s43, s43, 1024
    buffer_load_dwordx4 v15, s[32:35], s43 offen lds
    s_add_u32 m0, s47, 4096
    s_add_u32 s43, s43, 1024
    buffer_load_dwordx4 v15, s[32:35], s43 offen lds
    s_add_u32 m0, s47, 5120
    s_add_u32 s43, s43, 1024
    buffer_load_dwordx4 v15, s[32:35], s43 offen lds
    s_mov_b32 s45, 69632
    s_add_u32 s43, s71, s46
    s_add_u32 s47, s45, s46
    s_add_u32 m0, s47, 0
    s_nop 0
    buffer_load_dwordx4 v15, s[32:35], s43 offen lds
    s_add_u32 m0, s47, 1024
    s_add_u32 s43, s43, 1024
    buffer_load_dwordx4 v15, s[32:35], s43 offen lds
    s_add_u32 m0, s47, 2048
    s_add_u32 s43, s43, 1024
    buffer_load_dwordx4 v15, s[32:35], s43 offen lds
    s_add_u32 m0, s47, 3072
    s_add_u32 s43, s43, 1024
    buffer_load_dwordx4 v15, s[32:35], s43 offen lds
    s_add_u32 m0, s47, 4096
    s_add_u32 s43, s43, 1024
    buffer_load_dwordx4 v15, s[32:35], s43 offen lds
    s_add_u32 m0, s47, 5120
    s_add_u32 s43, s43, 1024
    buffer_load_dwordx4 v15, s[32:35], s43 offen lds
    s_lshr_b32 s42, s57, 1
    s_sub_u32 s43, s40, 4
    s_cmp_lg_u32 s42, s43
    s_cbranch_scc1 C4_NOQ0
    s_mov_b32 s45, 118784
    s_add_u32 s43, s16, s46
    s_add_u32 s47, s45, s46
    s_add_u32 m0, s47, 0
    s_nop 0
    buffer_load_dwordx4 v15, s[32:35], s43 offen lds
    s_add_u32 m0, s47, 1024
    s_add_u32 s43, s43, 1024
    buffer_load_dwordx4 v15, s[32:35], s43 offen lds
    s_add_u32 m0, s47, 2048
    s_add_u32 s43, s43, 1024
    buffer_load_dwordx4 v15, s[32:35], s43 offen lds
    s_add_u32 m0, s47, 3072
    s_add_u32 s43, s43, 1024
    buffer_load_dwordx4 v15, s[32:35], s43 offen lds
    s_add_u32 m0, s47, 4096
    s_add_u32 s43, s43, 1024
    buffer_load_dwordx4 v15, s[32:35], s43 offen lds
    s_add_u32 m0, s47, 5120
    s_add_u32 s43, s43, 1024
    buffer_load_dwordx4 v15, s[32:35], s43 offen lds
C4_NOQ0:
    s_add_u32 s71, s71, 393216
    s_mov_b32 s45, 94208
    s_add_u32 s43, s71, s46
    s_add_u32 s47, s45, s46
    s_add_u32 m0, s47, 0
    s_nop 0
    buffer_load_dwordx4 v15, s[32:35], s43 offen lds
    s_add_u32 m0, s47, 1024
    s_add_u32 s43, s43, 1024
    buffer_load_dwordx4 v15, s[32:35], s43 offen lds
    s_add_u32 m0, s47, 2048
    s_add_u32 s43, s43, 1024
    buffer_load_dwordx4 v15, s[32:35], s43 offen lds
    s_add_u32 m0, s47, 3072
    s_add_u32 s43, s43, 1024
    buffer_load_dwordx4 v15, s[32:35], s43 offen lds
    s_add_u32 m0, s47, 4096
    s_add_u32 s43, s43, 1024
    buffer_load_dwordx4 v15, s[32:35], s43 offen lds
    s_add_u32 m0, s47, 5120
    s_add_u32 s43, s43, 1024
    buffer_load_dwordx4 v15, s[32:35], s43 offen lds
C4_NOPD:
    s_mul_i32 s42, s58, 24576
    s_add_u32 s70, s42, 61210624
    s_add_u32 s71, s42, 87818240
    s_add_u32 s16, s42, 34996224
    s_mov_b32 s84, 0
    s_mov_b32 s86, 0
    s_mov_b32 s89, 1
    s_waitcnt vmcnt(6) lgkmcnt(0)
    s_barrier
    s_cmp_ge_u32 s40, 3
    s_cbranch_scc1 C4_ZWAVE
    s_setprio 3
    s_mov_b32 s87, 0x3dd53b95
    v_mov_b32 v16, 0
    v_mov_b32 v4, 0x3f80
    v_cmp_eq_u32 vcc, 0, v2
    v_cndmask_b32 v16, v16, v4, vcc
    v_mov_b32 v4, 0x3f800000
    v_cmp_eq_u32 vcc, 1, v2
    v_cndmask_b32 v16, v16, v4, vcc
    v_mov_b32 v17, 0
    v_mov_b32 v4, 0x3f80
    v_cmp_eq_u32 vcc, 2, v2
    v_cndmask_b32 v17, v17, v4, vcc
    v_mov_b32 v4, 0x3f800000
    v_cmp_eq_u32 vcc, 3, v2
    v_cndmask_b32 v17, v17, v4, vcc
    v_mov_b32 v18, 0
    v_mov_b32 v4, 0x3f80
    v_cmp_eq_u32 vcc, 4, v2
    v_cndmask_b32 v18, v18, v4, vcc
    v_mov_b32 v4, 0x3f800000
    v_cmp_eq_u32 vcc, 5, v2
    v_cndmask_b32 v18, v18, v4, vcc
    v_mov_b32 v19, 0
    v_mov_b32 v4, 0x3f80
    v_cmp_eq_u32 vcc, 6, v2
    v_cndmask_b32 v19, v19, v4, vcc
    v_mov_b32 v4, 0x3f800000
    v_cmp_eq_u32 vcc, 7, v2
    v_cndmask_b32 v19, v19, v4, vcc
    v_lshl_add_u32 v4, v3, 2, 0
    v_cmp_le_u32 s[8:9], v4, v2
    v_lshl_add_u32 v4, v3, 2, 1
    v_cmp_le_u32 s[10:11], v4, v2
    v_lshl_add_u32 v4, v3, 2, 2
    v_cmp_le_u32 s[12:13], v4, v2
    v_lshl_add_u32 v4, v3, 2, 3
    v_cmp_le_u32 s[14:15], v4, v2
    s_lshr_b32 s42, s61, 1
    s_add_u32 s42, s42, 4
    s_and_b32 s43, s61, 1
    s_cmp_eq_u32 s40, 2
    s_cselect_b32 s42, s42, s61
    s_cselect_b32 s43, s43, s40
    s_lshl_b32 s42, s42, 10
    s_lshl_b32 s43, s43, 3
    s_add_u32 s42, s42, s43
    s_mul_i32 s43, s59, 6144
    s_add_u32 s42, s42, s43
    s_add_u32 s72, s42, 21135360
    s_lshl_b32 s42, s58, 1
    s_add_u32 s42, s42, s40
    s_mul_i32 s42, s42, 6144
    s_add_u32 s75, s42, 21135360
    s_and_b32 s42, s54, 1
    s_lshl_b32 s42, s42, 4
    s_add_u32 s80, s42, s55
    s_and_b32 s42, s80, 3
    s_cmp_eq_u32 s42, 1
    s_cselect_b32 s42, s40, 0
    s_lshr_b32 s43, s80, 2
    s_add_u32 s43, s43, 32
    s_cmp_eq_u32 s42, 1
    s_cselect_b32 s80, s43, s80
    s_add_u32 s81, s32, 0x19fffff
    s_and_b32 s81, s81, 0xffe00000
    s_sub_u32 s81, s81, s32
    s_add_u32 s81, s81, s101
    s_lshr_b32 s42, s80, 1
    s_lshl_b32 s42, s42, 14
    s_add_u32 s81, s81, s42
    s_and_b32 s42, s80, 1
    s_lshl_b32 s42, s42, 12
    s_add_u32 s81, s81, s42
    v_mul_u32_u24 v10, 10240, v3
    v_lshl_add_u32 v10, v2, 4, v10
    s_lshr_b32 s42, s80, 1
    s_cmp_ge_u32 s42, 10
    s_cselect_b32 s43, 10, 0
    s_cselect_b32 s44, 128, 0
    s_sub_u32 s42, s42, s43
    s_lshl_b32 s42, s42, 10
    s_add_u32 s42, s42, s44
    s_and_b32 s43, s80, 1
    s_lshl_b32 s43, s43, 3
    s_add_u32 s42, s42, s43
    s_add_u32 s82, s42, s68
    s_add_u32 s45, s80, 32
    s_lshr_b32 s42, s45, 1
    s_cmp_ge_u32 s42, 10
    s_cselect_b32 s43, 10, 0
    s_cselect_b32 s44, 128, 0
    s_sub_u32 s42, s42, s43
    s_lshl_b32 s42, s42, 10
    s_add_u32 s42, s42, s44
    s_and_b32 s43, s45, 1
    s_lshl_b32 s43, s43, 3
    s_add_u32 s42, s42, s43
    s_add_u32 s73, s42, s68
    v_add_u32 v6, 4096, v15
    s_mul_i32 s42, s40, 12288
    s_add_u32 s42, s42, 20480
    v_add_u32 v7, s42, v15
    v_mov_b32 v8, -1
    v_mov_b32 v9, -1
    s_lshl_b32 s42, s40, 10
    s_add_u32 s42, s42, 256
    v_add_u32 v5, s42, v15
    s_cmp_eq_u32 s40, 0
    s_cselect_b32 s42, 0, 256
    s_add_u32 s42, s42, 2048
    v_add_u32 v4, s42, v13
    s_lshl_b32 s42, s40, 2
    s_add_u32 s42, s42, 8
    v_mov_b32 v12, s42
    s_mul_i32 s17, s40, 12288
    s_add_u32 s17, s17, 118784
    s_lshl_b32 s18, s40, 11
    s_add_u32 s18, s18, 143360
    s_cmp_eq_u32 s40, 0
    s_cselect_b32 s19, 0, 512
    s_add_u32 s19, s19, 146944
    s_lshr_b32 s42, s57, 2
    s_cmp_eq_u32 s42, s40
    s_cselect_b32 s19, 1, 0
    s_and_b32 s42, s57, 1
    s_cmp_eq_u32 s42, 0
    s_cselect_b32 s19, s19, 0
    s_bfe_u32 s43, s57, 0x10001
    s_lshl_b32 s19, s19, s43
    s_mul_i32 s43, s43, 6144
    s_add_u32 s17, s17, s43
    s_mul_i32 s42, s40, 12288
    s_add_u32 s42, s42, s43
    s_add_u32 s16, s16, s42
    s_lshl_b32 s42, s58, 1
    s_add_u32 s42, s42, s40
    s_mul_i32 s42, s42, 3072
    s_add_u32 s18, s42, 23068672
    s_mov_b32 s83, 0
C4_SLOOP:
    s_cmp_lt_u32 s40, 2
    s_cbranch_scc1 C4_SNW
    s_waitcnt vmcnt(0)
C4_SNW:
    s_barrier
    ds_read_b128 v[180:183], v6 offset:0
    ds_read_b128 v[184:187], v6 offset:1024
    ds_read_b128 v[188:191], v6 offset:2048
    ds_read_b128 v[192:195], v6 offset:3072
    ds_read_b128 v[196:199], v6 offset:4096
    ds_read_b128 v[200:203], v6 offset:5120
    ds_read_b128 v[204:207], v6 offset:6144
    ds_read_b128 v[208:211], v6 offset:7168
    ds_read_b128 v[212:215], v6 offset:8192
    ds_read_b128 v[216:219], v6 offset:9216
    s_waitcnt lgkmcnt(9)
    v_mfma_f32_16x16x32_bf16 v[220:223], v[20:23], v[180:183], 0
    v_mfma_f32_16x16x32_bf16 v[224:227], v[60:63], v[180:183], 0
    v_mfma_f32_16x16x32_bf16 v[228:231], v[100:103], v[180:183], 0
    v_mfma_f32_16x16x32_bf16 v[232:235], v[140:143], v[180:183], 0
    s_waitcnt lgkmcnt(8)
    v_mfma_f32_16x16x32_bf16 v[220:223], v[24:27], v[184:187], v[220:223]
    v_mfma_f32_16x16x32_bf16 v[224:227], v[64:67], v[184:187], v[224:227]
    v_mfma_f32_16x16x32_bf16 v[228:231], v[104:107], v[184:187], v[228:231]
    v_mfma_f32_16x16x32_bf16 v[232:235], v[144:147], v[184:187], v[232:235]
    s_waitcnt lgkmcnt(7)
    v_mfma_f32_16x16x32_bf16 v[220:223], v[28:31], v[188:191], v[220:223]
    v_mfma_f32_16x16x32_bf16 v[224:227], v[68:71], v[188:191], v[224:227]
    v_mfma_f32_16x16x32_bf16 v[228:231], v[108:111], v[188:191], v[228:231]
    v_mfma_f32_16x16x32_bf16 v[232:235], v[148:151], v[188:191], v[232:235]
    s_waitcnt lgkmcnt(6)
    v_mfma_f32_16x16x32_bf16 v[220:223], v[32:35], v[192:195], v[220:223]
    v_mfma_f32_16x16x32_bf16 v[224:227], v[72:75], v[192:195], v[224:227]
    v_mfma_f32_16x16x32_bf16 v[228:231], v[112:115], v[192:195], v[228:231]
    v_mfma_f32_16x16x32_bf16 v[232:235], v[152:155], v[192:195], v[232:235]
    s_waitcnt lgkmcnt(5)
    v_mfma_f32_16x16x32_bf16 v[220:223], v[36:39], v[196:199], v[220:223]
    v_mfma_f32_16x16x32_bf16 v[224:227], v[76:79], v[196:199], v[224:227]
    v_mfma_f32_16x16x32_bf16 v[228:231], v[116:119], v[196:199], v[228:231]
    v_mfma_f32_16x16x32_bf16 v[232:235], v[156:159], v[196:199], v[232:235]
    s_waitcnt lgkmcnt(4)
    v_mfma_f32_16x16x32_bf16 v[220:223], v[40:43], v[200:203], v[220:223]
    v_mfma_f32_16x16x32_bf16 v[224:227], v[80:83], v[200:203], v[224:227]
    v_mfma_f32_16x16x32_bf16 v[228:231], v[120:123], v[200:203], v[228:231]
    v_mfma_f32_16x16x32_bf16 v[232:235], v[160:163], v[200:203], v[232:235]
    s_waitcnt lgkmcnt(3)
    v_mfma_f32_16x16x32_bf16 v[220:223], v[44:47], v[204:207], v[220:223]
    v_mfma_f32_16x16x32_bf16 v[224:227], v[84:87], v[204:207], v[224:227]
    v_mfma_f32_16x16x32_bf16 v[228:231], v[124:127], v[204:207], v[228:231]
    v_mfma_f32_16x16x32_bf16 v[232:235], v[164:167], v[204:207], v[232:235]
    s_waitcnt lgkmcnt(2)
    v_mfma_f32_16x16x32_bf16 v[220:223], v[48:51], v[208:211], v[220:223]
    v_mfma_f32_16x16x32_bf16 v[224:227], v[88:91], v[208:211], v[224:227]
    v_mfma_f32_16x16x32_bf16 v[228:231], v[128:131], v[208:211], v[228:231]
    v_mfma_f32_16x16x32_bf16 v[232:235], v[168:171], v[208:211], v[232:235]
    s_waitcnt lgkmcnt(1)
    v_mfma_f32_16x16x32_bf16 v[220:223], v[52:55], v[212:215], v[220:223]
    v_mfma_f32_16x16x32_bf16 v[224:227], v[92:95], v[212:215], v[224:227]
    v_mfma_f32_16x16x32_bf16 v[228:231], v[132:135], v[212:215], v[228:231]
    v_mfma_f32_16x16x32_bf16 v[232:235], v[172:175], v[212:215], v[232:235]
    s_waitcnt lgkmcnt(0)
    v_mfma_f32_16x16x32_bf16 v[220:223], v[56:59], v[216:219], v[220:223]
    v_mfma_f32_16x16x32_bf16 v[224:227], v[96:99], v[216:219], v[224:227]
    v_mfma_f32_16x16x32_bf16 v[228:231], v[136:139], v[216:219], v[228:231]
    v_mfma_f32_16x16x32_bf16 v[232:235], v[176:179], v[216:219], v[232:235]
    s_mul_i32 s42, s86, 196608
    s_add_u32 s42, s42, s72
    s_nop 7
    v_add_f32_dpp v220, v224, v220 row_ror:8 row_mask:0xf bank_mask:0xf
    v_add_f32_dpp v221, v225, v221 row_ror:8 row_mask:0xf bank_mask:0xf
    v_add_f32_dpp v222, v226, v222 row_ror:8 row_mask:0xf bank_mask:0xf
    v_add_f32_dpp v223, v227, v223 row_ror:8 row_mask:0xf bank_mask:0xf
    v_add_f32_dpp v232, v228, v232 row_ror:8 row_mask:0xf bank_mask:0xf
    v_add_f32_dpp v233, v229, v233 row_ror:8 row_mask:0xf bank_mask:0xf
    v_add_f32_dpp v234, v230, v234 row_ror:8 row_mask:0xf bank_mask:0xf
    v_add_f32_dpp v235, v231, v235 row_ror:8 row_mask:0xf bank_mask:0xf
    v_mul_f32 v220, s87, v220
    v_mul_f32 v221, s87, v221
    v_mul_f32 v222, s87, v222
    v_mul_f32 v223, s87, v223
    s_mov_b64 vcc, s[64:65]
    v_cndmask_b32 v220, v232, v220, vcc
    v_cndmask_b32 v221, v233, v221, vcc
    v_cndmask_b32 v222, v234, v222, vcc
    v_cndmask_b32 v223, v235, v223, vcc
    v_cvt_pk_bf16_f32 v224, v220, v221
    v_cvt_pk_bf16_f32 v225, v222, v223
    s_cmp_eq_u32 s92, 0
    s_cbranch_scc1 PB_23
    buffer_store_dwordx2 v[224:225], v15, s[32:35], s42 offen
    s_branch PB_24
PB_23:
    buffer_store_dwordx2 v[224:225], v15, s[32:35], s42 offen sc1
PB_24:
    s_add_u32 s43, s86, 2
    s_and_b32 s43, s43, 3
    s_mul_i32 s43, s43, 196608
    s_add_u32 s43, s43, s72
    s_cmp_eq_u32 s92, 0
    s_cbranch_scc1 PB_25
    buffer_store_dwordx2 v[8:9], v15, s[32:35], s43 offen
    s_branch PB_26
PB_25:
    buffer_store_dwordx2 v[8:9], v15, s[32:35], s43 offen sc1
PB_26:
    s_cmp_lg_u32 s40, 2
    s_cbranch_scc1 C4_SC01
    s_cmp_ge_u32 s84, 63
    s_cbranch_scc1 C4_DONE
    s_barrier
C4_SPINR:
    s_sleep 15
    s_branch C4_SRED
C4_SC01:
    ds_read_b128 v[204:207], v7 offset:0
    ds_read_b128 v[208:211], v7 offset:1024
    ds_read_b128 v[212:215], v7 offset:2048
    ds_read_b128 v[216:219], v7 offset:3072
    ds_read_b128 v[220:223], v7 offset:4096
    ds_read_b128 v[224:227], v7 offset:5120
    ds_read_b128 v[228:231], v7 offset:6144
    ds_read_b128 v[232:235], v7 offset:7168
    ds_read_b128 v[236:239], v7 offset:8192
    ds_read_b128 v[240:243], v7 offset:9216
    s_mul_i32 s42, s86, 196608
    s_add_u32 s42, s42, s75
    s_add_u32 s43, s42, 4096
    s_sleep 6
    s_cmp_ge_u32 s84, 63
    s_cbranch_scc1 C4_POLLGL
C4_POLLG:
    buffer_load_dwordx4 v[180:183], v15, s[32:35], s42 offen offset:0 sc1
    buffer_load_dwordx4 v[184:187], v15, s[32:35], s42 offen offset:1024 sc1
    buffer_load_dwordx4 v[188:191], v15, s[32:35], s42 offen offset:2048 sc1
    buffer_load_dwordx4 v[192:195], v15, s[32:35], s42 offen offset:3072 sc1
    buffer_load_dwordx4 v[196:199], v15, s[32:35], s43 offen offset:0 sc1
    buffer_load_dwordx4 v[200:203], v15, s[32:35], s43 offen offset:1024 sc1
    s_waitcnt lgkmcnt(0)
    s_waitcnt vmcnt(5)
    v_mfma_f32_16x16x32_bf16 v[248:251], v[204:207], v[180:183], 0
    v_max_u32 v14, v180, v182
    v_mfma_f32_16x16x32_bf16 v[244:247], v[180:183], v[180:183], 0
    v_mfma_f32_16x16x32_bf16 v[252:255], v[228:231], v[180:183], 0
    s_waitcnt vmcnt(4)
    v_mfma_f32_16x16x32_bf16 v[248:251], v[208:211], v[184:187], v[248:251]
    v_max3_u32 v14, v14, v184, v186
    v_mfma_f32_16x16x32_bf16 v[244:247], v[184:187], v[184:187], v[244:247]
    ds_read_b128 v[204:207], v7 offset:10240
    ds_read_b128 v[208:211], v7 offset:11264
    v_mfma_f32_16x16x32_bf16 v[252:255], v[232:235], v[184:187], v[252:255]
    s_waitcnt vmcnt(3)
    v_mfma_f32_16x16x32_bf16 v[248:251], v[212:215], v[188:191], v[248:251]
    v_max3_u32 v14, v14, v188, v190
    v_mfma_f32_16x16x32_bf16 v[244:247], v[188:191], v[188:191], v[244:247]
    v_mfma_f32_16x16x32_bf16 v[252:255], v[236:239], v[188:191], v[252:255]
    s_waitcnt vmcnt(2)
    v_mfma_f32_16x16x32_bf16 v[248:251], v[216:219], v[192:195], v[248:251]
    v_max3_u32 v14, v14, v192, v194
    v_mfma_f32_16x16x32_bf16 v[244:247], v[192:195], v[192:195], v[244:247]
    v_mfma_f32_16x16x32_bf16 v[252:255], v[240:243], v[192:195], v[252:255]
    s_waitcnt vmcnt(1)
    v_mfma_f32_16x16x32_bf16 v[248:251], v[220:223], v[196:199], v[248:251]
    v_max3_u32 v14, v14, v196, v198
    v_mfma_f32_16x16x32_bf16 v[244:247], v[196:199], v[196:199], v[244:247]
    s_waitcnt lgkmcnt(0)
    v_mfma_f32_16x16x32_bf16 v[252:255], v[204:207], v[196:199], v[252:255]
    s_waitcnt vmcnt(0)
    v_mfma_f32_16x16x32_bf16 v[248:251], v[224:227], v[200:203], v[248:251]
    v_max3_u32 v14, v14, v200, v202
    v_mfma_f32_16x16x32_bf16 v[244:247], v[200:203], v[200:203], v[244:247]
    v_cmp_eq_u32 vcc, -1, v14
    s_add_u32 s88, s88, 1
    s_cmp_lt_u32 s88, 0x40000
    s_cselect_b64 s[90:91], vcc, 0
    s_cmp_lg_u64 s[90:91], 0
    v_mfma_f32_16x16x32_bf16 v[252:255], v[208:211], v[200:203], v[252:255]
    s_cbranch_scc0 C4_POLLGD
    ds_read_b128 v[204:207], v7 offset:0
    ds_read_b128 v[208:211], v7 offset:1024
    s_branch C4_POLLG
C4_POLLGL:
    buffer_load_dwordx4 v[180:183], v15, s[32:35], s42 offen offset:0 sc1
    buffer_load_dwordx4 v[184:187], v15, s[32:35], s42 offen offset:1024 sc1
    buffer_load_dwordx4 v[188:191], v15, s[32:35], s42 offen offset:2048 sc1
    buffer_load_dwordx4 v[192:195], v15, s[32:35], s42 offen offset:3072 sc1
    buffer_load_dwordx4 v[196:199], v15, s[32:35], s43 offen offset:0 sc1
    buffer_load_dwordx4 v[200:203], v15, s[32:35], s43 offen offset:1024 sc1
    s_waitcnt vmcnt(0)
    v_max_u32 v14, v180, v182
    v_max3_u32 v14, v14, v184, v186
    v_max3_u32 v14, v14, v188, v190
    v_max3_u32 v14, v14, v192, v194
    v_max3_u32 v14, v14, v196, v198
    v_max3_u32 v14, v14, v200, v202
    v_cmp_eq_u32 vcc, -1, v14
    s_add_u32 s88, s88, 1
    s_cmp_lt_u32 s88, 0x40000
    s_cselect_b64 s[90:91], vcc, 0
    s_cmp_lg_u64 s[90:91], 0
    s_cbranch_scc1 C4_POLLGL
    s_waitcnt lgkmcnt(0)
    s_branch C4_XPATH
C4_POLLGD:
    v_mov_b32 v14, 0xf149f2ca
    v_cmp_gt_u32 vcc, 2, v3
    s_nop 7
    v_cndmask_b32 v244, v244, v14, vcc
    v_cndmask_b32 v245, v245, v14, vcc
    v_cndmask_b32 v246, v246, v14, vcc
    v_cndmask_b32 v247, v247, v14, vcc
    v_max3_f32 v204, v248, v249, v250
    v_max3_f32 v205, v251, v252, v253
    v_max3_f32 v206, v254, v255, v244
    v_max3_f32 v207, v245, v246, v247
    v_max3_f32 v204, v204, v205, v206
    v_max_f32 v204, v204, v207
    v_mov_b32 v205, v204
    s_nop 1
    v_permlane32_swap_b32 v204, v205
    s_nop 1
    v_max_f32 v204, v204, v205
    v_mov_b32 v205, v204
    s_nop 1
    v_permlane16_swap_b32 v204, v205
    s_nop 1
    v_max_f32 v204, v204, v205
    v_sub_f32 v244, v244, v204
    v_sub_f32 v245, v245, v204
    v_sub_f32 v246, v246, v204
    v_sub_f32 v247, v247, v204
    v_sub_f32 v248, v248, v204
    v_sub_f32 v249, v249, v204
    v_sub_f32 v250, v250, v204
    v_sub_f32 v251, v251, v204
    v_sub_f32 v252, v252, v204
    v_sub_f32 v253, v253, v204
    v_sub_f32 v254, v254, v204
    v_sub_f32 v255, v255, v204
    v_exp_f32 v244, v244
    v_exp_f32 v245, v245
    v_exp_f32 v246, v246
    v_exp_f32 v247, v247
    v_exp_f32 v248, v248
    v_exp_f32 v249, v249
    v_exp_f32 v250, v250
    v_exp_f32 v251, v251
    v_exp_f32 v252, v252
    v_exp_f32 v253, v253
    v_exp_f32 v254, v254
    v_exp_f32 v255, v255
    s_nop 0
    v_add_f32 v206, v244, v245
    v_add_f32 v207, v246, v247
    v_add_f32 v208, v248, v249
    v_add_f32 v209, v250, v251
    v_add_f32 v210, v252, v253
    v_add_f32 v211, v254, v255
    v_add_f32 v206, v206, v207
    v_add_f32 v208, v208, v209
    v_add_f32 v210, v210, v211
    v_add_f32 v206, v206, v208
    v_add_f32 v206, v206, v210
    v_mov_b32 v207, v206
    s_nop 1
    v_permlane32_swap_b32 v206, v207
    s_nop 1
    v_add_f32 v206, v206, v207
    v_mov_b32 v207, v206
    s_nop 1
    v_permlane16_swap_b32 v206, v207
    s_nop 1
    v_add_f32 v206, v206, v207
    v_rcp_f32 v206, v206
    s_nop 0
    v_mul_f32 v244, v244, v206
    v_mul_f32 v245, v245, v206
    v_mul_f32 v246, v246, v206
    v_mul_f32 v247, v247, v206
    v_mul_f32 v248, v248, v206
    v_mul_f32 v249, v249, v206
    v_mul_f32 v250, v250, v206
    v_mul_f32 v251, v251, v206
    v_mul_f32 v252, v252, v206
    v_mul_f32 v253, v253, v206
    v_mul_f32 v254, v254, v206
    v_mul_f32 v255, v255, v206
    v_cvt_pk_bf16_f32 v216, v248, v249
    v_cvt_pk_bf16_f32 v217, v250, v251
    v_cvt_pk_bf16_f32 v218, v252, v253
    v_cvt_pk_bf16_f32 v219, v254, v255
    v_cvt_pk_bf16_f32 v220, v244, v245
    v_cvt_pk_bf16_f32 v221, v246, v247
    v_mov_b32 v14, s89
    ds_write_b128 v5, v[216:219]
    s_mov_b64 exec, s[98:99]
    ds_write_b64 v4, v[220:221]
    s_mov_b64 exec, -1
    s_waitcnt lgkmcnt(0)
    s_barrier
C4_XPATH:
    s_cmp_eq_u32 s19, 0
    s_cbranch_scc1 C4_XU_END
    s_setprio 0
    v_add_u32 v14, s17, v15
    s_cmp_eq_u32 s19, 2
    s_cbranch_scc1 C4_XU_1
    ds_read_b128 v[204:207], v14 offset:0
    ds_read_b128 v[208:211], v7 offset:0
    ds_read_b128 v[216:219], v14 offset:1024
    ds_read_b128 v[220:223], v7 offset:1024
    ds_read_b128 v[228:231], v14 offset:2048
    ds_read_b128 v[232:235], v7 offset:2048
    s_waitcnt lgkmcnt(4)
    v_mfma_f32_16x16x32_bf16 v[240:243], v[180:183], v[204:207], 0
    v_mfma_f32_16x16x32_bf16 v[244:247], v[208:211], v[204:207], 0
    s_nop 1
    ds_read_b128 v[204:207], v14 offset:3072
    ds_read_b128 v[208:211], v7 offset:3072
    s_waitcnt lgkmcnt(4)
    v_mfma_f32_16x16x32_bf16 v[240:243], v[184:187], v[216:219], v[240:243]
    v_mfma_f32_16x16x32_bf16 v[244:247], v[220:223], v[216:219], v[244:247]
    s_nop 1
    ds_read_b128 v[216:219], v14 offset:4096
    ds_read_b128 v[220:223], v7 offset:4096
    s_waitcnt lgkmcnt(4)
    v_mfma_f32_16x16x32_bf16 v[240:243], v[188:191], v[228:231], v[240:243]
    v_mfma_f32_16x16x32_bf16 v[244:247], v[232:235], v[228:231], v[244:247]
    s_nop 1
    ds_read_b128 v[228:231], v14 offset:5120
    ds_read_b128 v[232:235], v7 offset:5120
    s_waitcnt lgkmcnt(4)
    v_mfma_f32_16x16x32_bf16 v[240:243], v[192:195], v[204:207], v[240:243]
    v_mfma_f32_16x16x32_bf16 v[244:247], v[208:211], v[204:207], v[244:247]
    s_waitcnt lgkmcnt(2)
    v_mfma_f32_16x16x32_bf16 v[240:243], v[196:199], v[216:219], v[240:243]
    v_mfma_f32_16x16x32_bf16 v[244:247], v[220:223], v[216:219], v[244:247]
    s_waitcnt lgkmcnt(0)
    v_mfma_f32_16x16x32_bf16 v[240:243], v[200:203], v[228:231], v[240:243]
    v_mfma_f32_16x16x32_bf16 v[244:247], v[232:235], v[228:231], v[244:247]
    v_mov_b32 v204, 0xf149f2ca
    s_nop 7
    v_cndmask_b32 v240, v204, v240, s[98:99]
    v_cndmask_b32 v244, v204, v244, s[8:9]
    v_cndmask_b32 v241, v204, v241, s[98:99]
    v_cndmask_b32 v245, v204, v245, s[10:11]
    v_cndmask_b32 v242, v204, v242, s[98:99]
    v_cndmask_b32 v246, v204, v246, s[12:13]
    v_cndmask_b32 v243, v204, v243, s[98:99]
    v_cndmask_b32 v247, v204, v247, s[14:15]
    v_max3_f32 v205, v240, v241, v242
    v_max3_f32 v205, v205, v243, v244
    v_max3_f32 v205, v205, v245, v246
    v_max_f32 v205, v205, v247
    v_mov_b32 v207, v205
    s_nop 1
    v_permlane32_swap_b32 v205, v207
    s_nop 1
    v_max_f32 v205, v205, v207
    v_mov_b32 v207, v205
    s_nop 1
    v_permlane16_swap_b32 v205, v207
    s_nop 1
    v_max_f32 v205, v205, v207
    v_mul_f32 v205, s87, v205
    s_nop 0
    v_fma_f32 v240, v240, s87, -v205
    v_fma_f32 v241, v241, s87, -v205
    v_fma_f32 v242, v242, s87, -v205
    v_fma_f32 v243, v243, s87, -v205
    v_fma_f32 v244, v244, s87, -v205
    v_fma_f32 v245, v245, s87, -v205
    v_fma_f32 v246, v246, s87, -v205
    v_fma_f32 v247, v247, s87, -v205
    v_exp_f32 v240, v240
    v_exp_f32 v241, v241
    v_exp_f32 v242, v242
    v_exp_f32 v243, v243
    v_exp_f32 v244, v244
    v_exp_f32 v245, v245
    v_exp_f32 v246, v246
    v_exp_f32 v247, v247
    s_nop 0
    v_add_f32 v206, v240, v241
    v_add_f32 v207, v242, v243
    v_add_f32 v208, v244, v245
    v_add_f32 v209, v246, v247
    v_add_f32 v206, v206, v207
    v_add_f32 v208, v208, v209
    v_add_f32 v206, v206, v208
    v_mov_b32 v207, v206
    s_nop 1
    v_permlane32_swap_b32 v206, v207
    s_nop 1
    v_add_f32 v206, v206, v207
    v_mov_b32 v207, v206
    s_nop 1
    v_permlane16_swap_b32 v206, v207
    s_nop 1
    v_add_f32 v206, v206, v207
    v_rcp_f32 v206, v206
    s_nop 0
    v_mul_f32 v240, v240, v206
    v_mul_f32 v241, v241, v206
    v_mul_f32 v242, v242, v206
    v_mul_f32 v243, v243, v206
    v_mul_f32 v244, v244, v206
    v_mul_f32 v245, v245, v206
    v_mul_f32 v246, v246, v206
    v_mul_f32 v247, v247, v206
    v_cvt_pk_bf16_f32 v216, v244, v245
    v_cvt_pk_bf16_f32 v217, v246, v247
    v_cvt_pk_bf16_f32 v218, v240, v241
    v_cvt_pk_bf16_f32 v219, v242, v243
    s_mul_i32 s42, s86, 98304
    s_add_u32 s42, s42, s18
    s_add_u32 s43, s86, 2
    s_and_b32 s43, s43, 3
    s_mul_i32 s43, s43, 98304
    s_add_u32 s43, s43, s18
    s_cmp_eq_u32 s92, 0
    s_cbranch_scc1 PB_27
    buffer_store_dwordx4 v[216:219], v15, s[32:35], s42 offen offset:1024
    buffer_store_dwordx2 v[8:9], v15, s[32:35], s43 offen offset:1024
    buffer_store_dwordx2 v[8:9], v15, s[32:35], s43 offen offset:1032
    s_branch PB_28
PB_27:
    buffer_store_dwordx4 v[216:219], v15, s[32:35], s42 offen offset:1024 sc1
    buffer_store_dwordx2 v[8:9], v15, s[32:35], s43 offen offset:1024 sc1
    buffer_store_dwordx2 v[8:9], v15, s[32:35], s43 offen offset:1032 sc1
PB_28:
    s_branch C4_XU_Q
C4_XU_1:
    ds_read_b128 v[204:207], v14 offset:0
    ds_read_b128 v[208:211], v7 offset:0
    ds_read_b128 v[212:215], v7 offset:6144
    ds_read_b128 v[216:219], v14 offset:1024
    ds_read_b128 v[220:223], v7 offset:1024
    ds_read_b128 v[224:227], v7 offset:7168
    ds_read_b128 v[228:231], v14 offset:2048
    ds_read_b128 v[232:235], v7 offset:2048
    ds_read_b128 v[236:239], v7 offset:8192
    s_waitcnt lgkmcnt(6)
    v_mfma_f32_16x16x32_bf16 v[240:243], v[180:183], v[204:207], 0
    v_mfma_f32_16x16x32_bf16 v[244:247], v[208:211], v[204:207], 0
    v_mfma_f32_16x16x32_bf16 v[248:251], v[212:215], v[204:207], 0
    s_nop 1
    ds_read_b128 v[204:207], v14 offset:3072
    ds_read_b128 v[208:211], v7 offset:3072
    ds_read_b128 v[212:215], v7 offset:9216
    s_waitcnt lgkmcnt(6)
    v_mfma_f32_16x16x32_bf16 v[240:243], v[184:187], v[216:219], v[240:243]
    v_mfma_f32_16x16x32_bf16 v[244:247], v[220:223], v[216:219], v[244:247]
    v_mfma_f32_16x16x32_bf16 v[248:251], v[224:227], v[216:219], v[248:251]
    s_nop 1
    ds_read_b128 v[216:219], v14 offset:4096
    ds_read_b128 v[220:223], v7 offset:4096
    ds_read_b128 v[224:227], v7 offset:10240
    s_waitcnt lgkmcnt(6)
    v_mfma_f32_16x16x32_bf16 v[240:243], v[188:191], v[228:231], v[240:243]
    v_mfma_f32_16x16x32_bf16 v[244:247], v[232:235], v[228:231], v[244:247]
    v_mfma_f32_16x16x32_bf16 v[248:251], v[236:239], v[228:231], v[248:251]
    s_nop 1
    ds_read_b128 v[228:231], v14 offset:5120
    ds_read_b128 v[232:235], v7 offset:5120
    ds_read_b128 v[236:239], v7 offset:11264
    s_waitcnt lgkmcnt(6)
    v_mfma_f32_16x16x32_bf16 v[240:243], v[192:195], v[204:207], v[240:243]
    v_mfma_f32_16x16x32_bf16 v[244:247], v[208:211], v[204:207], v[244:247]
    v_mfma_f32_16x16x32_bf16 v[248:251], v[212:215], v[204:207], v[248:251]
    s_waitcnt lgkmcnt(3)
    v_mfma_f32_16x16x32_bf16 v[240:243], v[196:199], v[216:219], v[240:243]
    v_mfma_f32_16x16x32_bf16 v[244:247], v[220:223], v[216:219], v[244:247]
    v_mfma_f32_16x16x32_bf16 v[248:251], v[224:227], v[216:219], v[248:251]
    s_waitcnt lgkmcnt(0)
    v_mfma_f32_16x16x32_bf16 v[240:243], v[200:203], v[228:231], v[240:243]
    v_mfma_f32_16x16x32_bf16 v[244:247], v[232:235], v[228:231], v[244:247]
    v_mfma_f32_16x16x32_bf16 v[248:251], v[236:239], v[228:231], v[248:251]
    v_mov_b32 v204, 0xf149f2ca
    s_nop 7
    v_cndmask_b32 v240, v204, v240, s[98:99]
    v_cndmask_b32 v248, v204, v248, s[8:9]
    v_cndmask_b32 v241, v204, v241, s[98:99]
    v_cndmask_b32 v249, v204, v249, s[10:11]
    v_cndmask_b32 v242, v204, v242, s[98:99]
    v_cndmask_b32 v250, v204, v250, s[12:13]
    v_cndmask_b32 v243, v204, v243, s[98:99]
    v_cndmask_b32 v251, v204, v251, s[14:15]
    v_max3_f32 v205, v240, v241, v242
    v_max3_f32 v205, v205, v243, v244
    v_max3_f32 v205, v205, v245, v246
    v_max3_f32 v205, v205, v247, v248
    v_max3_f32 v205, v205, v249, v250
    v_max_f32 v205, v205, v251
    v_mov_b32 v207, v205
    s_nop 1
    v_permlane32_swap_b32 v205, v207
    s_nop 1
    v_max_f32 v205, v205, v207
    v_mov_b32 v207, v205
    s_nop 1
    v_permlane16_swap_b32 v205, v207
    s_nop 1
    v_max_f32 v205, v205, v207
    v_mul_f32 v205, s87, v205
    s_nop 0
    v_fma_f32 v240, v240, s87, -v205
    v_fma_f32 v241, v241, s87, -v205
    v_fma_f32 v242, v242, s87, -v205
    v_fma_f32 v243, v243, s87, -v205
    v_fma_f32 v244, v244, s87, -v205
    v_fma_f32 v245, v245, s87, -v205
    v_fma_f32 v246, v246, s87, -v205
    v_fma_f32 v247, v247, s87, -v205
    v_fma_f32 v248, v248, s87, -v205
    v_fma_f32 v249, v249, s87, -v205
    v_fma_f32 v250, v250, s87, -v205
    v_fma_f32 v251, v251, s87, -v205
    v_exp_f32 v240, v240
    v_exp_f32 v241, v241
    v_exp_f32 v242, v242
    v_exp_f32 v243, v243
    v_exp_f32 v244, v244
    v_exp_f32 v245, v245
    v_exp_f32 v246, v246
    v_exp_f32 v247, v247
    v_exp_f32 v248, v248
    v_exp_f32 v249, v249
    v_exp_f32 v250, v250
    v_exp_f32 v251, v251
    s_nop 0
    v_add_f32 v206, v240, v241
    v_add_f32 v207, v242, v243
    v_add_f32 v208, v244, v245
    v_add_f32 v209, v246, v247
    v_add_f32 v210, v248, v249
    v_add_f32 v211, v250, v251
    v_add_f32 v206, v206, v207
    v_add_f32 v208, v208, v209
    v_add_f32 v210, v210, v211
    v_add_f32 v206, v206, v208
    v_add_f32 v206, v206, v210
    v_mov_b32 v207, v206
    s_nop 1
    v_permlane32_swap_b32 v206, v207
    s_nop 1
    v_add_f32 v206, v206, v207
    v_mov_b32 v207, v206
    s_nop 1
    v_permlane16_swap_b32 v206, v207
    s_nop 1
    v_add_f32 v206, v206, v207
    v_rcp_f32 v206, v206
    s_nop 0
    v_mul_f32 v240, v240, v206
    v_mul_f32 v241, v241, v206
    v_mul_f32 v242, v242, v206
    v_mul_f32 v243, v243, v206
    v_mul_f32 v244, v244, v206
    v_mul_f32 v245, v245, v206
    v_mul_f32 v246, v246, v206
    v_mul_f32 v247, v247, v206
    v_mul_f32 v248, v248, v206
    v_mul_f32 v249, v249, v206
    v_mul_f32 v250, v250, v206
    v_mul_f32 v251, v251, v206
    v_cvt_pk_bf16_f32 v216, v244, v245
    v_cvt_pk_bf16_f32 v217, v246, v247
    v_cvt_pk_bf16_f32 v218, v248, v249
    v_cvt_pk_bf16_f32 v219, v250, v251
    v_cvt_pk_bf16_f32 v220, v240, v241
    v_cvt_pk_bf16_f32 v221, v242, v243
    s_mul_i32 s42, s86, 98304
    s_add_u32 s42, s42, s18
    s_add_u32 s43, s86, 2
    s_and_b32 s43, s43, 3
    s_mul_i32 s43, s43, 98304
    s_add_u32 s43, s43, s18
    s_cmp_eq_u32 s92, 0
    s_cbranch_scc1 PB_29
    buffer_store_dwordx4 v[216:219], v15, s[32:35], s42 offen
    buffer_store_dwordx2 v[220:221], v15, s[32:35], s42 offen offset:2048
    buffer_store_dwordx2 v[8:9], v15, s[32:35], s43 offen
    buffer_store_dwordx2 v[8:9], v15, s[32:35], s43 offen offset:8
    buffer_store_dwordx2 v[8:9], v15, s[32:35], s43 offen offset:2048
    s_branch PB_30
PB_29:
    buffer_store_dwordx4 v[216:219], v15, s[32:35], s42 offen sc1
    buffer_store_dwordx2 v[220:221], v15, s[32:35], s42 offen offset:2048 sc1
    buffer_store_dwordx2 v[8:9], v15, s[32:35], s43 offen sc1
    buffer_store_dwordx2 v[8:9], v15, s[32:35], s43 offen offset:8 sc1
    buffer_store_dwordx2 v[8:9], v15, s[32:35], s43 offen offset:2048 sc1
PB_30:
C4_XU_Q:
    s_setprio 3
    s_cmp_ge_u32 s84, 63
    s_cbranch_scc1 C4_XU_END
    s_add_u32 m0, s17, 0
    s_add_u32 s43, s16, 0
    buffer_load_dwordx4 v15, s[32:35], s43 offen lds
    s_add_u32 m0, s17, 1024
    s_add_u32 s43, s16, 1024
    buffer_load_dwordx4 v15, s[32:35], s43 offen lds
    s_add_u32 m0, s17, 2048
    s_add_u32 s43, s16, 2048
    buffer_load_dwordx4 v15, s[32:35], s43 offen lds
    s_add_u32 m0, s17, 3072
    s_add_u32 s43, s16, 3072
    buffer_load_dwordx4 v15, s[32:35], s43 offen lds
    s_add_u32 m0, s17, 4096
    s_add_u32 s43, s16, 4096
    buffer_load_dwordx4 v15, s[32:35], s43 offen lds
    s_add_u32 m0, s17, 5120
    s_add_u32 s43, s16, 5120
    buffer_load_dwordx4 v15, s[32:35], s43 offen lds
    s_add_u32 s16, s16, 393216
C4_XU_END:
    s_xor_b32 s83, s83, 1
    s_mul_i32 s42, s83, 24576
    s_mul_i32 s43, s40, 12288
    s_add_u32 s42, s42, s43
    s_add_u32 s42, s42, 20480
    v_add_u32 v7, s42, v15
    s_cmp_ge_u32 s84, 63
    s_cbranch_scc1 C4_DONE
    s_cmp_ge_u32 s80, 32
    s_cbranch_scc1 C4_SPINR
    s_cmp_eq_u32 s40, 0
    s_cbranch_scc1 C4_SW0
    s_branch C4_NORED
C4_SW0:
    s_branch C4_NORED
C4_SRED:
    s_mul_i32 s42, s86, 327680
    s_add_u32 s42, s42, s81
    s_add_u32 s43, s86, 1
    s_and_b32 s43, s43, 3
    s_mul_i32 s44, s43, 10240
    s_add_u32 s43, s43, 2
    s_and_b32 s43, s43, 3
    s_mul_i32 s45, s43, 10240
C4_RED1:
C4_POLLZ1:
    buffer_load_dwordx4 v[184:187], v15, s[32:35], s42 offen offset:0 sc1
    buffer_load_dwordx4 v[188:191], v15, s[32:35], s42 offen offset:1024 sc1
    buffer_load_dwordx4 v[192:195], v15, s[32:35], s42 offen offset:2048 sc1
    buffer_load_dwordx4 v[196:199], v15, s[32:35], s42 offen offset:3072 sc1
    s_waitcnt vmcnt(3)
    v_mfma_f32_16x16x32_bf16 v[228:231], v[184:187], v[16:19], 0
    v_max_u32 v14, v184, v186
    s_waitcnt vmcnt(2)
    v_mfma_f32_16x16x32_bf16 v[228:231], v[188:191], v[16:19], v[228:231]
    v_max3_u32 v14, v14, v188, v190
    s_waitcnt vmcnt(1)
    v_mfma_f32_16x16x32_bf16 v[228:231], v[192:195], v[16:19], v[228:231]
    v_max3_u32 v14, v14, v192, v194
    s_waitcnt vmcnt(0)
    v_mfma_f32_16x16x32_bf16 v[228:231], v[196:199], v[16:19], v[228:231]
    v_max3_u32 v14, v14, v196, v198
    v_cmp_eq_u32 vcc, -1, v14
    s_add_u32 s88, s88, 1
    s_cmp_lt_u32 s88, 0x40000
    s_cselect_b64 s[90:91], vcc, 0
    s_cmp_lg_u64 s[90:91], 0
    s_cbranch_scc1 C4_POLLZ1
    s_add_u32 s42, s44, s82
    s_add_u32 s43, s45, s82
    v_cvt_pk_bf16_f32 v232, v228, v229
    v_cvt_pk_bf16_f32 v233, v230, v231
    s_mov_b64 exec, s[64:65]
    s_cmp_eq_u32 s92, 0
    s_cbranch_scc1 PB_31
    buffer_store_dwordx2 v[232:233], v15, s[32:35], s42 offen
    buffer_store_dwordx2 v[8:9], v15, s[32:35], s43 offen
    s_branch PB_32
PB_31:
    buffer_store_dwordx2 v[232:233], v15, s[32:35], s42 offen sc1
    buffer_store_dwordx2 v[8:9], v15, s[32:35], s43 offen sc1
PB_32:
    s_mov_b64 exec, -1
    s_waitcnt vmcnt(0)
C4_NORED:
    s_add_u32 s84, s84, 1
    s_add_u32 s89, s89, 1
    s_and_b32 s86, s84, 3
    s_branch C4_SLOOP
C4_ZWAVE:
    s_setprio 2
    v_mov_b32 v12, 0
    v_mov_b32 v202, 0
    v_mov_b32 v203, 0
    v_mov_b32 v250, 0
    v_mov_b32 v251, 0
    s_mul_i32 s75, s57, 5
    s_add_u32 s75, s75, s74
    s_add_u32 s78, s32, 0x19fffff
    s_and_b32 s78, s78, 0xffe00000
    s_sub_u32 s78, s78, s32
    s_add_u32 s78, s78, s101
    s_lshr_b32 s42, s75, 1
    s_lshl_b32 s42, s42, 14
    s_add_u32 s78, s78, s42
    s_and_b32 s42, s75, 1
    s_lshl_b32 s42, s42, 12
    s_add_u32 s78, s78, s42
    s_lshl_b32 s42, s58, 8
    s_add_u32 s78, s78, s42
    s_mul_i32 s17, s58, 2621440
    s_lshl_b32 s42, s75, 9
    s_add_u32 s17, s17, s42
    s_add_u32 s17, s17, 135266304
    s_lshl_b32 s42, s74, 11
    s_add_u32 s69, s68, s42
    s_add_u32 s42, s42, 4096
    v_add_u32 v7, s42, v15
    v_add_u32 v6, 4096, v15
    s_lshr_b32 s42, s61, 1
    s_add_u32 s42, s42, 4
    s_and_b32 s43, s61, 1
    s_cmp_eq_u32 s79, 2
    s_cselect_b32 s42, s42, s61
    s_cselect_b32 s43, s43, s79
    s_lshl_b32 s42, s42, 10
    s_lshl_b32 s43, s43, 3
    s_add_u32 s42, s42, s43
    s_lshr_b32 s43, s57, 2
    s_lshl_b32 s43, s43, 7
    s_add_u32 s42, s42, s43
    s_mul_i32 s43, s58, 6144
    s_add_u32 s42, s42, s43
    s_add_u32 s72, s42, 21921792
    s_add_u32 s76, s43, 21921792
    v_mov_b32 v8, -1
    v_mov_b32 v9, -1
    v_mov_b32 v10, -1
    v_mov_b32 v11, -1
    s_mov_b32 s83, 0
    s_sub_u32 s42, s40, 4
    s_and_b32 s42, s42, 1
    s_lshl_b32 s43, s58, 1
    s_add_u32 s43, s43, s42
    s_mul_i32 s43, s43, 3072
    s_add_u32 s18, s43, 23068672
    s_lshl_b32 s43, s42, 11
    s_add_u32 s19, s43, 143360
    s_lshl_b32 s43, s42, 9
    s_add_u32 s16, s43, 146944
    s_mul_i32 s42, s83, 24576
    s_add_u32 s42, s42, 69632
    v_add_u32 v5, s42, v15
    ds_read_b128 v[204:207], v5 offset:0
    ds_read_b128 v[208:211], v5 offset:1024
    ds_read_b128 v[212:215], v5 offset:2048
    ds_read_b128 v[216:219], v5 offset:3072
    ds_read_b128 v[220:223], v5 offset:4096
    s_waitcnt lgkmcnt(4)
    v_mfma_f32_16x16x32_bf16 v[228:231], v[204:207], v[16:19], 0
    ds_read_b128 v[224:227], v5 offset:5120
    s_waitcnt lgkmcnt(4)
    v_mfma_f32_16x16x32_bf16 v[228:231], v[208:211], v[20:23], v[228:231]
    ds_read_b128 v[204:207], v5 offset:6144
    s_waitcnt lgkmcnt(4)
    v_mfma_f32_16x16x32_bf16 v[228:231], v[212:215], v[24:27], v[228:231]
    ds_read_b128 v[208:211], v5 offset:7168
    s_waitcnt lgkmcnt(4)
    v_mfma_f32_16x16x32_bf16 v[228:231], v[216:219], v[28:31], v[228:231]
    ds_read_b128 v[212:215], v5 offset:8192
    s_waitcnt lgkmcnt(4)
    v_mfma_f32_16x16x32_bf16 v[228:231], v[220:223], v[32:35], v[228:231]
    ds_read_b128 v[216:219], v5 offset:9216
    s_waitcnt lgkmcnt(4)
    v_mfma_f32_16x16x32_bf16 v[228:231], v[224:227], v[36:39], v[228:231]
    ds_read_b128 v[220:223], v5 offset:10240
    s_waitcnt lgkmcnt(4)
    v_mfma_f32_16x16x32_bf16 v[232:235], v[204:207], v[16:19], 0
    ds_read_b128 v[224:227], v5 offset:11264
    s_waitcnt lgkmcnt(4)
    v_mfma_f32_16x16x32_bf16 v[232:235], v[208:211], v[20:23], v[232:235]
    ds_read_b128 v[204:207], v5 offset:12288
    s_waitcnt lgkmcnt(4)
    v_mfma_f32_16x16x32_bf16 v[232:235], v[212:215], v[24:27], v[232:235]
    ds_read_b128 v[208:211], v5 offset:13312
    s_waitcnt lgkmcnt(4)
    v_mfma_f32_16x16x32_bf16 v[232:235], v[216:219], v[28:31], v[232:235]
    ds_read_b128 v[212:215], v5 offset:14336
    s_waitcnt lgkmcnt(4)
    v_mfma_f32_16x16x32_bf16 v[232:235], v[220:223], v[32:35], v[232:235]
    ds_read_b128 v[216:219], v5 offset:15360
    s_waitcnt lgkmcnt(4)
    v_mfma_f32_16x16x32_bf16 v[232:235], v[224:227], v[36:39], v[232:235]
    ds_read_b128 v[220:223], v5 offset:16384
    s_waitcnt lgkmcnt(4)
    v_mfma_f32_16x16x32_bf16 v[236:239], v[204:207], v[40:43], 0
    ds_read_b128 v[224:227], v5 offset:17408
    s_waitcnt lgkmcnt(4)
    v_mfma_f32_16x16x32_bf16 v[236:239], v[208:211], v[44:47], v[236:239]
    ds_read_b128 v[204:207], v5 offset:18432
    s_waitcnt lgkmcnt(4)
    v_mfma_f32_16x16x32_bf16 v[236:239], v[212:215], v[48:51], v[236:239]
    ds_read_b128 v[208:211], v5 offset:19456
    s_waitcnt lgkmcnt(4)
    v_mfma_f32_16x16x32_bf16 v[236:239], v[216:219], v[52:55], v[236:239]
    ds_read_b128 v[212:215], v5 offset:20480
    s_waitcnt lgkmcnt(4)
    v_mfma_f32_16x16x32_bf16 v[236:239], v[220:223], v[56:59], v[236:239]
    ds_read_b128 v[216:219], v5 offset:21504
    s_waitcnt lgkmcnt(4)
    v_mfma_f32_16x16x32_bf16 v[236:239], v[224:227], v[60:63], v[236:239]
    ds_read_b128 v[220:223], v5 offset:22528
    s_waitcnt lgkmcnt(4)
    v_mfma_f32_16x16x32_bf16 v[240:243], v[204:207], v[40:43], 0
    ds_read_b128 v[224:227], v5 offset:23552
    s_waitcnt lgkmcnt(4)
    v_mfma_f32_16x16x32_bf16 v[240:243], v[208:211], v[44:47], v[240:243]
    s_waitcnt lgkmcnt(3)
    v_mfma_f32_16x16x32_bf16 v[240:243], v[212:215], v[48:51], v[240:243]
    s_waitcnt lgkmcnt(2)
    v_mfma_f32_16x16x32_bf16 v[240:243], v[216:219], v[52:55], v[240:243]
    s_waitcnt lgkmcnt(1)
    v_mfma_f32_16x16x32_bf16 v[240:243], v[220:223], v[56:59], v[240:243]
    s_waitcnt lgkmcnt(0)
    v_mfma_f32_16x16x32_bf16 v[240:243], v[224:227], v[60:63], v[240:243]
    s_nop 7
    v_cvt_pk_bf16_f32 v192, v228, v229
    v_cvt_pk_bf16_f32 v193, v230, v231
    v_cvt_pk_bf16_f32 v194, v232, v233
    v_cvt_pk_bf16_f32 v195, v234, v235
    v_cvt_pk_bf16_f32 v196, v236, v237
    v_cvt_pk_bf16_f32 v197, v238, v239
    v_cvt_pk_bf16_f32 v198, v240, v241
    v_cvt_pk_bf16_f32 v199, v242, v243
    s_xor_b32 s83, s83, 1
    s_waitcnt vmcnt(0)
C4_ZLOOP:
    s_barrier
    s_cmp_eq_u32 s84, 0
    s_cbranch_scc1 C4_PFN0
    s_sub_u32 s42, s40, 4
    s_cmp_ge_u32 s42, 2
    s_cbranch_scc1 C4_PFN0
    s_sub_u32 s48, s84, 1
    s_and_b32 s51, s48, 3
    s_mul_i32 s51, s51, 98304
    s_add_u32 s51, s51, s18
    buffer_load_dwordx4 v[64:67], v15, s[32:35], s51 offen sc1
    buffer_load_dwordx4 v[68:71], v15, s[32:35], s51 offen offset:1024 sc1
    buffer_load_dwordx2 v[72:73], v15, s[32:35], s51 offen offset:2048 sc1
C4_PFN0:
    s_cmp_eq_u32 s40, 3
    s_cbranch_scc1 C4_NODMA
    s_and_b32 s42, s84, 3
    s_cmp_lg_u32 s42, 2
    s_cbranch_scc1 C4_NOFL
    s_add_u32 s42, s84, 2
    s_lshl_b32 s42, s42, 8
    s_add_u32 s93, s42, s77
    buffer_load_dword v254, v12, s[32:35], s93 offen sc1
C4_NOFL:
    s_cmp_lg_u32 s40, 5
    s_cbranch_scc1 C4_NOHS
    s_and_b32 s42, s84, 3
    s_cmp_eq_u32 s42, 1
    s_cselect_b32 s42, 1, 0
    s_cmp_ge_u32 s84, 44
    s_cselect_b32 s42, 1, s42
    s_cmp_eq_u32 s42, 0
    s_cbranch_scc1 C4_NOHS
    s_cmp_le_u32 s84, 1
    s_cbranch_scc1 C4_NOHS
    s_sub_u32 s42, s84, 1
    v_mov_b32 v14, s42
    s_mov_b64 exec, 1
    buffer_store_dword v14, v12, s[32:35], s50 offen sc1
    s_mov_b64 exec, -1
C4_NOHS:
    s_and_b32 s42, s84, 1
    s_xor_b32 s42, s42, 1
    s_mul_i32 s44, s42, 24576
    s_add_u32 s44, s44, 20480
    s_add_u32 s43, s70, s46
    s_add_u32 s47, s44, s46
    s_add_u32 m0, s47, 0
    s_nop 0
    buffer_load_dwordx4 v15, s[32:35], s43 offen lds
    s_add_u32 m0, s47, 1024
    s_add_u32 s43, s43, 1024
    buffer_load_dwordx4 v15, s[32:35], s43 offen lds
    s_add_u32 m0, s47, 2048
    s_add_u32 s43, s43, 1024
    buffer_load_dwordx4 v15, s[32:35], s43 offen lds
    s_add_u32 m0, s47, 3072
    s_add_u32 s43, s43, 1024
    buffer_load_dwordx4 v15, s[32:35], s43 offen lds
    s_add_u32 m0, s47, 4096
    s_add_u32 s43, s43, 1024
    buffer_load_dwordx4 v15, s[32:35], s43 offen lds
    s_add_u32 m0, s47, 5120
    s_add_u32 s43, s43, 1024
    buffer_load_dwordx4 v15, s[32:35], s43 offen lds
    s_add_u32 s70, s70, 393216
C4_NODMA:
    s_cmp_eq_u32 s84, 0
    s_cbranch_scc1 C4_PFN1
    s_sub_u32 s42, s40, 4
    s_cmp_ge_u32 s42, 2
    s_cbranch_scc1 C4_PFN1
C4_PFWL:
    s_waitcnt vmcnt(6)
    v_max3_u32 v14, v64, v66, v68
    v_max3_u32 v14, v14, v70, v72
    v_cmp_eq_u32 vcc, -1, v14
    s_add_u32 s88, s88, 1
    s_cmp_lt_u32 s88, 0x40000
    s_cselect_b64 s[90:91], vcc, 0
    s_cmp_eq_u64 s[90:91], 0
    s_cbranch_scc1 C4_PFKL
    buffer_load_dwordx4 v[64:67], v15, s[32:35], s51 offen sc1
    buffer_load_dwordx4 v[68:71], v15, s[32:35], s51 offen offset:1024 sc1
    buffer_load_dwordx2 v[72:73], v15, s[32:35], s51 offen offset:2048 sc1
    s_waitcnt vmcnt(0)
    s_branch C4_PFWL
C4_PFKL:
    s_and_b32 s42, s48, 1
    s_mul_i32 s42, s42, 6144
    s_add_u32 s43, s42, s19
    s_add_u32 s42, s42, s16
    v_add_u32 v14, s43, v15
    v_add_u32 v74, s42, v15
    ds_write_b64 v14, v[68:69]
    ds_write_b128 v14, v[64:67] offset:1024
    s_mov_b64 exec, s[98:99]
    ds_write_b64 v74, v[70:71]
    ds_write_b64 v74, v[72:73] offset:1024
    s_mov_b64 exec, -1
    v_mov_b32 v14, s89
    s_sub_u32 s42, s40, 4
    s_lshl_b32 s42, s42, 2
    v_mov_b32 v74, s42
    ds_write_b32 v74, v14 offset:40
C4_PFN1:
    s_cmp_eq_u32 s79, 99
    s_cbranch_scc1 C4_NOV
    ds_read_b128 v[144:147], v6 offset:0
    ds_read_b128 v[148:151], v6 offset:1024
    ds_read_b128 v[152:155], v6 offset:2048
    ds_read_b128 v[156:159], v6 offset:3072
    ds_read_b128 v[160:163], v6 offset:4096
    ds_read_b128 v[164:167], v6 offset:5120
    ds_read_b128 v[168:171], v6 offset:6144
    ds_read_b128 v[172:175], v6 offset:7168
    s_waitcnt lgkmcnt(7)
    v_mfma_f32_16x16x32_bf16 v[184:187], v[64:67], v[144:147], 0
    v_mfma_f32_16x16x32_bf16 v[188:191], v[104:107], v[144:147], 0
    ds_read_b128 v[144:147], v6 offset:8192
    s_waitcnt lgkmcnt(7)
    v_mfma_f32_16x16x32_bf16 v[184:187], v[68:71], v[148:151], v[184:187]
    v_mfma_f32_16x16x32_bf16 v[188:191], v[108:111], v[148:151], v[188:191]
    ds_read_b128 v[148:151], v6 offset:9216
    s_waitcnt lgkmcnt(7)
    v_mfma_f32_16x16x32_bf16 v[184:187], v[72:75], v[152:155], v[184:187]
    v_mfma_f32_16x16x32_bf16 v[188:191], v[112:115], v[152:155], v[188:191]
    s_waitcnt lgkmcnt(6)
    v_mfma_f32_16x16x32_bf16 v[184:187], v[76:79], v[156:159], v[184:187]
    v_mfma_f32_16x16x32_bf16 v[188:191], v[116:119], v[156:159], v[188:191]
    s_waitcnt lgkmcnt(5)
    v_mfma_f32_16x16x32_bf16 v[184:187], v[80:83], v[160:163], v[184:187]
    v_mfma_f32_16x16x32_bf16 v[188:191], v[120:123], v[160:163], v[188:191]
    s_waitcnt lgkmcnt(4)
    v_mfma_f32_16x16x32_bf16 v[184:187], v[84:87], v[164:167], v[184:187]
    v_mfma_f32_16x16x32_bf16 v[188:191], v[124:127], v[164:167], v[188:191]
    s_waitcnt lgkmcnt(3)
    v_mfma_f32_16x16x32_bf16 v[184:187], v[88:91], v[168:171], v[184:187]
    v_mfma_f32_16x16x32_bf16 v[188:191], v[128:131], v[168:171], v[188:191]
    s_waitcnt lgkmcnt(2)
    v_mfma_f32_16x16x32_bf16 v[184:187], v[92:95], v[172:175], v[184:187]
    v_mfma_f32_16x16x32_bf16 v[188:191], v[132:135], v[172:175], v[188:191]
    s_waitcnt lgkmcnt(1)
    v_mfma_f32_16x16x32_bf16 v[184:187], v[96:99], v[144:147], v[184:187]
    v_mfma_f32_16x16x32_bf16 v[188:191], v[136:139], v[144:147], v[188:191]
    s_waitcnt lgkmcnt(0)
    v_mfma_f32_16x16x32_bf16 v[184:187], v[100:103], v[148:151], v[184:187]
    v_mfma_f32_16x16x32_bf16 v[188:191], v[140:143], v[148:151], v[188:191]
    s_mul_i32 s42, s86, 98304
    s_add_u32 s42, s42, s72
    s_nop 7
    v_add_f32_dpp v184, v188, v184 row_ror:8 row_mask:0xf bank_mask:0xf
    v_add_f32_dpp v185, v189, v185 row_ror:8 row_mask:0xf bank_mask:0xf
    v_add_f32_dpp v186, v190, v186 row_ror:8 row_mask:0xf bank_mask:0xf
    v_add_f32_dpp v187, v191, v187 row_ror:8 row_mask:0xf bank_mask:0xf
    s_nop 0
    v_cvt_pk_bf16_f32 v188, v184, v185
    v_cvt_pk_bf16_f32 v189, v186, v187
    s_add_u32 s43, s86, 2
    s_and_b32 s43, s43, 3
    s_mul_i32 s43, s43, 98304
    s_add_u32 s43, s43, s72
    s_mov_b64 exec, s[64:65]
    s_cmp_eq_u32 s92, 0
    s_cbranch_scc1 PB_33
    buffer_store_dwordx2 v[188:189], v15, s[32:35], s42 offen
    s_branch PB_34
PB_33:
    buffer_store_dwordx2 v[188:189], v15, s[32:35], s42 offen sc1
PB_34:
    s_cmp_eq_u32 s92, 0
    s_cbranch_scc1 PB_35
    buffer_store_dwordx2 v[8:9], v15, s[32:35], s43 offen
    s_branch PB_36
PB_35:
    buffer_store_dwordx2 v[8:9], v15, s[32:35], s43 offen sc1
PB_36:
    s_mov_b64 exec, -1
C4_NOV:
    s_cmp_lg_u32 s40, 3
    s_cbranch_scc1 C4_NOVP
    s_mul_i32 s42, s86, 98304
    s_add_u32 s42, s42, s76
    s_add_u32 s43, s42, 4096
    s_sleep 10
C4_POLLV:
    buffer_load_dwordx4 v[144:147], v15, s[32:35], s42 offen offset:0 sc1
    buffer_load_dwordx4 v[148:151], v15, s[32:35], s42 offen offset:1024 sc1
    buffer_load_dwordx4 v[152:155], v15, s[32:35], s42 offen offset:2048 sc1
    buffer_load_dwordx4 v[156:159], v15, s[32:35], s42 offen offset:3072 sc1
    buffer_load_dwordx4 v[160:163], v15, s[32:35], s43 offen offset:0 sc1
    buffer_load_dwordx4 v[164:167], v15, s[32:35], s43 offen offset:1024 sc1
    s_waitcnt vmcnt(0)
    v_max_u32 v14, v144, v146
    v_max3_u32 v14, v14, v148, v150
    v_max3_u32 v14, v14, v152, v154
    v_max3_u32 v14, v14, v156, v158
    v_max3_u32 v14, v14, v160, v162
    v_max3_u32 v14, v14, v164, v166
    v_cmp_eq_u32 vcc, -1, v14
    s_add_u32 s88, s88, 1
    s_cmp_lt_u32 s88, 0x40000
    s_cselect_b64 s[90:91], vcc, 0
    s_cmp_lg_u64 s[90:91], 0
    s_cbranch_scc1 C4_POLLV
    ds_write_b128 v15, v[144:147] offset:14336
    ds_write_b128 v15, v[148:151] offset:15360
    ds_write_b128 v15, v[152:155] offset:16384
    ds_write_b128 v15, v[156:159] offset:17408
    ds_write_b128 v15, v[160:163] offset:18432
    ds_write_b128 v15, v[164:167] offset:19456
    v_mov_b32 v14, s89
    ds_write_b32 v12, v14 offset:32
C4_NOVP:
    s_cmp_eq_u32 s84, 0
    s_cbranch_scc1 C4_NOZXX
    s_add_u32 s48, s84, 1
C4_SPINXF:
    ds_read_b32 v252, v12 offset:40
    ds_read_b32 v253, v12 offset:44
    s_waitcnt lgkmcnt(0)
    v_cmp_ne_u32 vcc, s89, v252
    v_cmp_ne_u32 s[90:91], s89, v253
    s_or_b64 vcc, vcc, s[90:91]
    s_add_u32 s88, s88, 1
    s_cmp_lt_u32 s88, 0x40000
    s_cselect_b64 s[90:91], vcc, 0
    s_cmp_lg_u64 s[90:91], 0
    s_cbranch_scc1 C4_SPINXF
    s_and_b32 s42, s48, 1
    s_mul_i32 s42, s42, 6144
    s_add_u32 s42, s42, 143360
    v_add_u32 v5, s42, v15
    ds_read_b128 v[204:207], v5 offset:0
    ds_read_b128 v[208:211], v5 offset:1024
    ds_read_b128 v[212:215], v5 offset:2048
    ds_read_b128 v[216:219], v5 offset:3072
    ds_read_b128 v[220:223], v5 offset:4096
    ds_read_b128 v[224:227], v5 offset:5120
    s_waitcnt lgkmcnt(4)
    v_mfma_f32_16x16x32_bf16 v[228:231], v[176:179], v[204:207], 0
    v_mfma_f32_16x16x32_bf16 v[232:235], v[176:179], v[208:211], 0
    s_waitcnt lgkmcnt(2)
    v_mfma_f32_16x16x32_bf16 v[228:231], v[180:183], v[212:215], v[228:231]
    v_mfma_f32_16x16x32_bf16 v[232:235], v[180:183], v[216:219], v[232:235]
    s_waitcnt lgkmcnt(0)
    v_mfma_f32_16x16x32_bf16 v[228:231], v[200:203], v[220:223], v[228:231]
    v_mfma_f32_16x16x32_bf16 v[232:235], v[200:203], v[224:227], v[232:235]
    s_nop 7
    s_nop 1
    v_cvt_pk_bf16_f32 v236, v228, v229
    v_cvt_pk_bf16_f32 v237, v230, v231
    v_cvt_pk_bf16_f32 v238, v232, v233
    v_cvt_pk_bf16_f32 v239, v234, v235
C4_NOZXX:
C4_SPINV:
    ds_read_b32 v252, v12 offset:32
    ds_read_b128 v[204:207], v15 offset:14336
    ds_read_b128 v[208:211], v15 offset:15360
    ds_read_b128 v[212:215], v15 offset:16384
    ds_read_b128 v[216:219], v15 offset:17408
    ds_read_b128 v[220:223], v15 offset:18432
    ds_read_b128 v[224:227], v15 offset:19456
    s_waitcnt lgkmcnt(0)
    v_cmp_ne_u32 vcc, s89, v252
    s_add_u32 s88, s88, 1
    s_cmp_lt_u32 s88, 0x40000
    s_cselect_b64 s[90:91], vcc, 0
    s_cmp_lg_u64 s[90:91], 0
    s_cbranch_scc1 C4_SPINV
    v_mfma_f32_16x16x32_bf16 v[228:231], v[204:207], v[16:19], 0
    v_mfma_f32_16x16x32_bf16 v[232:235], v[204:207], v[40:43], 0
    v_mfma_f32_16x16x32_bf16 v[228:231], v[208:211], v[20:23], v[228:231]
    v_mfma_f32_16x16x32_bf16 v[232:235], v[208:211], v[44:47], v[232:235]
    v_mfma_f32_16x16x32_bf16 v[228:231], v[212:215], v[24:27], v[228:231]
    v_mfma_f32_16x16x32_bf16 v[232:235], v[212:215], v[48:51], v[232:235]
    v_mfma_f32_16x16x32_bf16 v[228:231], v[216:219], v[28:31], v[228:231]
    v_mfma_f32_16x16x32_bf16 v[232:235], v[216:219], v[52:55], v[232:235]
    v_mfma_f32_16x16x32_bf16 v[228:231], v[220:223], v[32:35], v[228:231]
    v_mfma_f32_16x16x32_bf16 v[232:235], v[220:223], v[56:59], v[232:235]
    v_mfma_f32_16x16x32_bf16 v[228:231], v[224:227], v[36:39], v[228:231]
    v_mfma_f32_16x16x32_bf16 v[232:235], v[224:227], v[60:63], v[232:235]
    s_mov_b64 vcc, s[66:67]
    s_nop 7
    v_cndmask_b32 v228, v232, v228, vcc
    v_cndmask_b32 v229, v233, v229, vcc
    v_cndmask_b32 v230, v234, v230, vcc
    v_cndmask_b32 v231, v235, v231, vcc
    v_cvt_pk_bf16_f32 v200, v228, v229
    v_cvt_pk_bf16_f32 v201, v230, v231
    s_cmp_eq_u32 s84, 0
    s_cbranch_scc1 C4_NOZXS
    s_add_u32 s42, s17, 20480
    buffer_store_dwordx2 v[236:237], v13, s[32:35], s17 offen sc1
    buffer_store_dwordx2 v[238:239], v13, s[32:35], s42 offen sc1
    s_add_u32 s17, s17, 40960
C4_NOZXS:
    s_cmp_ge_u32 s84, 63
    s_cbranch_scc1 C4_ZFIN
    s_barrier
    ds_read_b128 v[240:243], v15 offset:256
    ds_read_b128 v[244:247], v15 offset:1280
    ds_read_b64 v[248:249], v13 offset:2304
    s_waitcnt lgkmcnt(2)
    v_mfma_f32_16x16x32_bf16 v[184:187], v[240:243], v[192:195], 0
    s_waitcnt lgkmcnt(1)
    v_mfma_f32_16x16x32_bf16 v[184:187], v[244:247], v[196:199], v[184:187]
    s_waitcnt lgkmcnt(0)
    v_mfma_f32_16x16x32_bf16 v[184:187], v[248:251], v[200:203], v[184:187]
    s_mul_i32 s42, s86, 327680
    s_add_u32 s42, s42, s78
    s_add_u32 s43, s86, 2
    s_and_b32 s43, s43, 3
    s_mul_i32 s43, s43, 327680
    s_add_u32 s49, s43, s78
    s_nop 7
    v_cvt_pk_bf16_f32 v188, v184, v185
    v_cvt_pk_bf16_f32 v189, v186, v187
    v_mov_b32 v190, v188
    v_mov_b32 v191, v189
    s_nop 1
    v_permlane16_swap_b32 v188, v190
    v_permlane16_swap_b32 v189, v191
    s_mov_b64 exec, 0xffff
    buffer_store_dwordx4 v[188:191], v15, s[32:35], s42 offen sc1
    s_mov_b64 exec, -1
    s_cmp_eq_u32 s40, 3
    s_cbranch_scc1 C4_NODMA2
    s_and_b32 s42, s84, 3
    s_cmp_lg_u32 s42, 2
    s_cbranch_scc1 C4_T1W_OK
    s_cmp_ge_u32 s84, 62
    s_cbranch_scc1 C4_T1W_OK
C4_T1W:
    s_waitcnt vmcnt(0)
    v_readfirstlane_b32 s42, v254
    s_cmp_ge_u32 s42, 48
    s_cbranch_scc1 C4_T1W_OK
    s_add_u32 s88, s88, 1
    s_cmp_ge_u32 s88, 0x40000
    s_cbranch_scc1 C4_T1W_OK
    s_sleep 4
    buffer_load_dword v254, v12, s[32:35], s93 offen sc1
    s_branch C4_T1W
C4_T1W_OK:
    s_and_b32 s42, s84, 1
    s_mul_i32 s44, s42, 24576
    s_add_u32 s45, s44, 69632
    s_add_u32 s43, s71, s46
    s_add_u32 s47, s45, s46
    s_add_u32 m0, s47, 0
    s_nop 0
    buffer_load_dwordx4 v15, s[32:35], s43 offen lds
    s_add_u32 m0, s47, 1024
    s_add_u32 s43, s43, 1024
    buffer_load_dwordx4 v15, s[32:35], s43 offen lds
    s_add_u32 m0, s47, 2048
    s_add_u32 s43, s43, 1024
    buffer_load_dwordx4 v15, s[32:35], s43 offen lds
    s_add_u32 m0, s47, 3072
    s_add_u32 s43, s43, 1024
    buffer_load_dwordx4 v15, s[32:35], s43 offen lds
    s_add_u32 m0, s47, 4096
    s_add_u32 s43, s43, 1024
    buffer_load_dwordx4 v15, s[32:35], s43 offen lds
    s_add_u32 m0, s47, 5120
    s_add_u32 s43, s43, 1024
    buffer_load_dwordx4 v15, s[32:35], s43 offen lds
    s_add_u32 s71, s71, 393216
C4_NODMA2:
    v_mov_b32 v176, v192
    v_mov_b32 v177, v193
    v_mov_b32 v178, v194
    v_mov_b32 v179, v195
    v_mov_b32 v180, v196
    v_mov_b32 v181, v197
    v_mov_b32 v182, v198
    v_mov_b32 v183, v199
    s_mul_i32 s42, s83, 24576
    s_add_u32 s42, s42, 69632
    v_add_u32 v5, s42, v15
    ds_read_b128 v[204:207], v5 offset:0
    ds_read_b128 v[208:211], v5 offset:1024
    ds_read_b128 v[212:215], v5 offset:2048
    ds_read_b128 v[216:219], v5 offset:3072
    ds_read_b128 v[220:223], v5 offset:4096
    s_waitcnt lgkmcnt(4)
    v_mfma_f32_16x16x32_bf16 v[228:231], v[204:207], v[16:19], 0
    ds_read_b128 v[224:227], v5 offset:5120
    s_waitcnt lgkmcnt(4)
    v_mfma_f32_16x16x32_bf16 v[228:231], v[208:211], v[20:23], v[228:231]
    ds_read_b128 v[204:207], v5 offset:6144
    s_waitcnt lgkmcnt(4)
    v_mfma_f32_16x16x32_bf16 v[228:231], v[212:215], v[24:27], v[228:231]
    ds_read_b128 v[208:211], v5 offset:7168
    s_waitcnt lgkmcnt(4)
    v_mfma_f32_16x16x32_bf16 v[228:231], v[216:219], v[28:31], v[228:231]
    ds_read_b128 v[212:215], v5 offset:8192
    s_waitcnt lgkmcnt(4)
    v_mfma_f32_16x16x32_bf16 v[228:231], v[220:223], v[32:35], v[228:231]
    ds_read_b128 v[216:219], v5 offset:9216
    s_waitcnt lgkmcnt(4)
    v_mfma_f32_16x16x32_bf16 v[228:231], v[224:227], v[36:39], v[228:231]
    ds_read_b128 v[220:223], v5 offset:10240
    s_waitcnt lgkmcnt(4)
    v_mfma_f32_16x16x32_bf16 v[232:235], v[204:207], v[16:19], 0
    ds_read_b128 v[224:227], v5 offset:11264
    s_waitcnt lgkmcnt(4)
    v_mfma_f32_16x16x32_bf16 v[232:235], v[208:211], v[20:23], v[232:235]
    ds_read_b128 v[204:207], v5 offset:12288
    s_waitcnt lgkmcnt(4)
    v_mfma_f32_16x16x32_bf16 v[232:235], v[212:215], v[24:27], v[232:235]
    ds_read_b128 v[208:211], v5 offset:13312
    s_waitcnt lgkmcnt(4)
    v_mfma_f32_16x16x32_bf16 v[232:235], v[216:219], v[28:31], v[232:235]
    ds_read_b128 v[212:215], v5 offset:14336
    s_waitcnt lgkmcnt(4)
    v_mfma_f32_16x16x32_bf16 v[232:235], v[220:223], v[32:35], v[232:235]
    ds_read_b128 v[216:219], v5 offset:15360
    s_waitcnt lgkmcnt(4)
    v_mfma_f32_16x16x32_bf16 v[232:235], v[224:227], v[36:39], v[232:235]
    ds_read_b128 v[220:223], v5 offset:16384
    s_waitcnt lgkmcnt(4)
    v_mfma_f32_16x16x32_bf16 v[236:239], v[204:207], v[40:43], 0
    ds_read_b128 v[224:227], v5 offset:17408
    s_waitcnt lgkmcnt(4)
    v_mfma_f32_16x16x32_bf16 v[236:239], v[208:211], v[44:47], v[236:239]
    ds_read_b128 v[204:207], v5 offset:18432
    s_waitcnt lgkmcnt(4)
    v_mfma_f32_16x16x32_bf16 v[236:239], v[212:215], v[48:51], v[236:239]
    ds_read_b128 v[208:211], v5 offset:19456
    s_waitcnt lgkmcnt(4)
    v_mfma_f32_16x16x32_bf16 v[236:239], v[216:219], v[52:55], v[236:239]
    ds_read_b128 v[212:215], v5 offset:20480
    s_waitcnt lgkmcnt(4)
    v_mfma_f32_16x16x32_bf16 v[236:239], v[220:223], v[56:59], v[236:239]
    ds_read_b128 v[216:219], v5 offset:21504
    s_waitcnt lgkmcnt(4)
    v_mfma_f32_16x16x32_bf16 v[236:239], v[224:227], v[60:63], v[236:239]
    ds_read_b128 v[220:223], v5 offset:22528
    s_waitcnt lgkmcnt(4)
    v_mfma_f32_16x16x32_bf16 v[240:243], v[204:207], v[40:43], 0
    ds_read_b128 v[224:227], v5 offset:23552
    s_waitcnt lgkmcnt(4)
    v_mfma_f32_16x16x32_bf16 v[240:243], v[208:211], v[44:47], v[240:243]
    s_waitcnt lgkmcnt(3)
    v_mfma_f32_16x16x32_bf16 v[240:243], v[212:215], v[48:51], v[240:243]
    s_waitcnt lgkmcnt(2)
    v_mfma_f32_16x16x32_bf16 v[240:243], v[216:219], v[52:55], v[240:243]
    s_waitcnt lgkmcnt(1)
    v_mfma_f32_16x16x32_bf16 v[240:243], v[220:223], v[56:59], v[240:243]
    s_waitcnt lgkmcnt(0)
    v_mfma_f32_16x16x32_bf16 v[240:243], v[224:227], v[60:63], v[240:243]
    s_nop 7
    v_cvt_pk_bf16_f32 v192, v228, v229
    v_cvt_pk_bf16_f32 v193, v230, v231
    v_cvt_pk_bf16_f32 v194, v232, v233
    v_cvt_pk_bf16_f32 v195, v234, v235
    v_cvt_pk_bf16_f32 v196, v236, v237
    v_cvt_pk_bf16_f32 v197, v238, v239
    v_cvt_pk_bf16_f32 v198, v240, v241
    v_cvt_pk_bf16_f32 v199, v242, v243
    s_xor_b32 s83, s83, 1
    s_mov_b64 exec, 0xffff
    buffer_store_dwordx4 v[8:11], v15, s[32:35], s49 offen sc1
    s_mov_b64 exec, -1
    s_cmp_ge_u32 s84, 63
    s_cbranch_scc1 C4_DONE
    s_add_u32 s84, s84, 1
    s_add_u32 s89, s89, 1
    s_and_b32 s86, s84, 3
    s_mul_i32 s42, s86, 10240
    s_add_u32 s42, s42, s69
    s_sleep 10
C4_POLLM:
    buffer_load_dwordx4 v[144:147], v15, s[32:35], s42 offen sc1
    buffer_load_dwordx4 v[148:151], v15, s[32:35], s42 offen offset:1024 sc1
    s_waitcnt vmcnt(1)
    ds_write_b128 v7, v[144:147]
    v_max_u32 v14, v144, v146
    s_waitcnt vmcnt(0)
    ds_write_b128 v7, v[148:151] offset:1024
    v_max3_u32 v14, v14, v148, v150
    v_cmp_eq_u32 vcc, -1, v14
    s_add_u32 s88, s88, 1
    s_cmp_lt_u32 s88, 0x40000
    s_cselect_b64 s[90:91], vcc, 0
    s_cmp_lg_u64 s[90:91], 0
    s_cbranch_scc0 C4_POLLMD
    s_waitcnt lgkmcnt(0)
    s_branch C4_POLLM
C4_POLLMD:
    s_waitcnt lgkmcnt(0)
    s_branch C4_ZLOOP
C4_ZFIN:
    v_mov_b32 v176, v192
    v_mov_b32 v177, v193
    v_mov_b32 v178, v194
    v_mov_b32 v179, v195
    v_mov_b32 v180, v196
    v_mov_b32 v181, v197
    v_mov_b32 v182, v198
    v_mov_b32 v183, v199
C4_DONE:
    s_setprio 0
    s_sub_u32 s42, s40, 4
    s_cmp_ge_u32 s42, 2
    s_cbranch_scc1 C4_PFN2
    s_and_b32 s51, s84, 3
    s_mul_i32 s51, s51, 98304
    s_add_u32 s51, s51, s18
    buffer_load_dwordx4 v[64:67], v15, s[32:35], s51 offen sc1
    buffer_load_dwordx4 v[68:71], v15, s[32:35], s51 offen offset:1024 sc1
    buffer_load_dwordx2 v[72:73], v15, s[32:35], s51 offen offset:2048 sc1
C4_PFWD:
    s_waitcnt vmcnt(0)
    v_max3_u32 v14, v64, v66, v68
    v_max3_u32 v14, v14, v70, v72
    v_cmp_eq_u32 vcc, -1, v14
    s_add_u32 s88, s88, 1
    s_cmp_lt_u32 s88, 0x40000
    s_cselect_b64 s[90:91], vcc, 0
    s_cmp_eq_u64 s[90:91], 0
    s_cbranch_scc1 C4_PFKD
    buffer_load_dwordx4 v[64:67], v15, s[32:35], s51 offen sc1
    buffer_load_dwordx4 v[68:71], v15, s[32:35], s51 offen offset:1024 sc1
    buffer_load_dwordx2 v[72:73], v15, s[32:35], s51 offen offset:2048 sc1
    s_waitcnt vmcnt(0)
    s_branch C4_PFWD
C4_PFKD:
    s_and_b32 s42, s84, 1
    s_mul_i32 s42, s42, 6144
    s_add_u32 s43, s42, s19
    s_add_u32 s42, s42, s16
    v_add_u32 v14, s43, v15
    v_add_u32 v74, s42, v15
    ds_write_b64 v14, v[68:69]
    ds_write_b128 v14, v[64:67] offset:1024
    s_mov_b64 exec, s[98:99]
    ds_write_b64 v74, v[70:71]
    ds_write_b64 v74, v[72:73] offset:1024
    s_mov_b64 exec, -1
C4_PFN2:
    s_waitcnt lgkmcnt(0)
    s_barrier
    s_cmp_lt_u32 s40, 3
    s_cbranch_scc1 C4_NOZXL
    s_and_b32 s42, s84, 1
    s_mul_i32 s42, s42, 6144
    s_add_u32 s42, s42, 143360
    v_add_u32 v5, s42, v15
    ds_read_b128 v[204:207], v5 offset:0
    ds_read_b128 v[208:211], v5 offset:1024
    ds_read_b128 v[212:215], v5 offset:2048
    ds_read_b128 v[216:219], v5 offset:3072
    ds_read_b128 v[220:223], v5 offset:4096
    ds_read_b128 v[224:227], v5 offset:5120
    s_waitcnt lgkmcnt(4)
    v_mfma_f32_16x16x32_bf16 v[228:231], v[176:179], v[204:207], 0
    v_mfma_f32_16x16x32_bf16 v[232:235], v[176:179], v[208:211], 0
    s_waitcnt lgkmcnt(2)
    v_mfma_f32_16x16x32_bf16 v[228:231], v[180:183], v[212:215], v[228:231]
    v_mfma_f32_16x16x32_bf16 v[232:235], v[180:183], v[216:219], v[232:235]
    s_waitcnt lgkmcnt(0)
    v_mfma_f32_16x16x32_bf16 v[228:231], v[200:203], v[220:223], v[228:231]
    v_mfma_f32_16x16x32_bf16 v[232:235], v[200:203], v[224:227], v[232:235]
    s_nop 7
    s_nop 1
    v_cvt_pk_bf16_f32 v236, v228, v229
    v_cvt_pk_bf16_f32 v237, v230, v231
    v_cvt_pk_bf16_f32 v238, v232, v233
    v_cvt_pk_bf16_f32 v239, v234, v235
    s_add_u32 s42, s17, 20480
    buffer_store_dwordx2 v[236:237], v13, s[32:35], s17 offen sc1
    buffer_store_dwordx2 v[238:239], v13, s[32:35], s42 offen sc1
    s_add_u32 s17, s17, 40960
C4_NOZXL:
    s_waitcnt vmcnt(0) lgkmcnt(0)
    s_barrier
    s_cmp_lg_u32 s40, 0
    s_cbranch_scc1 C4_NOHS2
    v_mov_b32 v255, 64
    v_mov_b32 v12, 0
    s_mov_b64 exec, 1
    buffer_store_dword v255, v12, s[32:35], s50 offen sc1
    s_mov_b64 exec, -1
C4_NOHS2:
    v_lshrrev_b32 v1, 6, v0
    s_nop 0
    v_readfirstlane_b32 s40, v1
    v_and_b32 v1, 63, v0
    v_and_b32 v2, 15, v0
    v_lshrrev_b32 v3, 4, v1
    s_and_b32 s41, s40, 3
    s_lshr_b32 s39, s40, 2
    s_mov_b32 s55, -1
WENTRY0:
    s_mov_b32 s98, 0
    s_mov_b32 s3, s55
    s_cmp_eq_u32 s55, -1
    s_cbranch_scc0 WFIRST
WLOOP:
    s_cmp_lg_u32 s40, 0
    s_cbranch_scc1 WL_1
    s_mov_b64 exec, 1
    v_mov_b32 v4, 1
    v_mov_b32 v5, 0
    s_lshl_b32 s42, s100, 7
    s_add_u32 s42, s42, 66560
    buffer_atomic_add v4, v5, s[32:35], s42 offen sc0 sc1
    v_mov_b32 v5, 155648
    s_waitcnt vmcnt(0)
    ds_write_b32 v5, v4
    s_waitcnt lgkmcnt(0)
    s_mov_b64 exec, -1
WL_1:
    s_barrier
    v_mov_b32 v5, 155648
    ds_read_b32 v4, v5
    s_waitcnt lgkmcnt(0)
    v_readfirstlane_b32 s3, v4
    s_add_u32 s3, s3, 16
WFIRST:
    s_cmp_ge_u32 s3, 196
    s_cbranch_scc1 MG_END0
    s_mov_b32 s95, 0
    s_mov_b32 s97, 0
    s_mov_b32 s91, 0
    s_mov_b32 s87, 1
    s_mov_b32 s94, 65536
    s_mov_b32 s96, 136192
    s_lshl_b32 s86, s100, 7
    s_cmp_lt_u32 s3, 8
    s_cbranch_scc1 DC_MOD
    s_cmp_lt_u32 s3, 24
    s_cbranch_scc1 DC_LN1
    s_cmp_lt_u32 s3, 36
    s_cbranch_scc1 DC_T1F
    s_cmp_lt_u32 s3, 92
    s_cbranch_scc1 DC_T1
    s_sub_u32 s42, s3, 92
    s_cmp_lt_u32 s3, 169
    s_cbranch_scc1 DC_REG
    s_cmp_lt_u32 s3, 182
    s_cbranch_scc1 DC_PERS
    s_sub_u32 s42, s42, 13
DC_REG:
    s_mul_i32 s43, s42, 9363
    s_lshr_b32 s43, s43, 16
    s_mul_i32 s44, s43, 7
    s_sub_u32 s42, s42, s44
    s_sub_u32 s44, s43, 2
    s_mov_b32 s46, 0
    s_cmp_eq_u32 s42, 0
    s_cbranch_scc1 DC_FB
    s_sub_u32 s44, s43, 2
    s_mov_b32 s46, 1
    s_cmp_eq_u32 s42, 1
    s_cbranch_scc1 DC_FB
    s_sub_u32 s44, s43, 2
    s_mov_b32 s46, 2
    s_cmp_eq_u32 s42, 2
    s_cbranch_scc1 DC_FB
    s_sub_u32 s44, s43, 1
    s_mov_b32 s46, 0
    s_cmp_eq_u32 s42, 3
    s_cbranch_scc1 DC_FA
    s_sub_u32 s44, s43, 1
    s_mov_b32 s46, 1
    s_cmp_eq_u32 s42, 4
    s_cbranch_scc1 DC_FA
    s_sub_u32 s44, s43, 1
    s_mov_b32 s46, 2
    s_cmp_eq_u32 s42, 5
    s_cbranch_scc1 DC_FA
    s_sub_u32 s44, s43, 0
    s_mov_b32 s46, 0
    s_cmp_eq_u32 s42, 6
    s_cbranch_scc1 DC_LN2
DC_LN2:
    s_mov_b32 s99, 6
    s_lshl_b32 s56, s44, 3
    s_add_u32 s56, s56, s100
    s_lshl_b32 s45, s44, 10
    s_mov_b32 s94, 136192
    s_add_u32 s95, s44, 1
    s_lshl_b32 s95, s95, 2
    s_mov_b32 s90, 68608
    s_mov_b32 s91, 5
    s_add_u32 s45, s45, s86
    s_add_u32 s101, s45, 86016
    s_branch DC_CHKRB
DC_FA:
    s_mov_b32 s99, 7
    s_mov_b32 s56, s44
    s_mul_i32 s57, s100, 3
    s_add_u32 s57, s57, s46
    s_lshl_b32 s45, s44, 10
    s_add_u32 s94, s45, 86016
    s_mov_b32 s95, 1
    s_add_u32 s45, s45, s86
    s_add_u32 s101, s45, 102400
    s_branch DC_CHKRB
DC_FB:
    s_mov_b32 s99, 8
    s_lshl_b32 s45, s44, 10
    s_add_u32 s94, s45, 102400
    s_mov_b32 s95, 3
    s_mov_b32 s101, 0
    s_lshl_b32 s45, s46, 3
    s_add_u32 s47, s45, s100
    s_cmp_lt_u32 s46, 2
    s_cbranch_scc1 DC_FB2
    s_lshl_b32 s45, s43, 2
    s_add_u32 s45, s45, s100
    s_and_b32 s45, s45, 7
    s_add_u32 s47, s45, 16
    s_cmp_ge_u32 s45, 4
    s_cselect_b32 s99, 0, s99
DC_FB2:
    s_cmp_ge_u32 s47, 10
    s_cselect_b32 s45, 1, 0
    s_cselect_b32 s46, 10, 0
    s_sub_u32 s57, s47, s46
    s_lshl_b32 s56, s44, 1
    s_add_u32 s56, s56, s45
DC_CHKRB:
    s_cmp_ge_u32 s44, 11
    s_cselect_b32 s99, 0, s99
    s_branch DC_END
DC_PERS:
    s_sub_u32 s42, s3, 169
    s_mov_b32 s90, 68608
    s_mov_b32 s91, 5
    s_mov_b32 s101, 0
    s_mov_b32 s99, 10
    s_mov_b32 s56, s42
    s_mov_b32 s57, s100
    s_cmp_lt_u32 s42, 2
    s_cbranch_scc1 DC_END
    s_mov_b32 s99, 11
    s_sub_u32 s43, s42, 2
    s_lshl_b32 s43, s43, 3
    s_add_u32 s56, s43, s100
    s_cmp_lt_u32 s42, 8
    s_cbranch_scc1 DC_END
    s_mov_b32 s99, 12
    s_sub_u32 s43, s42, 8
    s_lshl_b32 s43, s43, 3
    s_add_u32 s43, s43, s100
    s_lshr_b32 s56, s43, 1
    s_and_b32 s57, s43, 1
    s_branch DC_END
DC_MOD:
    s_mov_b32 s99, 1
    s_lshl_b32 s56, s3, 3
    s_add_u32 s56, s56, s100
    s_cmp_lt_u32 s3, 3
    s_mov_b32 s101, 68608
    s_mov_b32 s45, 67584
    s_cselect_b32 s101, s45, s101
    s_add_u32 s101, s101, s86
    s_branch DC_END
DC_LN1:
    s_mov_b32 s99, 2
    s_sub_u32 s44, s3, 8
    s_lshl_b32 s56, s44, 3
    s_add_u32 s56, s56, s100
    s_mov_b32 s94, 67584
    s_mov_b32 s95, 3
    s_mov_b32 s97, 1
    s_lshl_b32 s45, s44, 10
    s_add_u32 s45, s45, s86
    s_add_u32 s101, s45, 69632
    s_branch DC_END
DC_T1F:
    s_mov_b32 s99, 9
    s_sub_u32 s44, s3, 24
    s_mul_i32 s56, s44, 5462
    s_lshr_b32 s56, s56, 16
    s_mul_i32 s45, s56, 12
    s_sub_u32 s44, s44, s45
    s_add_u32 s56, s56, 1
    s_lshr_b32 s58, s44, 2
    s_mov_b32 s87, 4
    s_branch DC_T1C
DC_T1:
    s_mov_b32 s99, 3
    s_sub_u32 s44, s3, 36
    s_lshr_b32 s56, s44, 2
    s_add_u32 s56, s56, 2
    s_mov_b32 s87, 12
DC_T1C:
    s_and_b32 s44, s44, 3
    s_lshl_b32 s57, s100, 2
    s_add_u32 s57, s57, s44
    s_lshl_b32 s45, s56, 10
    s_add_u32 s94, s45, 69632
    s_mov_b32 s95, 1
    s_mov_b32 s97, 1
    s_add_u32 s45, s45, s86
    s_add_u32 s101, s45, 118784
DC_END:
    s_cmp_eq_u32 s99, 0
    s_cbranch_scc1 WNULL
    s_cmp_eq_u32 s91, 0
    s_cbranch_scc1 WPRE
    s_cmp_lg_u32 s40, 0
    s_cbranch_scc1 WP_3
    v_and_b32 v8, 7, v1
    v_lshlrev_b32 v8, 7, v8
    v_mov_b32 v5, 0
    s_mov_b32 s79, 0
WP_2:
    s_add_u32 s78, s90, s79
    buffer_load_dword v6, v8, s[32:35], s90 offen sc1
    buffer_load_dword v7, v8, s[32:35], s78 offen sc1
    s_waitcnt vmcnt(0)
    v_min_u32 v6, v6, v7
    v_cmp_gt_u32 vcc, s91, v6
    s_cmp_eq_u64 vcc, 0
    s_cbranch_scc1 WP_3
    s_add_u32 s98, s98, 1
    s_cmp_ge_u32 s98, 0x8000
    s_cbranch_scc1 WP_3
    s_sleep 4
    s_branch WP_2
WP_3:
    s_barrier
WPRE:
    s_cmp_eq_u32 s99, 6
    s_cbranch_scc1 P_LN2
    s_cmp_eq_u32 s99, 7
    s_cbranch_scc1 P_FA
    s_cmp_eq_u32 s99, 8
    s_cbranch_scc1 P_FB
    s_cmp_eq_u32 s99, 2
    s_cbranch_scc1 P_LN1
    s_cmp_eq_u32 s99, 10
    s_cbranch_scc1 B_SUMP
    s_cmp_eq_u32 s99, 11
    s_cbranch_scc1 B_FAP
    s_cmp_eq_u32 s99, 12
    s_cbranch_scc1 B_FBP
WWAIT:
    s_cmp_eq_u32 s95, 0
    s_cbranch_scc1 WL_3
    s_cmp_lg_u32 s85, 0
    s_cbranch_scc1 GW_GD
    s_mov_b32 s85, 1
    s_cmp_lg_u32 s40, 0
    s_cbranch_scc1 GW_G2
    s_load_dwordx2 s[76:77], s[0:1], 112
    v_and_b32 v5, 3, v1
    v_lshlrev_b32 v5, 6, v5
    s_mov_b32 s78, 0
    s_waitcnt vmcnt(0) lgkmcnt(0)
GW_G1:
    global_load_dword v6, v5, s[76:77] sc1
    s_waitcnt vmcnt(0)
    v_readlane_b32 s42, v6, 0
    v_readlane_b32 s43, v6, 1
    v_readlane_b32 s44, v6, 2
    v_readlane_b32 s45, v6, 3
    s_add_u32 s42, s42, s43
    s_add_u32 s44, s44, s45
    s_add_u32 s42, s42, s44
    s_add_u32 s78, s78, 1
    s_cmp_ge_u32 s78, 0x40000
    s_cbranch_scc1 GW_G3
    s_and_b32 s43, s42, 0xff
    s_cmp_eq_u32 s43, 0
    s_cbranch_scc0 GW_G1
GW_G3:
    s_lshr_b32 s42, s42, 16
    v_mov_b32 v6, s42
    v_mov_b32 v5, 155648
    ds_write_b32 v5, v6 offset:32
    s_waitcnt lgkmcnt(0)
GW_G2:
    s_barrier
    v_mov_b32 v5, 155648
    ds_read_b32 v6, v5 offset:32
    s_waitcnt lgkmcnt(0)
    v_readfirstlane_b32 s42, v6
    s_cmp_lg_u32 s42, 0
    s_cbranch_scc1 FALLBACK
GW_GD:
    s_cmp_lg_u32 s40, 0
    s_cbranch_scc1 WL_3
    v_and_b32 v8, 7, v1
    v_lshlrev_b32 v8, 7, v8
    v_mov_b32 v5, 0
    s_mov_b32 s79, 0
    s_cmp_lg_u32 s99, 6
    s_cbranch_scc1 WL_2
    v_lshlrev_b32 v8, 7, v1
    s_mov_b32 s79, 8192
WL_2:
    s_add_u32 s78, s94, s79
    buffer_load_dword v6, v8, s[32:35], s94 offen sc1
    buffer_load_dword v7, v8, s[32:35], s78 offen sc1
    buffer_load_dword v9, v5, s[32:35], s96 offen sc1
    s_waitcnt vmcnt(0)
    v_min_u32 v6, v6, v7
    v_cmp_gt_u32 vcc, s95, v6
    v_readfirstlane_b32 s43, v9
    s_cmp_eq_u64 vcc, 0
    s_cbranch_scc1 WL_3
    s_add_u32 s98, s98, 1
    s_cmp_ge_u32 s98, 0x8000
    s_cbranch_scc1 WL_3
    s_cmp_ge_u32 s43, 64
    s_cselect_b32 s97, 1, s97
    s_sleep 4
    s_cmp_eq_u32 s97, 1
    s_cbranch_scc1 WL_2
    s_sleep 127
    s_branch WL_2
WL_3:
    s_barrier
    s_cmp_eq_u32 s99, 3
    s_cbranch_scc1 B_T1
    s_cmp_eq_u32 s99, 9
    s_cbranch_scc1 B_T1F
    s_cmp_eq_u32 s99, 6
    s_cbranch_scc1 B_LN2
    s_cmp_eq_u32 s99, 7
    s_cbranch_scc1 B_FA
    s_cmp_eq_u32 s99, 8
    s_cbranch_scc1 B_FB
    s_cmp_eq_u32 s99, 1
    s_cbranch_scc1 B_MOD
    v_lshlrev_b32 v5, 3, v1
    s_mov_b32 s24, 2560
    s_mov_b32 s23, 0
    buffer_load_dwordx2 v[60:61], v5, s[32:35], s23 offen offset:0
    buffer_load_dwordx2 v[70:71], v5, s[32:35], s24 offen offset:0
    buffer_load_dwordx2 v[62:63], v5, s[32:35], s23 offen offset:512
    buffer_load_dwordx2 v[72:73], v5, s[32:35], s24 offen offset:512
    buffer_load_dwordx2 v[64:65], v5, s[32:35], s23 offen offset:1024
    buffer_load_dwordx2 v[74:75], v5, s[32:35], s24 offen offset:1024
    buffer_load_dwordx2 v[66:67], v5, s[32:35], s23 offen offset:1536
    buffer_load_dwordx2 v[76:77], v5, s[32:35], s24 offen offset:1536
    buffer_load_dwordx2 v[68:69], v5, s[32:35], s23 offen offset:2048
    buffer_load_dwordx2 v[78:79], v5, s[32:35], s24 offen offset:2048
    s_mov_b32 s26, 1048576
    s_mul_i32 s42, s40, 2592
    v_lshl_add_u32 v6, v1, 2, s42
    s_waitcnt vmcnt(0)
    v_add_f32 v70, 1.0, v70
    v_add_f32 v71, 1.0, v71
    v_add_f32 v72, 1.0, v72
    v_add_f32 v73, 1.0, v73
    v_add_f32 v74, 1.0, v74
    v_add_f32 v75, 1.0, v75
    v_add_f32 v76, 1.0, v76
    v_add_f32 v77, 1.0, v77
    v_add_f32 v78, 1.0, v78
    v_add_f32 v79, 1.0, v79
    v_cvt_pk_bf16_f32 v70, v70, v70
    v_lshlrev_b32 v70, 16, v70
    v_cvt_pk_bf16_f32 v71, v71, v71
    v_lshlrev_b32 v71, 16, v71
    v_cvt_pk_bf16_f32 v72, v72, v72
    v_lshlrev_b32 v72, 16, v72
    v_cvt_pk_bf16_f32 v73, v73, v73
    v_lshlrev_b32 v73, 16, v73
    v_cvt_pk_bf16_f32 v74, v74, v74
    v_lshlrev_b32 v74, 16, v74
    v_cvt_pk_bf16_f32 v75, v75, v75
    v_lshlrev_b32 v75, 16, v75
    v_cvt_pk_bf16_f32 v76, v76, v76
    v_lshlrev_b32 v76, 16, v76
    v_cvt_pk_bf16_f32 v77, v77, v77
    v_lshlrev_b32 v77, 16, v77
    v_cvt_pk_bf16_f32 v78, v78, v78
    v_lshlrev_b32 v78, 16, v78
    v_cvt_pk_bf16_f32 v79, v79, v79
    v_lshlrev_b32 v79, 16, v79
    v_fma_f32 v40, v40, v70, v60
    v_fma_f32 v41, v41, v71, v61
    v_fma_f32 v42, v42, v72, v62
    v_fma_f32 v43, v43, v73, v63
    v_fma_f32 v44, v44, v74, v64
    v_fma_f32 v45, v45, v75, v65
    v_fma_f32 v46, v46, v76, v66
    v_fma_f32 v47, v47, v77, v67
    v_fma_f32 v48, v48, v78, v68
    v_fma_f32 v49, v49, v79, v69
    v_cvt_pk_bf16_f32 v20, v40, v41
    v_cvt_pk_bf16_f32 v21, v42, v43
    v_cvt_pk_bf16_f32 v22, v44, v45
    v_cvt_pk_bf16_f32 v23, v46, v47
    v_cvt_pk_bf16_f32 v24, v48, v49
    v_fma_f32 v50, v50, v70, v60
    v_fma_f32 v51, v51, v71, v61
    v_fma_f32 v52, v52, v72, v62
    v_fma_f32 v53, v53, v73, v63
    v_fma_f32 v54, v54, v74, v64
    v_fma_f32 v55, v55, v75, v65
    v_fma_f32 v56, v56, v76, v66
    v_fma_f32 v57, v57, v77, v67
    v_fma_f32 v58, v58, v78, v68
    v_fma_f32 v59, v59, v79, v69
    v_cvt_pk_bf16_f32 v25, v50, v51
    v_cvt_pk_bf16_f32 v26, v52, v53
    v_cvt_pk_bf16_f32 v27, v54, v55
    v_cvt_pk_bf16_f32 v28, v56, v57
    v_cvt_pk_bf16_f32 v29, v58, v59
    s_cmp_lt_u32 s56, 8
    s_cbranch_scc1 LN1_F
    buffer_store_dword v20, v4, s[32:35], s26 offen offset:0 sc1
    buffer_store_dword v21, v4, s[32:35], s26 offen offset:256 sc1
    buffer_store_dword v22, v4, s[32:35], s26 offen offset:512 sc1
    buffer_store_dword v23, v4, s[32:35], s26 offen offset:768 sc1
    buffer_store_dword v24, v4, s[32:35], s26 offen offset:1024 sc1
    buffer_store_dword v25, v4, s[32:35], s26 offen offset:1280 sc1
    buffer_store_dword v26, v4, s[32:35], s26 offen offset:1536 sc1
    buffer_store_dword v27, v4, s[32:35], s26 offen offset:1792 sc1
    buffer_store_dword v28, v4, s[32:35], s26 offen offset:2048 sc1
    buffer_store_dword v29, v4, s[32:35], s26 offen offset:2304 sc1
    s_branch LN1_END
LN1_F:
    ds_write_b32 v6, v20 offset:0
    ds_write_b32 v6, v21 offset:256
    ds_write_b32 v6, v22 offset:512
    ds_write_b32 v6, v23 offset:768
    ds_write_b32 v6, v24 offset:1024
    ds_write_b32 v6, v25 offset:1296
    ds_write_b32 v6, v26 offset:1552
    ds_write_b32 v6, v27 offset:1808
    ds_write_b32 v6, v28 offset:2064
    ds_write_b32 v6, v29 offset:2320
    v_mul_u32_u24 v6, 1296, v2
    v_lshl_add_u32 v6, v3, 3, v6
    s_lshl_b32 s42, s40, 6
    v_add_u32 v6, s42, v6
    v_lshlrev_b32 v15, 4, v1
    s_mul_i32 s42, s56, 20480
    s_lshl_b32 s43, s40, 10
    s_add_u32 s42, s42, s43
    s_add_u32 s42, s42, 10485760
    s_waitcnt lgkmcnt(0)
    s_barrier
    ds_read_b64 v[60:61], v6 offset:0
    ds_read_b64 v[62:63], v6 offset:32
    ds_read_b64 v[64:65], v6 offset:512
    ds_read_b64 v[66:67], v6 offset:544
    s_cmp_ge_u32 s40, 4
    s_cbranch_scc1 LN1_F2
    ds_read_b64 v[68:69], v6 offset:1024
    ds_read_b64 v[70:71], v6 offset:1056
    s_add_u32 s43, s42, 16384
    s_waitcnt lgkmcnt(0)
    buffer_store_dwordx4 v[68:71], v15, s[32:35], s43 offen sc1
LN1_F2:
    s_waitcnt lgkmcnt(0)
    s_add_u32 s43, s42, 8192
    buffer_store_dwordx4 v[60:63], v15, s[32:35], s42 offen sc1
    buffer_store_dwordx4 v[64:67], v15, s[32:35], s43 offen sc1
LN1_END:
    s_branch WDONE
WNULL:
    s_barrier
    s_branch WLOOP
P_LN2:
    s_load_dwordx2 s[4:5], s[0:1], 0
    s_waitcnt lgkmcnt(0)
    s_mov_b32 s12, s4
    s_mov_b32 s13, s5
    s_mov_b32 s14, 2621440
    s_mov_b32 s15, 0x00020000
    v_lshlrev_b32 v15, 4, v1
    s_lshl_b32 s42, s56, 4
    v_add_u32 v4, s42, v2
    v_mul_u32_u24 v4, 1280, v4
    v_lshl_add_u32 v4, v3, 3, v4
    s_lshl_b32 s58, s40, 6
    v_lshlrev_b32 v5, 4, v3
    s_lshl_b32 s59, s40, 7
    s_add_u32 s42, s58, 0
    buffer_load_dwordx2 v[16:17], v4, s[12:15], s42 offen
    buffer_load_dwordx2 v[18:19], v4, s[12:15], s42 offen offset:32
    s_add_u32 s42, s59, 5120
    buffer_load_dwordx4 v[28:31], v5, s[32:35], s42 offen
    buffer_load_dwordx4 v[32:35], v5, s[32:35], s42 offen offset:64
    s_add_u32 s42, s59, 7680
    buffer_load_dwordx4 v[52:55], v5, s[32:35], s42 offen
    buffer_load_dwordx4 v[56:59], v5, s[32:35], s42 offen offset:64
    s_add_u32 s42, s59, 10240
    buffer_load_dwordx4 v[76:79], v5, s[32:35], s42 offen
    buffer_load_dwordx4 v[80:83], v5, s[32:35], s42 offen offset:64
    s_add_u32 s42, s58, 512
    buffer_load_dwordx2 v[20:21], v4, s[12:15], s42 offen
    buffer_load_dwordx2 v[22:23], v4, s[12:15], s42 offen offset:32
    s_add_u32 s42, s59, 6144
    buffer_load_dwordx4 v[36:39], v5, s[32:35], s42 offen
    buffer_load_dwordx4 v[40:43], v5, s[32:35], s42 offen offset:64
    s_add_u32 s42, s59, 8704
    buffer_load_dwordx4 v[60:63], v5, s[32:35], s42 offen
    buffer_load_dwordx4 v[64:67], v5, s[32:35], s42 offen offset:64
    s_add_u32 s42, s59, 11264
    buffer_load_dwordx4 v[84:87], v5, s[32:35], s42 offen
    buffer_load_dwordx4 v[88:91], v5, s[32:35], s42 offen offset:64
    s_cmp_ge_u32 s40, 4
    s_cbranch_scc1 LN2P_SKIP
    s_add_u32 s42, s58, 1024
    buffer_load_dwordx2 v[24:25], v4, s[12:15], s42 offen
    buffer_load_dwordx2 v[26:27], v4, s[12:15], s42 offen offset:32
    s_add_u32 s42, s59, 7168
    buffer_load_dwordx4 v[44:47], v5, s[32:35], s42 offen
    buffer_load_dwordx4 v[48:51], v5, s[32:35], s42 offen offset:64
    s_add_u32 s42, s59, 9728
    buffer_load_dwordx4 v[68:71], v5, s[32:35], s42 offen
    buffer_load_dwordx4 v[72:75], v5, s[32:35], s42 offen offset:64
    s_add_u32 s42, s59, 12288
    buffer_load_dwordx4 v[92:95], v5, s[32:35], s42 offen
    buffer_load_dwordx4 v[96:99], v5, s[32:35], s42 offen offset:64
LN2P_SKIP:
    s_branch WWAIT
P_FA:
    s_load_dwordx4 s[4:7], s[0:1], 64
    s_waitcnt lgkmcnt(0)
    s_mov_b32 s8, s4
    s_mov_b32 s9, s5
    s_mov_b32 s10, 1966080
    s_mov_b32 s11, 0x00020000
    s_mov_b32 s12, s6
    s_mov_b32 s13, s7
    s_mov_b32 s14, 1966080
    s_mov_b32 s15, 0x00020000
    v_lshlrev_b32 v15, 4, v1
    v_lshrrev_b32 v4, 3, v1
    s_and_b32 s42, s40, 1
    s_lshl_b32 s42, s42, 3
    v_add_u32 v4, s42, v4
    v_bfe_u32 v5, v4, 1, 2
    v_bfe_u32 v6, v1, 1, 2
    v_xor_b32 v6, v6, v5
    v_and_b32 v7, 1, v1
    v_mul_u32_u24 v132, 3072, v4
    v_lshl_add_u32 v132, v6, 5, v132
    v_lshl_add_u32 v132, v7, 4, v132
    s_lshl_b32 s60, s39, 12
    s_lshl_b32 s42, s41, 10
    s_add_u32 s60, s60, s42
    s_bfe_u32 s42, s40, 0x10001
    s_mul_i32 s61, s42, 49152
    s_mul_i32 s62, s61, 3
    s_mul_i32 s63, s39, 98304
    v_lshrrev_b32 v4, 2, v2
    v_lshl_add_u32 v4, v3, 2, v4
    v_bfe_u32 v5, v4, 1, 2
    v_and_b32 v6, 3, v2
    v_mul_u32_u24 v7, 128, v4
    v_lshl_add_u32 v7, v6, 3, v7
    s_mul_i32 s42, s39, 2
    s_add_u32 s43, s42, 0
    v_xor_b32 v6, s43, v5
    v_lshl_add_u32 v128, v6, 5, v7
    v_add_u32 v130, 0x10000, v128
    s_add_u32 s43, s42, 1
    v_xor_b32 v6, s43, v5
    v_lshl_add_u32 v129, v6, 5, v7
    v_add_u32 v131, 0x10000, v129
    s_add_u32 m0, s60, 0
    s_lshl_b32 s58, s57, 7
    s_add_u32 s58, s58, s61
    s_add_u32 s58, s58, s63
    s_add_u32 s45, s58, 0
    buffer_load_dwordx4 v132, s[8:11], s45 offen lds
    s_add_u32 m0, s60, 8192
    s_add_u32 s45, s58, 0
    buffer_load_dwordx4 v132, s[12:15], s45 offen lds
    s_add_u32 m0, s60, 16384
    s_add_u32 s45, s58, 196608
    buffer_load_dwordx4 v132, s[8:11], s45 offen lds
    s_add_u32 m0, s60, 24576
    s_add_u32 s45, s58, 196608
    buffer_load_dwordx4 v132, s[12:15], s45 offen lds
    s_add_u32 m0, s60, 32768
    s_add_u32 s45, s58, 393216
    buffer_load_dwordx4 v132, s[8:11], s45 offen lds
    s_add_u32 m0, s60, 40960
    s_add_u32 s45, s58, 393216
    buffer_load_dwordx4 v132, s[12:15], s45 offen lds
    s_add_u32 m0, s60, 49152
    s_add_u32 s45, s58, 589824
    buffer_load_dwordx4 v132, s[8:11], s45 offen lds
    s_add_u32 m0, s60, 57344
    s_add_u32 s45, s58, 589824
    buffer_load_dwordx4 v132, s[12:15], s45 offen lds
    s_add_u32 m0, s60, 65536
    s_add_u32 s45, s58, 786432
    buffer_load_dwordx4 v132, s[8:11], s45 offen lds
    s_add_u32 m0, s60, 73728
    s_add_u32 s45, s58, 786432
    buffer_load_dwordx4 v132, s[12:15], s45 offen lds
    s_add_u32 m0, s60, 81920
    s_add_u32 s45, s58, 983040
    buffer_load_dwordx4 v132, s[8:11], s45 offen lds
    s_add_u32 m0, s60, 90112
    s_add_u32 s45, s58, 983040
    buffer_load_dwordx4 v132, s[12:15], s45 offen lds
    s_add_u32 m0, s60, 98304
    s_add_u32 s45, s58, 1179648
    buffer_load_dwordx4 v132, s[8:11], s45 offen lds
    s_add_u32 m0, s60, 106496
    s_add_u32 s45, s58, 1179648
    buffer_load_dwordx4 v132, s[12:15], s45 offen lds
    s_add_u32 m0, s60, 114688
    s_add_u32 s45, s58, 1376256
    buffer_load_dwordx4 v132, s[8:11], s45 offen lds
    s_add_u32 m0, s60, 122880
    s_add_u32 s45, s58, 1376256
    buffer_load_dwordx4 v132, s[12:15], s45 offen lds
    s_branch WWAIT
P_FB:
    s_load_dwordx2 s[4:5], s[0:1], 80
    s_load_dwordx2 s[6:7], s[0:1], 104
    s_waitcnt lgkmcnt(0)
    s_mov_b32 s8, s4
    s_mov_b32 s9, s5
    s_mov_b32 s10, 1966080
    s_mov_b32 s11, 0x00020000
    s_mov_b32 s12, s6
    s_mov_b32 s13, s7
    s_mov_b32 s14, 2621440
    s_mov_b32 s15, 0x00020000
    v_lshlrev_b32 v15, 4, v1
    v_lshrrev_b32 v4, 3, v1
    s_and_b32 s42, s40, 1
    s_lshl_b32 s42, s42, 3
    v_add_u32 v4, s42, v4
    v_bfe_u32 v5, v4, 1, 2
    v_bfe_u32 v6, v1, 1, 2
    v_xor_b32 v6, v6, v5
    v_and_b32 v7, 1, v1
    v_mul_u32_u24 v108, 1280, v4
    v_lshl_add_u32 v108, v6, 5, v108
    v_lshl_add_u32 v108, v7, 4, v108
    s_lshl_b32 s60, s39, 12
    s_lshl_b32 s42, s41, 10
    s_add_u32 s60, s60, s42
    s_bfe_u32 s42, s40, 0x10001
    s_mul_i32 s61, s42, 20480
    s_mul_i32 s62, s61, 3
    s_mul_i32 s63, s39, 40960
    v_lshrrev_b32 v4, 2, v2
    v_lshl_add_u32 v4, v3, 2, v4
    v_bfe_u32 v5, v4, 1, 2
    v_and_b32 v6, 3, v2
    v_mul_u32_u24 v7, 128, v4
    v_lshl_add_u32 v7, v6, 3, v7
    s_mul_i32 s42, s39, 2
    s_add_u32 s43, s42, 0
    v_xor_b32 v6, s43, v5
    v_lshl_add_u32 v104, v6, 5, v7
    v_add_u32 v106, 0x10000, v104
    s_add_u32 s43, s42, 1
    v_xor_b32 v6, s43, v5
    v_lshl_add_u32 v105, v6, 5, v7
    v_add_u32 v107, 0x10000, v105
    s_add_u32 m0, s60, 0
    s_lshl_b32 s58, s57, 7
    s_add_u32 s58, s58, s61
    s_add_u32 s58, s58, s63
    s_add_u32 s45, s58, 0
    buffer_load_dwordx4 v108, s[8:11], s45 offen lds
    s_add_u32 m0, s60, 8192
    s_add_u32 s45, s58, 81920
    buffer_load_dwordx4 v108, s[8:11], s45 offen lds
    s_add_u32 m0, s60, 16384
    s_add_u32 s45, s58, 163840
    buffer_load_dwordx4 v108, s[8:11], s45 offen lds
    s_add_u32 m0, s60, 24576
    s_add_u32 s45, s58, 245760
    buffer_load_dwordx4 v108, s[8:11], s45 offen lds
    s_add_u32 m0, s60, 32768
    s_add_u32 s45, s58, 327680
    buffer_load_dwordx4 v108, s[8:11], s45 offen lds
    s_add_u32 m0, s60, 40960
    s_add_u32 s45, s58, 409600
    buffer_load_dwordx4 v108, s[8:11], s45 offen lds
    s_add_u32 m0, s60, 49152
    s_add_u32 s45, s58, 491520
    buffer_load_dwordx4 v108, s[8:11], s45 offen lds
    s_add_u32 m0, s60, 57344
    s_add_u32 s45, s58, 573440
    buffer_load_dwordx4 v108, s[8:11], s45 offen lds
    s_add_u32 m0, s60, 65536
    s_add_u32 s45, s58, 655360
    buffer_load_dwordx4 v108, s[8:11], s45 offen lds
    s_add_u32 m0, s60, 73728
    s_add_u32 s45, s58, 737280
    buffer_load_dwordx4 v108, s[8:11], s45 offen lds
    s_add_u32 m0, s60, 81920
    s_add_u32 s45, s58, 819200
    buffer_load_dwordx4 v108, s[8:11], s45 offen lds
    s_add_u32 m0, s60, 90112
    s_add_u32 s45, s58, 901120
    buffer_load_dwordx4 v108, s[8:11], s45 offen lds
    s_add_u32 m0, s60, 98304
    s_add_u32 s45, s58, 983040
    buffer_load_dwordx4 v108, s[8:11], s45 offen lds
    s_add_u32 m0, s60, 106496
    s_add_u32 s45, s58, 1064960
    buffer_load_dwordx4 v108, s[8:11], s45 offen lds
    s_add_u32 m0, s60, 114688
    s_add_u32 s45, s58, 1146880
    buffer_load_dwordx4 v108, s[8:11], s45 offen lds
    s_add_u32 m0, s60, 122880
    s_add_u32 s45, s58, 1228800
    buffer_load_dwordx4 v108, s[8:11], s45 offen lds
    s_lshl_b32 s42, s57, 6
    s_lshl_b32 s43, s39, 5
    s_add_u32 s67, s42, s43
    s_lshl_b32 s42, s67, 2
    s_add_u32 s42, s42, 12800
    v_lshlrev_b32 v5, 4, v3
    buffer_load_dwordx4 v[200:203], v5, s[32:35], s42 offen offset:0
    buffer_load_dwordx4 v[204:207], v5, s[32:35], s42 offen offset:64
    s_branch WWAIT
P_LN1:
    s_load_dwordx2 s[4:5], s[0:1], 0
    s_waitcnt lgkmcnt(0)
    s_mov_b32 s12, s4
    s_mov_b32 s13, s5
    s_mov_b32 s14, 2621440
    s_mov_b32 s15, 0x00020000
    s_lshl_b32 s3, s56, 4
    s_lshl_b32 s42, s40, 1
    s_add_u32 s3, s3, s42
    s_mul_i32 s3, s3, 1280
    v_lshl_add_u32 v4, v1, 2, s3
    buffer_load_dword v10, v4, s[12:15], 0 offen offset:0
    buffer_load_dword v11, v4, s[12:15], 0 offen offset:256
    buffer_load_dword v12, v4, s[12:15], 0 offen offset:512
    buffer_load_dword v13, v4, s[12:15], 0 offen offset:768
    buffer_load_dword v14, v4, s[12:15], 0 offen offset:1024
    buffer_load_dword v15, v4, s[12:15], 0 offen offset:1280
    buffer_load_dword v16, v4, s[12:15], 0 offen offset:1536
    buffer_load_dword v17, v4, s[12:15], 0 offen offset:1792
    buffer_load_dword v18, v4, s[12:15], 0 offen offset:2048
    buffer_load_dword v19, v4, s[12:15], 0 offen offset:2304
    s_waitcnt vmcnt(0)
    s_mov_b32 s24, 0x3acccccd
    s_mov_b32 s25, 0x3727c5ac
    v_lshlrev_b32 v40, 16, v10
    v_and_b32 v41, 0xffff0000, v10
    v_lshlrev_b32 v42, 16, v11
    v_and_b32 v43, 0xffff0000, v11
    v_lshlrev_b32 v44, 16, v12
    v_and_b32 v45, 0xffff0000, v12
    v_lshlrev_b32 v46, 16, v13
    v_and_b32 v47, 0xffff0000, v13
    v_lshlrev_b32 v48, 16, v14
    v_and_b32 v49, 0xffff0000, v14
    v_add_f32 v30, v40, v41
    v_add_f32 v30, v30, v42
    v_add_f32 v30, v30, v43
    v_add_f32 v30, v30, v44
    v_add_f32 v30, v30, v45
    v_add_f32 v30, v30, v46
    v_add_f32 v30, v30, v47
    v_add_f32 v30, v30, v48
    v_add_f32 v30, v30, v49
    s_nop 1
    v_add_f32_dpp v30, v30, v30 row_ror:8 row_mask:0xf bank_mask:0xf
    s_nop 1
    v_add_f32_dpp v30, v30, v30 row_ror:4 row_mask:0xf bank_mask:0xf
    s_nop 1
    v_add_f32_dpp v30, v30, v30 row_ror:2 row_mask:0xf bank_mask:0xf
    s_nop 1
    v_add_f32_dpp v30, v30, v30 row_ror:1 row_mask:0xf bank_mask:0xf
    s_nop 1
    v_readlane_b32 s28, v30, 0
    v_readlane_b32 s29, v30, 16
    v_readlane_b32 s30, v30, 32
    v_readlane_b32 s31, v30, 48
    s_nop 1
    v_mov_b32 v30, s28
    v_add_f32 v30, s29, v30
    v_add_f32 v30, s30, v30
    v_add_f32 v30, s31, v30
    v_mul_f32 v30, s24, v30
    v_sub_f32 v40, v40, v30
    v_sub_f32 v41, v41, v30
    v_sub_f32 v42, v42, v30
    v_sub_f32 v43, v43, v30
    v_sub_f32 v44, v44, v30
    v_sub_f32 v45, v45, v30
    v_sub_f32 v46, v46, v30
    v_sub_f32 v47, v47, v30
    v_sub_f32 v48, v48, v30
    v_sub_f32 v49, v49, v30
    v_mul_f32 v31, v40, v40
    v_fmac_f32 v31, v41, v41
    v_fmac_f32 v31, v42, v42
    v_fmac_f32 v31, v43, v43
    v_fmac_f32 v31, v44, v44
    v_fmac_f32 v31, v45, v45
    v_fmac_f32 v31, v46, v46
    v_fmac_f32 v31, v47, v47
    v_fmac_f32 v31, v48, v48
    v_fmac_f32 v31, v49, v49
    s_nop 1
    v_add_f32_dpp v31, v31, v31 row_ror:8 row_mask:0xf bank_mask:0xf
    s_nop 1
    v_add_f32_dpp v31, v31, v31 row_ror:4 row_mask:0xf bank_mask:0xf
    s_nop 1
    v_add_f32_dpp v31, v31, v31 row_ror:2 row_mask:0xf bank_mask:0xf
    s_nop 1
    v_add_f32_dpp v31, v31, v31 row_ror:1 row_mask:0xf bank_mask:0xf
    s_nop 1
    v_readlane_b32 s28, v31, 0
    v_readlane_b32 s29, v31, 16
    v_readlane_b32 s30, v31, 32
    v_readlane_b32 s31, v31, 48
    s_nop 1
    v_mov_b32 v31, s28
    v_add_f32 v31, s29, v31
    v_add_f32 v31, s30, v31
    v_add_f32 v31, s31, v31
    v_mul_f32 v31, s24, v31
    v_add_f32 v31, s25, v31
    v_rsq_f32 v31, v31
    s_nop 0
    v_mul_f32 v40, v40, v31
    v_mul_f32 v41, v41, v31
    v_mul_f32 v42, v42, v31
    v_mul_f32 v43, v43, v31
    v_mul_f32 v44, v44, v31
    v_mul_f32 v45, v45, v31
    v_mul_f32 v46, v46, v31
    v_mul_f32 v47, v47, v31
    v_mul_f32 v48, v48, v31
    v_mul_f32 v49, v49, v31
    v_lshlrev_b32 v50, 16, v15
    v_and_b32 v51, 0xffff0000, v15
    v_lshlrev_b32 v52, 16, v16
    v_and_b32 v53, 0xffff0000, v16
    v_lshlrev_b32 v54, 16, v17
    v_and_b32 v55, 0xffff0000, v17
    v_lshlrev_b32 v56, 16, v18
    v_and_b32 v57, 0xffff0000, v18
    v_lshlrev_b32 v58, 16, v19
    v_and_b32 v59, 0xffff0000, v19
    v_add_f32 v30, v50, v51
    v_add_f32 v30, v30, v52
    v_add_f32 v30, v30, v53
    v_add_f32 v30, v30, v54
    v_add_f32 v30, v30, v55
    v_add_f32 v30, v30, v56
    v_add_f32 v30, v30, v57
    v_add_f32 v30, v30, v58
    v_add_f32 v30, v30, v59
    s_nop 1
    v_add_f32_dpp v30, v30, v30 row_ror:8 row_mask:0xf bank_mask:0xf
    s_nop 1
    v_add_f32_dpp v30, v30, v30 row_ror:4 row_mask:0xf bank_mask:0xf
    s_nop 1
    v_add_f32_dpp v30, v30, v30 row_ror:2 row_mask:0xf bank_mask:0xf
    s_nop 1
    v_add_f32_dpp v30, v30, v30 row_ror:1 row_mask:0xf bank_mask:0xf
    s_nop 1
    v_readlane_b32 s28, v30, 0
    v_readlane_b32 s29, v30, 16
    v_readlane_b32 s30, v30, 32
    v_readlane_b32 s31, v30, 48
    s_nop 1
    v_mov_b32 v30, s28
    v_add_f32 v30, s29, v30
    v_add_f32 v30, s30, v30
    v_add_f32 v30, s31, v30
    v_mul_f32 v30, s24, v30
    v_sub_f32 v50, v50, v30
    v_sub_f32 v51, v51, v30
    v_sub_f32 v52, v52, v30
    v_sub_f32 v53, v53, v30
    v_sub_f32 v54, v54, v30
    v_sub_f32 v55, v55, v30
    v_sub_f32 v56, v56, v30
    v_sub_f32 v57, v57, v30
    v_sub_f32 v58, v58, v30
    v_sub_f32 v59, v59, v30
    v_mul_f32 v31, v50, v50
    v_fmac_f32 v31, v51, v51
    v_fmac_f32 v31, v52, v52
    v_fmac_f32 v31, v53, v53
    v_fmac_f32 v31, v54, v54
    v_fmac_f32 v31, v55, v55
    v_fmac_f32 v31, v56, v56
    v_fmac_f32 v31, v57, v57
    v_fmac_f32 v31, v58, v58
    v_fmac_f32 v31, v59, v59
    s_nop 1
    v_add_f32_dpp v31, v31, v31 row_ror:8 row_mask:0xf bank_mask:0xf
    s_nop 1
    v_add_f32_dpp v31, v31, v31 row_ror:4 row_mask:0xf bank_mask:0xf
    s_nop 1
    v_add_f32_dpp v31, v31, v31 row_ror:2 row_mask:0xf bank_mask:0xf
    s_nop 1
    v_add_f32_dpp v31, v31, v31 row_ror:1 row_mask:0xf bank_mask:0xf
    s_nop 1
    v_readlane_b32 s28, v31, 0
    v_readlane_b32 s29, v31, 16
    v_readlane_b32 s30, v31, 32
    v_readlane_b32 s31, v31, 48
    s_nop 1
    v_mov_b32 v31, s28
    v_add_f32 v31, s29, v31
    v_add_f32 v31, s30, v31
    v_add_f32 v31, s31, v31
    v_mul_f32 v31, s24, v31
    v_add_f32 v31, s25, v31
    v_rsq_f32 v31, v31
    s_nop 0
    v_mul_f32 v50, v50, v31
    v_mul_f32 v51, v51, v31
    v_mul_f32 v52, v52, v31
    v_mul_f32 v53, v53, v31
    v_mul_f32 v54, v54, v31
    v_mul_f32 v55, v55, v31
    v_mul_f32 v56, v56, v31
    v_mul_f32 v57, v57, v31
    v_mul_f32 v58, v58, v31
    v_mul_f32 v59, v59, v31
    s_branch WWAIT
B_MOD:
    s_cmp_ge_u32 s56, 60
    s_cbranch_scc1 MOD_END
    s_load_dwordx2 s[4:5], s[0:1], 88
    s_load_dwordx2 s[6:7], s[0:1], 96
    s_waitcnt lgkmcnt(0)
    s_mov_b32 s12, s4
    s_mov_b32 s13, s5
    s_mov_b32 s14, 1280
    s_mov_b32 s15, 0x00020000
    s_mov_b32 s16, s6
    s_mov_b32 s17, s7
    s_mov_b32 s18, 4915200
    s_mov_b32 s19, 0x00020000
    s_mul_i32 s42, s40, 80
    v_add_u32 v5, s42, v3
    v_lshlrev_b32 v6, 2, v5
    v_mul_u32_u24 v7, 7680, v5
    s_lshl_b32 s3, s56, 7
    v_lshlrev_b32 v8, 3, v2
    v_add3_u32 v7, v7, v8, s3
    s_mov_b32 s25, 0
    buffer_load_dwordx2 v[16:17], v7, s[16:19], s25 offen
    s_add_u32 s25, s25, 30720
    buffer_load_dwordx2 v[18:19], v7, s[16:19], s25 offen
    s_add_u32 s25, s25, 30720
    buffer_load_dwordx2 v[20:21], v7, s[16:19], s25 offen
    s_add_u32 s25, s25, 30720
    buffer_load_dwordx2 v[22:23], v7, s[16:19], s25 offen
    s_add_u32 s25, s25, 30720
    buffer_load_dwordx2 v[24:25], v7, s[16:19], s25 offen
    s_add_u32 s25, s25, 30720
    buffer_load_dwordx2 v[26:27], v7, s[16:19], s25 offen
    s_add_u32 s25, s25, 30720
    buffer_load_dwordx2 v[28:29], v7, s[16:19], s25 offen
    s_add_u32 s25, s25, 30720
    buffer_load_dwordx2 v[30:31], v7, s[16:19], s25 offen
    s_add_u32 s25, s25, 30720
    buffer_load_dwordx2 v[32:33], v7, s[16:19], s25 offen
    s_add_u32 s25, s25, 30720
    buffer_load_dwordx2 v[34:35], v7, s[16:19], s25 offen
    s_add_u32 s25, s25, 30720
    buffer_load_dwordx2 v[36:37], v7, s[16:19], s25 offen
    s_add_u32 s25, s25, 30720
    buffer_load_dwordx2 v[38:39], v7, s[16:19], s25 offen
    s_add_u32 s25, s25, 30720
    buffer_load_dwordx2 v[40:41], v7, s[16:19], s25 offen
    s_add_u32 s25, s25, 30720
    buffer_load_dwordx2 v[42:43], v7, s[16:19], s25 offen
    s_add_u32 s25, s25, 30720
    buffer_load_dwordx2 v[44:45], v7, s[16:19], s25 offen
    s_add_u32 s25, s25, 30720
    buffer_load_dwordx2 v[46:47], v7, s[16:19], s25 offen
    s_add_u32 s25, s25, 30720
    buffer_load_dwordx2 v[48:49], v7, s[16:19], s25 offen
    s_add_u32 s25, s25, 30720
    buffer_load_dwordx2 v[50:51], v7, s[16:19], s25 offen
    s_add_u32 s25, s25, 30720
    buffer_load_dwordx2 v[52:53], v7, s[16:19], s25 offen
    s_add_u32 s25, s25, 30720
    buffer_load_dwordx2 v[54:55], v7, s[16:19], s25 offen
    v_lshlrev_b32 v4, 1, v0
    buffer_load_ushort v10, v4, s[12:15], 0 offen
    buffer_load_ushort v11, v4, s[12:15], 0 offen offset:1024
    s_waitcnt vmcnt(0)
    s_mov_b32 s24, 0xbfb8aa3b
    v_lshlrev_b32 v10, 16, v10
    v_mul_f32 v9, s24, v10
    v_exp_f32 v9, v9
    s_nop 0
    v_add_f32 v9, 1.0, v9
    v_rcp_f32 v9, v9
    s_nop 0
    v_mul_f32 v10, v10, v9
    v_cvt_pk_bf16_f32 v10, v10, v10
    v_lshlrev_b32 v10, 16, v10
    v_lshlrev_b32 v11, 16, v11
    v_mul_f32 v9, s24, v11
    v_exp_f32 v9, v9
    s_nop 0
    v_add_f32 v9, 1.0, v9
    v_rcp_f32 v9, v9
    s_nop 0
    v_mul_f32 v11, v11, v9
    v_cvt_pk_bf16_f32 v11, v11, v11
    v_lshlrev_b32 v11, 16, v11
    v_lshlrev_b32 v4, 2, v0
    ds_write_b32 v4, v10
    ds_write_b32 v4, v11 offset:2048
    s_waitcnt lgkmcnt(0)
    s_barrier
    v_mov_b32 v10, 0
    v_mov_b32 v11, 0
    v_mov_b32 v12, 0
    v_mov_b32 v13, 0
    ds_read_b32 v60, v6 offset:0
    ds_read_b32 v61, v6 offset:16
    ds_read_b32 v62, v6 offset:32
    ds_read_b32 v63, v6 offset:48
    ds_read_b32 v64, v6 offset:64
    ds_read_b32 v65, v6 offset:80
    ds_read_b32 v66, v6 offset:96
    ds_read_b32 v67, v6 offset:112
    s_waitcnt lgkmcnt(0)
    ds_read_b32 v68, v6 offset:128
    ds_read_b32 v69, v6 offset:144
    ds_read_b32 v70, v6 offset:160
    ds_read_b32 v71, v6 offset:176
    ds_read_b32 v72, v6 offset:192
    ds_read_b32 v73, v6 offset:208
    ds_read_b32 v74, v6 offset:224
    ds_read_b32 v75, v6 offset:240
    s_waitcnt lgkmcnt(0)
    ds_read_b32 v76, v6 offset:256
    ds_read_b32 v77, v6 offset:272
    ds_read_b32 v78, v6 offset:288
    ds_read_b32 v79, v6 offset:304
    s_waitcnt lgkmcnt(0)
    v_lshlrev_b32 v80, 16, v16
    v_and_b32 v81, 0xffff0000, v16
    v_lshlrev_b32 v82, 16, v17
    v_and_b32 v83, 0xffff0000, v17
    v_fmac_f32 v10, v60, v80
    v_fmac_f32 v11, v60, v81
    v_fmac_f32 v12, v60, v82
    v_fmac_f32 v13, v60, v83
    v_lshlrev_b32 v80, 16, v18
    v_and_b32 v81, 0xffff0000, v18
    v_lshlrev_b32 v82, 16, v19
    v_and_b32 v83, 0xffff0000, v19
    v_fmac_f32 v10, v61, v80
    v_fmac_f32 v11, v61, v81
    v_fmac_f32 v12, v61, v82
    v_fmac_f32 v13, v61, v83
    v_lshlrev_b32 v80, 16, v20
    v_and_b32 v81, 0xffff0000, v20
    v_lshlrev_b32 v82, 16, v21
    v_and_b32 v83, 0xffff0000, v21
    v_fmac_f32 v10, v62, v80
    v_fmac_f32 v11, v62, v81
    v_fmac_f32 v12, v62, v82
    v_fmac_f32 v13, v62, v83
    v_lshlrev_b32 v80, 16, v22
    v_and_b32 v81, 0xffff0000, v22
    v_lshlrev_b32 v82, 16, v23
    v_and_b32 v83, 0xffff0000, v23
    v_fmac_f32 v10, v63, v80
    v_fmac_f32 v11, v63, v81
    v_fmac_f32 v12, v63, v82
    v_fmac_f32 v13, v63, v83
    v_lshlrev_b32 v80, 16, v24
    v_and_b32 v81, 0xffff0000, v24
    v_lshlrev_b32 v82, 16, v25
    v_and_b32 v83, 0xffff0000, v25
    v_fmac_f32 v10, v64, v80
    v_fmac_f32 v11, v64, v81
    v_fmac_f32 v12, v64, v82
    v_fmac_f32 v13, v64, v83
    v_lshlrev_b32 v80, 16, v26
    v_and_b32 v81, 0xffff0000, v26
    v_lshlrev_b32 v82, 16, v27
    v_and_b32 v83, 0xffff0000, v27
    v_fmac_f32 v10, v65, v80
    v_fmac_f32 v11, v65, v81
    v_fmac_f32 v12, v65, v82
    v_fmac_f32 v13, v65, v83
    v_lshlrev_b32 v80, 16, v28
    v_and_b32 v81, 0xffff0000, v28
    v_lshlrev_b32 v82, 16, v29
    v_and_b32 v83, 0xffff0000, v29
    v_fmac_f32 v10, v66, v80
    v_fmac_f32 v11, v66, v81
    v_fmac_f32 v12, v66, v82
    v_fmac_f32 v13, v66, v83
    v_lshlrev_b32 v80, 16, v30
    v_and_b32 v81, 0xffff0000, v30
    v_lshlrev_b32 v82, 16, v31
    v_and_b32 v83, 0xffff0000, v31
    v_fmac_f32 v10, v67, v80
    v_fmac_f32 v11, v67, v81
    v_fmac_f32 v12, v67, v82
    v_fmac_f32 v13, v67, v83
    v_lshlrev_b32 v80, 16, v32
    v_and_b32 v81, 0xffff0000, v32
    v_lshlrev_b32 v82, 16, v33
    v_and_b32 v83, 0xffff0000, v33
    v_fmac_f32 v10, v68, v80
    v_fmac_f32 v11, v68, v81
    v_fmac_f32 v12, v68, v82
    v_fmac_f32 v13, v68, v83
    v_lshlrev_b32 v80, 16, v34
    v_and_b32 v81, 0xffff0000, v34
    v_lshlrev_b32 v82, 16, v35
    v_and_b32 v83, 0xffff0000, v35
    v_fmac_f32 v10, v69, v80
    v_fmac_f32 v11, v69, v81
    v_fmac_f32 v12, v69, v82
    v_fmac_f32 v13, v69, v83
    v_lshlrev_b32 v80, 16, v36
    v_and_b32 v81, 0xffff0000, v36
    v_lshlrev_b32 v82, 16, v37
    v_and_b32 v83, 0xffff0000, v37
    v_fmac_f32 v10, v70, v80
    v_fmac_f32 v11, v70, v81
    v_fmac_f32 v12, v70, v82
    v_fmac_f32 v13, v70, v83
    v_lshlrev_b32 v80, 16, v38
    v_and_b32 v81, 0xffff0000, v38
    v_lshlrev_b32 v82, 16, v39
    v_and_b32 v83, 0xffff0000, v39
    v_fmac_f32 v10, v71, v80
    v_fmac_f32 v11, v71, v81
    v_fmac_f32 v12, v71, v82
    v_fmac_f32 v13, v71, v83
    v_lshlrev_b32 v80, 16, v40
    v_and_b32 v81, 0xffff0000, v40
    v_lshlrev_b32 v82, 16, v41
    v_and_b32 v83, 0xffff0000, v41
    v_fmac_f32 v10, v72, v80
    v_fmac_f32 v11, v72, v81
    v_fmac_f32 v12, v72, v82
    v_fmac_f32 v13, v72, v83
    v_lshlrev_b32 v80, 16, v42
    v_and_b32 v81, 0xffff0000, v42
    v_lshlrev_b32 v82, 16, v43
    v_and_b32 v83, 0xffff0000, v43
    v_fmac_f32 v10, v73, v80
    v_fmac_f32 v11, v73, v81
    v_fmac_f32 v12, v73, v82
    v_fmac_f32 v13, v73, v83
    v_lshlrev_b32 v80, 16, v44
    v_and_b32 v81, 0xffff0000, v44
    v_lshlrev_b32 v82, 16, v45
    v_and_b32 v83, 0xffff0000, v45
    v_fmac_f32 v10, v74, v80
    v_fmac_f32 v11, v74, v81
    v_fmac_f32 v12, v74, v82
    v_fmac_f32 v13, v74, v83
    v_lshlrev_b32 v80, 16, v46
    v_and_b32 v81, 0xffff0000, v46
    v_lshlrev_b32 v82, 16, v47
    v_and_b32 v83, 0xffff0000, v47
    v_fmac_f32 v10, v75, v80
    v_fmac_f32 v11, v75, v81
    v_fmac_f32 v12, v75, v82
    v_fmac_f32 v13, v75, v83
    v_lshlrev_b32 v80, 16, v48
    v_and_b32 v81, 0xffff0000, v48
    v_lshlrev_b32 v82, 16, v49
    v_and_b32 v83, 0xffff0000, v49
    v_fmac_f32 v10, v76, v80
    v_fmac_f32 v11, v76, v81
    v_fmac_f32 v12, v76, v82
    v_fmac_f32 v13, v76, v83
    v_lshlrev_b32 v80, 16, v50
    v_and_b32 v81, 0xffff0000, v50
    v_lshlrev_b32 v82, 16, v51
    v_and_b32 v83, 0xffff0000, v51
    v_fmac_f32 v10, v77, v80
    v_fmac_f32 v11, v77, v81
    v_fmac_f32 v12, v77, v82
    v_fmac_f32 v13, v77, v83
    v_lshlrev_b32 v80, 16, v52
    v_and_b32 v81, 0xffff0000, v52
    v_lshlrev_b32 v82, 16, v53
    v_and_b32 v83, 0xffff0000, v53
    v_fmac_f32 v10, v78, v80
    v_fmac_f32 v11, v78, v81
    v_fmac_f32 v12, v78, v82
    v_fmac_f32 v13, v78, v83
    v_lshlrev_b32 v80, 16, v54
    v_and_b32 v81, 0xffff0000, v54
    v_lshlrev_b32 v82, 16, v55
    v_and_b32 v83, 0xffff0000, v55
    v_fmac_f32 v10, v79, v80
    v_fmac_f32 v11, v79, v81
    v_fmac_f32 v12, v79, v82
    v_fmac_f32 v13, v79, v83
    v_lshl_add_u32 v5, s40, 2, v3
    v_lshlrev_b32 v5, 8, v5
    v_lshl_add_u32 v5, v2, 4, v5
    ds_write_b128 v5, v[10:13] offset:8192
    s_waitcnt lgkmcnt(0)
    s_barrier
    s_cmp_lg_u32 s40, 0
    s_cbranch_scc1 MOD_END
    v_lshlrev_b32 v5, 2, v1
    ds_read_b32 v16, v5 offset:8192
    ds_read_b32 v17, v5 offset:8448
    ds_read_b32 v18, v5 offset:8704
    ds_read_b32 v19, v5 offset:8960
    ds_read_b32 v20, v5 offset:9216
    ds_read_b32 v21, v5 offset:9472
    ds_read_b32 v22, v5 offset:9728
    ds_read_b32 v23, v5 offset:9984
    s_waitcnt lgkmcnt(0)
    ds_read_b32 v24, v5 offset:10240
    ds_read_b32 v25, v5 offset:10496
    ds_read_b32 v26, v5 offset:10752
    ds_read_b32 v27, v5 offset:11008
    ds_read_b32 v28, v5 offset:11264
    ds_read_b32 v29, v5 offset:11520
    ds_read_b32 v30, v5 offset:11776
    ds_read_b32 v31, v5 offset:12032
    s_waitcnt lgkmcnt(0)
    ds_read_b32 v32, v5 offset:12288
    ds_read_b32 v33, v5 offset:12544
    ds_read_b32 v34, v5 offset:12800
    ds_read_b32 v35, v5 offset:13056
    ds_read_b32 v36, v5 offset:13312
    ds_read_b32 v37, v5 offset:13568
    ds_read_b32 v38, v5 offset:13824
    ds_read_b32 v39, v5 offset:14080
    s_waitcnt lgkmcnt(0)
    ds_read_b32 v40, v5 offset:14336
    ds_read_b32 v41, v5 offset:14592
    ds_read_b32 v42, v5 offset:14848
    ds_read_b32 v43, v5 offset:15104
    ds_read_b32 v44, v5 offset:15360
    ds_read_b32 v45, v5 offset:15616
    ds_read_b32 v46, v5 offset:15872
    ds_read_b32 v47, v5 offset:16128
    s_waitcnt lgkmcnt(0)
    v_add_f32 v16, v16, v17
    v_add_f32 v16, v16, v18
    v_add_f32 v16, v16, v19
    v_add_f32 v16, v16, v20
    v_add_f32 v16, v16, v21
    v_add_f32 v16, v16, v22
    v_add_f32 v16, v16, v23
    v_add_f32 v16, v16, v24
    v_add_f32 v16, v16, v25
    v_add_f32 v16, v16, v26
    v_add_f32 v16, v16, v27
    v_add_f32 v16, v16, v28
    v_add_f32 v16, v16, v29
    v_add_f32 v16, v16, v30
    v_add_f32 v16, v16, v31
    v_add_f32 v16, v16, v32
    v_add_f32 v16, v16, v33
    v_add_f32 v16, v16, v34
    v_add_f32 v16, v16, v35
    v_add_f32 v16, v16, v36
    v_add_f32 v16, v16, v37
    v_add_f32 v16, v16, v38
    v_add_f32 v16, v16, v39
    v_add_f32 v16, v16, v40
    v_add_f32 v16, v16, v41
    v_add_f32 v16, v16, v42
    v_add_f32 v16, v16, v43
    v_add_f32 v16, v16, v44
    v_add_f32 v16, v16, v45
    v_add_f32 v16, v16, v46
    v_add_f32 v16, v16, v47
    v_cvt_pk_bf16_f32 v16, v16, v16
    v_lshlrev_b32 v16, 16, v16
    s_lshl_b32 s3, s56, 8
    s_add_u32 s3, s3, 0
    buffer_store_dword v16, v5, s[32:35], s3 offen sc1
MOD_END:
    s_branch WDONE
B_T1:
    s_load_dwordx4 s[4:7], s[0:1], 16
    s_load_dwordx2 s[48:49], s[0:1], 32
    s_waitcnt lgkmcnt(0)
    s_mov_b32 s8, s4
    s_mov_b32 s9, s5
    s_mov_b32 s10, 7864320
    s_mov_b32 s11, 0x00020000
    s_mov_b32 s12, s6
    s_mov_b32 s13, s7
    s_mov_b32 s14, 7864320
    s_mov_b32 s15, 0x00020000
    s_mov_b32 s16, s48
    s_mov_b32 s17, s49
    s_mov_b32 s18, 7864320
    s_mov_b32 s19, 0x00020000
    s_add_u32 s20, s52, 1048576
    s_addc_u32 s21, s53, 0
    s_mov_b32 s22, 2621440
    s_mov_b32 s23, 0x00020000
    s_cmp_lt_u32 s40, 4
    s_cselect_b32 s24, s8, s12
    s_cselect_b32 s25, s9, s13
    s_mov_b32 s26, 7864320
    s_mov_b32 s27, 0x00020000
    s_mov_b32 s47, 0x78
    v_lshl_add_u32 v4, s40, 6, v1
    v_mul_u32_u24 v5, 2731, v4
    v_lshrrev_b32 v5, 16, v5
    v_mul_u32_u24 v6, 24, v5
    v_sub_u32 v6, v4, v6
    v_lshrrev_b32 v7, 1, v6
    v_and_b32 v6, 1, v6
    v_bfe_u32 v8, v5, 1, 1
    v_bfe_u32 v9, v5, 3, 1
    v_lshl_or_b32 v8, v9, 1, v8
    v_xor_b32 v7, v7, v8
    v_mul_u32_u24 v88, 12288, v5
    v_lshl_add_u32 v88, v7, 5, v88
    v_lshl_add_u32 v88, v6, 4, v88
    s_add_u32 s42, s41, 8
    v_lshl_add_u32 v4, s42, 6, v1
    v_mul_u32_u24 v5, 2731, v4
    v_lshrrev_b32 v5, 16, v5
    v_mul_u32_u24 v6, 24, v5
    v_sub_u32 v6, v4, v6
    v_lshrrev_b32 v7, 1, v6
    v_and_b32 v6, 1, v6
    v_bfe_u32 v8, v5, 1, 1
    v_bfe_u32 v9, v5, 3, 1
    v_lshl_or_b32 v8, v9, 1, v8
    v_xor_b32 v7, v7, v8
    v_mul_u32_u24 v89, 12288, v5
    v_lshl_add_u32 v89, v7, 5, v89
    v_lshl_add_u32 v89, v6, 4, v89
    v_lshl_add_u32 v4, s40, 6, v1
    v_lshrrev_b32 v5, 2, v4
    v_and_b32 v6, 3, v4
    v_bfe_u32 v7, v5, 2, 2
    v_lshlrev_b32 v7, 1, v7
    v_lshrrev_b32 v7, v7, s47
    v_and_b32 v7, 3, v7
    v_xor_b32 v6, v6, v7
    s_lshl_b32 s43, s56, 7
    v_add_u32 v5, s43, v5
    v_mul_u32_u24 v90, 1280, v5
    v_lshl_add_u32 v90, v6, 4, v90
    s_lshl_b32 s44, s40, 10
    s_lshl_b32 s42, s42, 10
    s_mov_b32 s60, s44
    s_add_u32 s61, s44, 12288
    s_add_u32 s62, s44, 24576
    s_add_u32 s63, s44, 36864
    s_cmp_lt_u32 s40, 4
    s_cselect_b32 s64, 0, 12288
    s_add_u32 s64, s64, s42
    s_add_u32 s65, s42, 24576
    s_mul_i32 s66, s57, 384
    s_mov_b32 s67, 0
    v_lshrrev_b32 v4, 2, v2
    v_lshlrev_b32 v4, 1, v4
    v_lshrrev_b32 v4, v4, s47
    v_and_b32 v4, 3, v4
    v_xor_b32 v4, v4, v3
    v_lshl_add_u32 v5, s39, 6, v2
    v_lshlrev_b32 v5, 6, v5
    v_lshl_add_u32 v5, v4, 4, v5
    v_add_u32 v91, 36864, v5
    v_lshrrev_b32 v4, 2, v2
    v_lshl_add_u32 v5, v3, 3, v4
    v_lshrrev_b32 v6, 1, v4
    v_and_b32 v7, 1, v3
    v_lshl_or_b32 v6, v7, 1, v6
    v_and_b32 v7, 3, v2
    v_mul_u32_u24 v8, 384, v5
    v_lshl_add_u32 v8, v7, 3, v8
    s_mul_i32 s42, s41, 3
    s_add_u32 s43, s42, 0
    v_xor_b32 v9, s43, v6
    v_lshl_add_u32 v92, v9, 5, v8
    s_add_u32 s43, s42, 1
    v_xor_b32 v9, s43, v6
    v_lshl_add_u32 v93, v9, 5, v8
    s_add_u32 s43, s42, 2
    v_xor_b32 v9, s43, v6
    v_lshl_add_u32 v94, v9, 5, v8
    v_lshlrev_b32 v15, 4, v1
    v_mov_b32 v112, 0
    v_mov_b32 v113, 0
    v_mov_b32 v114, 0
    v_mov_b32 v115, 0
    v_mov_b32 v116, 0
    v_mov_b32 v117, 0
    v_mov_b32 v118, 0
    v_mov_b32 v119, 0
    v_mov_b32 v120, 0
    v_mov_b32 v121, 0
    v_mov_b32 v122, 0
    v_mov_b32 v123, 0
    v_mov_b32 v124, 0
    v_mov_b32 v125, 0
    v_mov_b32 v126, 0
    v_mov_b32 v127, 0
    v_mov_b32 v128, 0
    v_mov_b32 v129, 0
    v_mov_b32 v130, 0
    v_mov_b32 v131, 0
    v_mov_b32 v132, 0
    v_mov_b32 v133, 0
    v_mov_b32 v134, 0
    v_mov_b32 v135, 0
    v_mov_b32 v136, 0
    v_mov_b32 v137, 0
    v_mov_b32 v138, 0
    v_mov_b32 v139, 0
    v_mov_b32 v140, 0
    v_mov_b32 v141, 0
    v_mov_b32 v142, 0
    v_mov_b32 v143, 0
    v_mov_b32 v144, 0
    v_mov_b32 v145, 0
    v_mov_b32 v146, 0
    v_mov_b32 v147, 0
    v_mov_b32 v148, 0
    v_mov_b32 v149, 0
    v_mov_b32 v150, 0
    v_mov_b32 v151, 0
    v_mov_b32 v152, 0
    v_mov_b32 v153, 0
    v_mov_b32 v154, 0
    v_mov_b32 v155, 0
    v_mov_b32 v156, 0
    v_mov_b32 v157, 0
    v_mov_b32 v158, 0
    v_mov_b32 v159, 0
    v_mov_b32 v160, 0
    v_mov_b32 v161, 0
    v_mov_b32 v162, 0
    v_mov_b32 v163, 0
    v_mov_b32 v164, 0
    v_mov_b32 v165, 0
    v_mov_b32 v166, 0
    v_mov_b32 v167, 0
    v_mov_b32 v168, 0
    v_mov_b32 v169, 0
    v_mov_b32 v170, 0
    v_mov_b32 v171, 0
    v_mov_b32 v172, 0
    v_mov_b32 v173, 0
    v_mov_b32 v174, 0
    v_mov_b32 v175, 0
    v_mov_b32 v176, 0
    v_mov_b32 v177, 0
    v_mov_b32 v178, 0
    v_mov_b32 v179, 0
    v_mov_b32 v180, 0
    v_mov_b32 v181, 0
    v_mov_b32 v182, 0
    v_mov_b32 v183, 0
    v_mov_b32 v184, 0
    v_mov_b32 v185, 0
    v_mov_b32 v186, 0
    v_mov_b32 v187, 0
    v_mov_b32 v188, 0
    v_mov_b32 v189, 0
    v_mov_b32 v190, 0
    v_mov_b32 v191, 0
    v_mov_b32 v192, 0
    v_mov_b32 v193, 0
    v_mov_b32 v194, 0
    v_mov_b32 v195, 0
    v_mov_b32 v196, 0
    v_mov_b32 v197, 0
    v_mov_b32 v198, 0
    v_mov_b32 v199, 0
    v_mov_b32 v200, 0
    v_mov_b32 v201, 0
    v_mov_b32 v202, 0
    v_mov_b32 v203, 0
    v_mov_b32 v204, 0
    v_mov_b32 v205, 0
    v_mov_b32 v206, 0
    v_mov_b32 v207, 0
    v_mov_b32 v208, 0
    v_mov_b32 v209, 0
    v_mov_b32 v210, 0
    v_mov_b32 v211, 0
    v_mov_b32 v212, 0
    v_mov_b32 v213, 0
    v_mov_b32 v214, 0
    v_mov_b32 v215, 0
    v_mov_b32 v216, 0
    v_mov_b32 v217, 0
    v_mov_b32 v218, 0
    v_mov_b32 v219, 0
    v_mov_b32 v220, 0
    v_mov_b32 v221, 0
    v_mov_b32 v222, 0
    v_mov_b32 v223, 0
    v_mov_b32 v224, 0
    v_mov_b32 v225, 0
    v_mov_b32 v226, 0
    v_mov_b32 v227, 0
    v_mov_b32 v228, 0
    v_mov_b32 v229, 0
    v_mov_b32 v230, 0
    v_mov_b32 v231, 0
    v_mov_b32 v232, 0
    v_mov_b32 v233, 0
    v_mov_b32 v234, 0
    v_mov_b32 v235, 0
    v_mov_b32 v236, 0
    v_mov_b32 v237, 0
    v_mov_b32 v238, 0
    v_mov_b32 v239, 0
    v_mov_b32 v240, 0
    v_mov_b32 v241, 0
    v_mov_b32 v242, 0
    v_mov_b32 v243, 0
    v_mov_b32 v244, 0
    v_mov_b32 v245, 0
    v_mov_b32 v246, 0
    v_mov_b32 v247, 0
    v_mov_b32 v248, 0
    v_mov_b32 v249, 0
    v_mov_b32 v250, 0
    v_mov_b32 v251, 0
    v_mov_b32 v252, 0
    v_mov_b32 v253, 0
    v_mov_b32 v254, 0
    v_mov_b32 v255, 0
    s_mov_b32 s70, 0
    s_add_u32 m0, s60, s70
    s_nop 0
    buffer_load_dwordx4 v88, s[8:11], s66 offen lds
    s_add_u32 m0, s61, s70
    s_nop 0
    buffer_load_dwordx4 v88, s[12:15], s66 offen lds
    s_add_u32 m0, s62, s70
    s_nop 0
    buffer_load_dwordx4 v88, s[16:19], s66 offen lds
    s_add_u32 m0, s63, s70
    s_nop 0
    buffer_load_dwordx4 v90, s[20:23], s67 offen lds
    s_add_u32 m0, s64, s70
    s_nop 0
    buffer_load_dwordx4 v89, s[24:27], s66 offen lds
    s_add_u32 m0, s65, s70
    s_nop 0
    buffer_load_dwordx4 v89, s[16:19], s66 offen lds
    s_add_u32 s66, s66, 393216
    s_add_u32 s67, s67, 64
    s_mov_b32 s70, 45056
    s_add_u32 m0, s60, s70
    s_nop 0
    buffer_load_dwordx4 v88, s[8:11], s66 offen lds
    s_add_u32 m0, s61, s70
    s_nop 0
    buffer_load_dwordx4 v88, s[12:15], s66 offen lds
    s_add_u32 m0, s62, s70
    s_nop 0
    buffer_load_dwordx4 v88, s[16:19], s66 offen lds
    s_add_u32 m0, s63, s70
    s_nop 0
    buffer_load_dwordx4 v90, s[20:23], s67 offen lds
    s_add_u32 m0, s64, s70
    s_nop 0
    buffer_load_dwordx4 v89, s[24:27], s66 offen lds
    s_add_u32 m0, s65, s70
    s_nop 0
    buffer_load_dwordx4 v89, s[16:19], s66 offen lds
    s_add_u32 s66, s66, 393216
    s_add_u32 s67, s67, 64
    s_mov_b32 s70, 90112
    s_add_u32 m0, s60, s70
    s_nop 0
    buffer_load_dwordx4 v88, s[8:11], s66 offen lds
    s_add_u32 m0, s61, s70
    s_nop 0
    buffer_load_dwordx4 v88, s[12:15], s66 offen lds
    s_add_u32 m0, s62, s70
    s_nop 0
    buffer_load_dwordx4 v88, s[16:19], s66 offen lds
    s_add_u32 m0, s63, s70
    s_nop 0
    buffer_load_dwordx4 v90, s[20:23], s67 offen lds
    s_add_u32 m0, s64, s70
    s_nop 0
    buffer_load_dwordx4 v89, s[24:27], s66 offen lds
    s_add_u32 m0, s65, s70
    s_nop 0
    buffer_load_dwordx4 v89, s[16:19], s66 offen lds
    s_add_u32 s66, s66, 393216
    s_add_u32 s67, s67, 64
    s_waitcnt vmcnt(12)
    s_barrier
    v_add_u32 v95, 0, v91
    v_add_u32 v96, 0, v92
    v_add_u32 v97, 0, v93
    v_add_u32 v98, 0, v94
    ds_read_b128 v[16:19], v95 offset:0
    ds_read_b128 v[20:23], v95 offset:1024
    ds_read_b128 v[24:27], v95 offset:2048
    ds_read_b128 v[28:31], v95 offset:3072
    ds_read_b64_tr_b16 v[48:49], v96 offset:0
    ds_read_b64_tr_b16 v[50:51], v96 offset:1536
    ds_read_b64_tr_b16 v[52:53], v97 offset:0
    ds_read_b64_tr_b16 v[54:55], v97 offset:1536
    ds_read_b64_tr_b16 v[56:57], v98 offset:0
    ds_read_b64_tr_b16 v[58:59], v98 offset:1536
    ds_read_b64_tr_b16 v[60:61], v96 offset:12288
    ds_read_b64_tr_b16 v[62:63], v96 offset:13824
    ds_read_b64_tr_b16 v[64:65], v97 offset:12288
    ds_read_b64_tr_b16 v[66:67], v97 offset:13824
    ds_read_b64_tr_b16 v[68:69], v98 offset:12288
    ds_read_b64_tr_b16 v[70:71], v98 offset:13824
    ds_read_b64_tr_b16 v[72:73], v96 offset:24576
    ds_read_b64_tr_b16 v[74:75], v96 offset:26112
    ds_read_b64_tr_b16 v[76:77], v97 offset:24576
    ds_read_b64_tr_b16 v[78:79], v97 offset:26112
    ds_read_b64_tr_b16 v[80:81], v98 offset:24576
    ds_read_b64_tr_b16 v[82:83], v98 offset:26112
    s_mov_b32 s70, 0
    s_mov_b32 s71, 45056
    s_mov_b32 s72, 0
T1_LOOP:
    s_waitcnt lgkmcnt(14)
    v_mfma_f32_16x16x32_bf16 v[112:115], v[48:51], v[16:19], v[112:115]
    v_mfma_f32_16x16x32_bf16 v[116:119], v[48:51], v[20:23], v[116:119]
    v_mfma_f32_16x16x32_bf16 v[120:123], v[48:51], v[24:27], v[120:123]
    v_mfma_f32_16x16x32_bf16 v[124:127], v[48:51], v[28:31], v[124:127]
    s_waitcnt lgkmcnt(12)
    v_mfma_f32_16x16x32_bf16 v[128:131], v[52:55], v[16:19], v[128:131]
    v_mfma_f32_16x16x32_bf16 v[132:135], v[52:55], v[20:23], v[132:135]
    v_mfma_f32_16x16x32_bf16 v[136:139], v[52:55], v[24:27], v[136:139]
    v_mfma_f32_16x16x32_bf16 v[140:143], v[52:55], v[28:31], v[140:143]
    s_waitcnt vmcnt(6) lgkmcnt(0)
    s_barrier
    v_add_u32 v95, s71, v91
    v_add_u32 v96, s71, v92
    v_add_u32 v97, s71, v93
    v_add_u32 v98, s71, v94
    ds_read_b128 v[32:35], v95 offset:0
    ds_read_b128 v[36:39], v95 offset:1024
    ds_read_b128 v[40:43], v95 offset:2048
    ds_read_b128 v[44:47], v95 offset:3072
    ds_read_b64_tr_b16 v[48:49], v96 offset:0
    ds_read_b64_tr_b16 v[50:51], v96 offset:1536
    ds_read_b64_tr_b16 v[52:53], v97 offset:0
    ds_read_b64_tr_b16 v[54:55], v97 offset:1536
    v_mfma_f32_16x16x32_bf16 v[144:147], v[56:59], v[16:19], v[144:147]
    v_mfma_f32_16x16x32_bf16 v[148:151], v[56:59], v[20:23], v[148:151]
    v_mfma_f32_16x16x32_bf16 v[152:155], v[56:59], v[24:27], v[152:155]
    v_mfma_f32_16x16x32_bf16 v[156:159], v[56:59], v[28:31], v[156:159]
    ds_read_b64_tr_b16 v[56:57], v98 offset:0
    ds_read_b64_tr_b16 v[58:59], v98 offset:1536
    s_add_u32 m0, s60, s70
    s_nop 0
    buffer_load_dwordx4 v88, s[8:11], s66 offen lds
    v_mfma_f32_16x16x32_bf16 v[160:163], v[60:63], v[16:19], v[160:163]
    v_mfma_f32_16x16x32_bf16 v[164:167], v[60:63], v[20:23], v[164:167]
    v_mfma_f32_16x16x32_bf16 v[168:171], v[60:63], v[24:27], v[168:171]
    v_mfma_f32_16x16x32_bf16 v[172:175], v[60:63], v[28:31], v[172:175]
    ds_read_b64_tr_b16 v[60:61], v96 offset:12288
    ds_read_b64_tr_b16 v[62:63], v96 offset:13824
    s_add_u32 m0, s61, s70
    s_nop 0
    buffer_load_dwordx4 v88, s[12:15], s66 offen lds
    v_mfma_f32_16x16x32_bf16 v[176:179], v[64:67], v[16:19], v[176:179]
    v_mfma_f32_16x16x32_bf16 v[180:183], v[64:67], v[20:23], v[180:183]
    v_mfma_f32_16x16x32_bf16 v[184:187], v[64:67], v[24:27], v[184:187]
    v_mfma_f32_16x16x32_bf16 v[188:191], v[64:67], v[28:31], v[188:191]
    ds_read_b64_tr_b16 v[64:65], v97 offset:12288
    ds_read_b64_tr_b16 v[66:67], v97 offset:13824
    s_add_u32 m0, s62, s70
    s_nop 0
    buffer_load_dwordx4 v88, s[16:19], s66 offen lds
    v_mfma_f32_16x16x32_bf16 v[192:195], v[68:71], v[16:19], v[192:195]
    v_mfma_f32_16x16x32_bf16 v[196:199], v[68:71], v[20:23], v[196:199]
    v_mfma_f32_16x16x32_bf16 v[200:203], v[68:71], v[24:27], v[200:203]
    v_mfma_f32_16x16x32_bf16 v[204:207], v[68:71], v[28:31], v[204:207]
    ds_read_b64_tr_b16 v[68:69], v98 offset:12288
    ds_read_b64_tr_b16 v[70:71], v98 offset:13824
    s_add_u32 m0, s63, s70
    s_nop 0
    buffer_load_dwordx4 v90, s[20:23], s67 offen lds
    v_mfma_f32_16x16x32_bf16 v[208:211], v[72:75], v[16:19], v[208:211]
    v_mfma_f32_16x16x32_bf16 v[212:215], v[72:75], v[20:23], v[212:215]
    v_mfma_f32_16x16x32_bf16 v[216:219], v[72:75], v[24:27], v[216:219]
    v_mfma_f32_16x16x32_bf16 v[220:223], v[72:75], v[28:31], v[220:223]
    ds_read_b64_tr_b16 v[72:73], v96 offset:24576
    ds_read_b64_tr_b16 v[74:75], v96 offset:26112
    s_add_u32 m0, s64, s70
    s_nop 0
    buffer_load_dwordx4 v89, s[24:27], s66 offen lds
    v_mfma_f32_16x16x32_bf16 v[224:227], v[76:79], v[16:19], v[224:227]
    v_mfma_f32_16x16x32_bf16 v[228:231], v[76:79], v[20:23], v[228:231]
    v_mfma_f32_16x16x32_bf16 v[232:235], v[76:79], v[24:27], v[232:235]
    v_mfma_f32_16x16x32_bf16 v[236:239], v[76:79], v[28:31], v[236:239]
    ds_read_b64_tr_b16 v[76:77], v97 offset:24576
    ds_read_b64_tr_b16 v[78:79], v97 offset:26112
    s_add_u32 m0, s65, s70
    s_nop 0
    buffer_load_dwordx4 v89, s[16:19], s66 offen lds
    s_add_u32 s66, s66, 393216
    s_add_u32 s67, s67, 64
    v_mfma_f32_16x16x32_bf16 v[240:243], v[80:83], v[16:19], v[240:243]
    v_mfma_f32_16x16x32_bf16 v[244:247], v[80:83], v[20:23], v[244:247]
    v_mfma_f32_16x16x32_bf16 v[248:251], v[80:83], v[24:27], v[248:251]
    v_mfma_f32_16x16x32_bf16 v[252:255], v[80:83], v[28:31], v[252:255]
    ds_read_b64_tr_b16 v[80:81], v98 offset:24576
    ds_read_b64_tr_b16 v[82:83], v98 offset:26112
    s_mov_b32 s70, s71
    s_add_u32 s71, s71, 45056
    s_cmp_eq_u32 s71, 135168
    s_cselect_b32 s71, 0, s71
    s_waitcnt lgkmcnt(14)
    v_mfma_f32_16x16x32_bf16 v[112:115], v[48:51], v[32:35], v[112:115]
    v_mfma_f32_16x16x32_bf16 v[116:119], v[48:51], v[36:39], v[116:119]
    v_mfma_f32_16x16x32_bf16 v[120:123], v[48:51], v[40:43], v[120:123]
    v_mfma_f32_16x16x32_bf16 v[124:127], v[48:51], v[44:47], v[124:127]
    s_waitcnt lgkmcnt(12)
    v_mfma_f32_16x16x32_bf16 v[128:131], v[52:55], v[32:35], v[128:131]
    v_mfma_f32_16x16x32_bf16 v[132:135], v[52:55], v[36:39], v[132:135]
    v_mfma_f32_16x16x32_bf16 v[136:139], v[52:55], v[40:43], v[136:139]
    v_mfma_f32_16x16x32_bf16 v[140:143], v[52:55], v[44:47], v[140:143]
    s_waitcnt vmcnt(6) lgkmcnt(0)
    s_barrier
    v_add_u32 v95, s71, v91
    v_add_u32 v96, s71, v92
    v_add_u32 v97, s71, v93
    v_add_u32 v98, s71, v94
    ds_read_b128 v[16:19], v95 offset:0
    ds_read_b128 v[20:23], v95 offset:1024
    ds_read_b128 v[24:27], v95 offset:2048
    ds_read_b128 v[28:31], v95 offset:3072
    ds_read_b64_tr_b16 v[48:49], v96 offset:0
    ds_read_b64_tr_b16 v[50:51], v96 offset:1536
    ds_read_b64_tr_b16 v[52:53], v97 offset:0
    ds_read_b64_tr_b16 v[54:55], v97 offset:1536
    v_mfma_f32_16x16x32_bf16 v[144:147], v[56:59], v[32:35], v[144:147]
    v_mfma_f32_16x16x32_bf16 v[148:151], v[56:59], v[36:39], v[148:151]
    v_mfma_f32_16x16x32_bf16 v[152:155], v[56:59], v[40:43], v[152:155]
    v_mfma_f32_16x16x32_bf16 v[156:159], v[56:59], v[44:47], v[156:159]
    ds_read_b64_tr_b16 v[56:57], v98 offset:0
    ds_read_b64_tr_b16 v[58:59], v98 offset:1536
    s_add_u32 m0, s60, s70
    s_nop 0
    buffer_load_dwordx4 v88, s[8:11], s66 offen lds
    v_mfma_f32_16x16x32_bf16 v[160:163], v[60:63], v[32:35], v[160:163]
    v_mfma_f32_16x16x32_bf16 v[164:167], v[60:63], v[36:39], v[164:167]
    v_mfma_f32_16x16x32_bf16 v[168:171], v[60:63], v[40:43], v[168:171]
    v_mfma_f32_16x16x32_bf16 v[172:175], v[60:63], v[44:47], v[172:175]
    ds_read_b64_tr_b16 v[60:61], v96 offset:12288
    ds_read_b64_tr_b16 v[62:63], v96 offset:13824
    s_add_u32 m0, s61, s70
    s_nop 0
    buffer_load_dwordx4 v88, s[12:15], s66 offen lds
    v_mfma_f32_16x16x32_bf16 v[176:179], v[64:67], v[32:35], v[176:179]
    v_mfma_f32_16x16x32_bf16 v[180:183], v[64:67], v[36:39], v[180:183]
    v_mfma_f32_16x16x32_bf16 v[184:187], v[64:67], v[40:43], v[184:187]
    v_mfma_f32_16x16x32_bf16 v[188:191], v[64:67], v[44:47], v[188:191]
    ds_read_b64_tr_b16 v[64:65], v97 offset:12288
    ds_read_b64_tr_b16 v[66:67], v97 offset:13824
    s_add_u32 m0, s62, s70
    s_nop 0
    buffer_load_dwordx4 v88, s[16:19], s66 offen lds
    v_mfma_f32_16x16x32_bf16 v[192:195], v[68:71], v[32:35], v[192:195]
    v_mfma_f32_16x16x32_bf16 v[196:199], v[68:71], v[36:39], v[196:199]
    v_mfma_f32_16x16x32_bf16 v[200:203], v[68:71], v[40:43], v[200:203]
    v_mfma_f32_16x16x32_bf16 v[204:207], v[68:71], v[44:47], v[204:207]
    ds_read_b64_tr_b16 v[68:69], v98 offset:12288
    ds_read_b64_tr_b16 v[70:71], v98 offset:13824
    s_add_u32 m0, s63, s70
    s_nop 0
    buffer_load_dwordx4 v90, s[20:23], s67 offen lds
    v_mfma_f32_16x16x32_bf16 v[208:211], v[72:75], v[32:35], v[208:211]
    v_mfma_f32_16x16x32_bf16 v[212:215], v[72:75], v[36:39], v[212:215]
    v_mfma_f32_16x16x32_bf16 v[216:219], v[72:75], v[40:43], v[216:219]
    v_mfma_f32_16x16x32_bf16 v[220:223], v[72:75], v[44:47], v[220:223]
    ds_read_b64_tr_b16 v[72:73], v96 offset:24576
    ds_read_b64_tr_b16 v[74:75], v96 offset:26112
    s_add_u32 m0, s64, s70
    s_nop 0
    buffer_load_dwordx4 v89, s[24:27], s66 offen lds
    v_mfma_f32_16x16x32_bf16 v[224:227], v[76:79], v[32:35], v[224:227]
    v_mfma_f32_16x16x32_bf16 v[228:231], v[76:79], v[36:39], v[228:231]
    v_mfma_f32_16x16x32_bf16 v[232:235], v[76:79], v[40:43], v[232:235]
    v_mfma_f32_16x16x32_bf16 v[236:239], v[76:79], v[44:47], v[236:239]
    ds_read_b64_tr_b16 v[76:77], v97 offset:24576
    ds_read_b64_tr_b16 v[78:79], v97 offset:26112
    s_add_u32 m0, s65, s70
    s_nop 0
    buffer_load_dwordx4 v89, s[16:19], s66 offen lds
    s_add_u32 s66, s66, 393216
    s_add_u32 s67, s67, 64
    v_mfma_f32_16x16x32_bf16 v[240:243], v[80:83], v[32:35], v[240:243]
    v_mfma_f32_16x16x32_bf16 v[244:247], v[80:83], v[36:39], v[244:247]
    v_mfma_f32_16x16x32_bf16 v[248:251], v[80:83], v[40:43], v[248:251]
    v_mfma_f32_16x16x32_bf16 v[252:255], v[80:83], v[44:47], v[252:255]
    ds_read_b64_tr_b16 v[80:81], v98 offset:24576
    ds_read_b64_tr_b16 v[82:83], v98 offset:26112
    s_mov_b32 s70, s71
    s_add_u32 s71, s71, 45056
    s_cmp_eq_u32 s71, 135168
    s_cselect_b32 s71, 0, s71
    s_add_u32 s72, s72, 1
    s_cmp_lt_u32 s72, 8
    s_cbranch_scc1 T1_LOOP
    s_waitcnt lgkmcnt(14)
    v_mfma_f32_16x16x32_bf16 v[112:115], v[48:51], v[16:19], v[112:115]
    v_mfma_f32_16x16x32_bf16 v[116:119], v[48:51], v[20:23], v[116:119]
    v_mfma_f32_16x16x32_bf16 v[120:123], v[48:51], v[24:27], v[120:123]
    v_mfma_f32_16x16x32_bf16 v[124:127], v[48:51], v[28:31], v[124:127]
    s_waitcnt lgkmcnt(12)
    v_mfma_f32_16x16x32_bf16 v[128:131], v[52:55], v[16:19], v[128:131]
    v_mfma_f32_16x16x32_bf16 v[132:135], v[52:55], v[20:23], v[132:135]
    v_mfma_f32_16x16x32_bf16 v[136:139], v[52:55], v[24:27], v[136:139]
    v_mfma_f32_16x16x32_bf16 v[140:143], v[52:55], v[28:31], v[140:143]
    s_waitcnt vmcnt(6) lgkmcnt(0)
    s_barrier
    v_add_u32 v95, s71, v91
    v_add_u32 v96, s71, v92
    v_add_u32 v97, s71, v93
    v_add_u32 v98, s71, v94
    ds_read_b128 v[32:35], v95 offset:0
    ds_read_b128 v[36:39], v95 offset:1024
    ds_read_b128 v[40:43], v95 offset:2048
    ds_read_b128 v[44:47], v95 offset:3072
    ds_read_b64_tr_b16 v[48:49], v96 offset:0
    ds_read_b64_tr_b16 v[50:51], v96 offset:1536
    ds_read_b64_tr_b16 v[52:53], v97 offset:0
    ds_read_b64_tr_b16 v[54:55], v97 offset:1536
    v_mfma_f32_16x16x32_bf16 v[144:147], v[56:59], v[16:19], v[144:147]
    v_mfma_f32_16x16x32_bf16 v[148:151], v[56:59], v[20:23], v[148:151]
    v_mfma_f32_16x16x32_bf16 v[152:155], v[56:59], v[24:27], v[152:155]
    v_mfma_f32_16x16x32_bf16 v[156:159], v[56:59], v[28:31], v[156:159]
    ds_read_b64_tr_b16 v[56:57], v98 offset:0
    ds_read_b64_tr_b16 v[58:59], v98 offset:1536
    s_add_u32 m0, s60, s70
    s_nop 0
    buffer_load_dwordx4 v88, s[8:11], s66 offen lds
    v_mfma_f32_16x16x32_bf16 v[160:163], v[60:63], v[16:19], v[160:163]
    v_mfma_f32_16x16x32_bf16 v[164:167], v[60:63], v[20:23], v[164:167]
    v_mfma_f32_16x16x32_bf16 v[168:171], v[60:63], v[24:27], v[168:171]
    v_mfma_f32_16x16x32_bf16 v[172:175], v[60:63], v[28:31], v[172:175]
    ds_read_b64_tr_b16 v[60:61], v96 offset:12288
    ds_read_b64_tr_b16 v[62:63], v96 offset:13824
    s_add_u32 m0, s61, s70
    s_nop 0
    buffer_load_dwordx4 v88, s[12:15], s66 offen lds
    v_mfma_f32_16x16x32_bf16 v[176:179], v[64:67], v[16:19], v[176:179]
    v_mfma_f32_16x16x32_bf16 v[180:183], v[64:67], v[20:23], v[180:183]
    v_mfma_f32_16x16x32_bf16 v[184:187], v[64:67], v[24:27], v[184:187]
    v_mfma_f32_16x16x32_bf16 v[188:191], v[64:67], v[28:31], v[188:191]
    ds_read_b64_tr_b16 v[64:65], v97 offset:12288
    ds_read_b64_tr_b16 v[66:67], v97 offset:13824
    s_add_u32 m0, s62, s70
    s_nop 0
    buffer_load_dwordx4 v88, s[16:19], s66 offen lds
    v_mfma_f32_16x16x32_bf16 v[192:195], v[68:71], v[16:19], v[192:195]
    v_mfma_f32_16x16x32_bf16 v[196:199], v[68:71], v[20:23], v[196:199]
    v_mfma_f32_16x16x32_bf16 v[200:203], v[68:71], v[24:27], v[200:203]
    v_mfma_f32_16x16x32_bf16 v[204:207], v[68:71], v[28:31], v[204:207]
    ds_read_b64_tr_b16 v[68:69], v98 offset:12288
    ds_read_b64_tr_b16 v[70:71], v98 offset:13824
    s_add_u32 m0, s63, s70
    s_nop 0
    buffer_load_dwordx4 v90, s[20:23], s67 offen lds
    v_mfma_f32_16x16x32_bf16 v[208:211], v[72:75], v[16:19], v[208:211]
    v_mfma_f32_16x16x32_bf16 v[212:215], v[72:75], v[20:23], v[212:215]
    v_mfma_f32_16x16x32_bf16 v[216:219], v[72:75], v[24:27], v[216:219]
    v_mfma_f32_16x16x32_bf16 v[220:223], v[72:75], v[28:31], v[220:223]
    ds_read_b64_tr_b16 v[72:73], v96 offset:24576
    ds_read_b64_tr_b16 v[74:75], v96 offset:26112
    s_add_u32 m0, s64, s70
    s_nop 0
    buffer_load_dwordx4 v89, s[24:27], s66 offen lds
    v_mfma_f32_16x16x32_bf16 v[224:227], v[76:79], v[16:19], v[224:227]
    v_mfma_f32_16x16x32_bf16 v[228:231], v[76:79], v[20:23], v[228:231]
    v_mfma_f32_16x16x32_bf16 v[232:235], v[76:79], v[24:27], v[232:235]
    v_mfma_f32_16x16x32_bf16 v[236:239], v[76:79], v[28:31], v[236:239]
    ds_read_b64_tr_b16 v[76:77], v97 offset:24576
    ds_read_b64_tr_b16 v[78:79], v97 offset:26112
    s_add_u32 m0, s65, s70
    s_nop 0
    buffer_load_dwordx4 v89, s[16:19], s66 offen lds
    s_add_u32 s66, s66, 393216
    s_add_u32 s67, s67, 64
    v_mfma_f32_16x16x32_bf16 v[240:243], v[80:83], v[16:19], v[240:243]
    v_mfma_f32_16x16x32_bf16 v[244:247], v[80:83], v[20:23], v[244:247]
    v_mfma_f32_16x16x32_bf16 v[248:251], v[80:83], v[24:27], v[248:251]
    v_mfma_f32_16x16x32_bf16 v[252:255], v[80:83], v[28:31], v[252:255]
    ds_read_b64_tr_b16 v[80:81], v98 offset:24576
    ds_read_b64_tr_b16 v[82:83], v98 offset:26112
    s_mov_b32 s70, s71
    s_add_u32 s71, s71, 45056
    s_cmp_eq_u32 s71, 135168
    s_cselect_b32 s71, 0, s71
    s_waitcnt lgkmcnt(14)
    v_mfma_f32_16x16x32_bf16 v[112:115], v[48:51], v[32:35], v[112:115]
    v_mfma_f32_16x16x32_bf16 v[116:119], v[48:51], v[36:39], v[116:119]
    v_mfma_f32_16x16x32_bf16 v[120:123], v[48:51], v[40:43], v[120:123]
    v_mfma_f32_16x16x32_bf16 v[124:127], v[48:51], v[44:47], v[124:127]
    s_waitcnt lgkmcnt(12)
    v_mfma_f32_16x16x32_bf16 v[128:131], v[52:55], v[32:35], v[128:131]
    v_mfma_f32_16x16x32_bf16 v[132:135], v[52:55], v[36:39], v[132:135]
    v_mfma_f32_16x16x32_bf16 v[136:139], v[52:55], v[40:43], v[136:139]
    v_mfma_f32_16x16x32_bf16 v[140:143], v[52:55], v[44:47], v[140:143]
    s_waitcnt vmcnt(6) lgkmcnt(0)
    s_barrier
    v_add_u32 v95, s71, v91
    v_add_u32 v96, s71, v92
    v_add_u32 v97, s71, v93
    v_add_u32 v98, s71, v94
    ds_read_b128 v[16:19], v95 offset:0
    ds_read_b128 v[20:23], v95 offset:1024
    ds_read_b128 v[24:27], v95 offset:2048
    ds_read_b128 v[28:31], v95 offset:3072
    ds_read_b64_tr_b16 v[48:49], v96 offset:0
    ds_read_b64_tr_b16 v[50:51], v96 offset:1536
    ds_read_b64_tr_b16 v[52:53], v97 offset:0
    ds_read_b64_tr_b16 v[54:55], v97 offset:1536
    v_mfma_f32_16x16x32_bf16 v[144:147], v[56:59], v[32:35], v[144:147]
    v_mfma_f32_16x16x32_bf16 v[148:151], v[56:59], v[36:39], v[148:151]
    v_mfma_f32_16x16x32_bf16 v[152:155], v[56:59], v[40:43], v[152:155]
    v_mfma_f32_16x16x32_bf16 v[156:159], v[56:59], v[44:47], v[156:159]
    ds_read_b64_tr_b16 v[56:57], v98 offset:0
    ds_read_b64_tr_b16 v[58:59], v98 offset:1536
    v_mfma_f32_16x16x32_bf16 v[160:163], v[60:63], v[32:35], v[160:163]
    v_mfma_f32_16x16x32_bf16 v[164:167], v[60:63], v[36:39], v[164:167]
    v_mfma_f32_16x16x32_bf16 v[168:171], v[60:63], v[40:43], v[168:171]
    v_mfma_f32_16x16x32_bf16 v[172:175], v[60:63], v[44:47], v[172:175]
    ds_read_b64_tr_b16 v[60:61], v96 offset:12288
    ds_read_b64_tr_b16 v[62:63], v96 offset:13824
    v_mfma_f32_16x16x32_bf16 v[176:179], v[64:67], v[32:35], v[176:179]
    v_mfma_f32_16x16x32_bf16 v[180:183], v[64:67], v[36:39], v[180:183]
    v_mfma_f32_16x16x32_bf16 v[184:187], v[64:67], v[40:43], v[184:187]
    v_mfma_f32_16x16x32_bf16 v[188:191], v[64:67], v[44:47], v[188:191]
    ds_read_b64_tr_b16 v[64:65], v97 offset:12288
    ds_read_b64_tr_b16 v[66:67], v97 offset:13824
    v_mfma_f32_16x16x32_bf16 v[192:195], v[68:71], v[32:35], v[192:195]
    v_mfma_f32_16x16x32_bf16 v[196:199], v[68:71], v[36:39], v[196:199]
    v_mfma_f32_16x16x32_bf16 v[200:203], v[68:71], v[40:43], v[200:203]
    v_mfma_f32_16x16x32_bf16 v[204:207], v[68:71], v[44:47], v[204:207]
    ds_read_b64_tr_b16 v[68:69], v98 offset:12288
    ds_read_b64_tr_b16 v[70:71], v98 offset:13824
    v_mfma_f32_16x16x32_bf16 v[208:211], v[72:75], v[32:35], v[208:211]
    v_mfma_f32_16x16x32_bf16 v[212:215], v[72:75], v[36:39], v[212:215]
    v_mfma_f32_16x16x32_bf16 v[216:219], v[72:75], v[40:43], v[216:219]
    v_mfma_f32_16x16x32_bf16 v[220:223], v[72:75], v[44:47], v[220:223]
    ds_read_b64_tr_b16 v[72:73], v96 offset:24576
    ds_read_b64_tr_b16 v[74:75], v96 offset:26112
    v_mfma_f32_16x16x32_bf16 v[224:227], v[76:79], v[32:35], v[224:227]
    v_mfma_f32_16x16x32_bf16 v[228:231], v[76:79], v[36:39], v[228:231]
    v_mfma_f32_16x16x32_bf16 v[232:235], v[76:79], v[40:43], v[232:235]
    v_mfma_f32_16x16x32_bf16 v[236:239], v[76:79], v[44:47], v[236:239]
    ds_read_b64_tr_b16 v[76:77], v97 offset:24576
    ds_read_b64_tr_b16 v[78:79], v97 offset:26112
    v_mfma_f32_16x16x32_bf16 v[240:243], v[80:83], v[32:35], v[240:243]
    v_mfma_f32_16x16x32_bf16 v[244:247], v[80:83], v[36:39], v[244:247]
    v_mfma_f32_16x16x32_bf16 v[248:251], v[80:83], v[40:43], v[248:251]
    v_mfma_f32_16x16x32_bf16 v[252:255], v[80:83], v[44:47], v[252:255]
    ds_read_b64_tr_b16 v[80:81], v98 offset:24576
    ds_read_b64_tr_b16 v[82:83], v98 offset:26112
    s_mov_b32 s70, s71
    s_add_u32 s71, s71, 45056
    s_cmp_eq_u32 s71, 135168
    s_cselect_b32 s71, 0, s71
    s_waitcnt lgkmcnt(14)
    v_mfma_f32_16x16x32_bf16 v[112:115], v[48:51], v[16:19], v[112:115]
    v_mfma_f32_16x16x32_bf16 v[116:119], v[48:51], v[20:23], v[116:119]
    v_mfma_f32_16x16x32_bf16 v[120:123], v[48:51], v[24:27], v[120:123]
    v_mfma_f32_16x16x32_bf16 v[124:127], v[48:51], v[28:31], v[124:127]
    s_waitcnt lgkmcnt(12)
    v_mfma_f32_16x16x32_bf16 v[128:131], v[52:55], v[16:19], v[128:131]
    v_mfma_f32_16x16x32_bf16 v[132:135], v[52:55], v[20:23], v[132:135]
    v_mfma_f32_16x16x32_bf16 v[136:139], v[52:55], v[24:27], v[136:139]
    v_mfma_f32_16x16x32_bf16 v[140:143], v[52:55], v[28:31], v[140:143]
    s_waitcnt vmcnt(0) lgkmcnt(0)
    s_barrier
    v_add_u32 v95, s71, v91
    v_add_u32 v96, s71, v92
    v_add_u32 v97, s71, v93
    v_add_u32 v98, s71, v94
    ds_read_b128 v[32:35], v95 offset:0
    ds_read_b128 v[36:39], v95 offset:1024
    ds_read_b128 v[40:43], v95 offset:2048
    ds_read_b128 v[44:47], v95 offset:3072
    ds_read_b64_tr_b16 v[48:49], v96 offset:0
    ds_read_b64_tr_b16 v[50:51], v96 offset:1536
    ds_read_b64_tr_b16 v[52:53], v97 offset:0
    ds_read_b64_tr_b16 v[54:55], v97 offset:1536
    v_mfma_f32_16x16x32_bf16 v[144:147], v[56:59], v[16:19], v[144:147]
    v_mfma_f32_16x16x32_bf16 v[148:151], v[56:59], v[20:23], v[148:151]
    v_mfma_f32_16x16x32_bf16 v[152:155], v[56:59], v[24:27], v[152:155]
    v_mfma_f32_16x16x32_bf16 v[156:159], v[56:59], v[28:31], v[156:159]
    ds_read_b64_tr_b16 v[56:57], v98 offset:0
    ds_read_b64_tr_b16 v[58:59], v98 offset:1536
    v_mfma_f32_16x16x32_bf16 v[160:163], v[60:63], v[16:19], v[160:163]
    v_mfma_f32_16x16x32_bf16 v[164:167], v[60:63], v[20:23], v[164:167]
    v_mfma_f32_16x16x32_bf16 v[168:171], v[60:63], v[24:27], v[168:171]
    v_mfma_f32_16x16x32_bf16 v[172:175], v[60:63], v[28:31], v[172:175]
    ds_read_b64_tr_b16 v[60:61], v96 offset:12288
    ds_read_b64_tr_b16 v[62:63], v96 offset:13824
    v_mfma_f32_16x16x32_bf16 v[176:179], v[64:67], v[16:19], v[176:179]
    v_mfma_f32_16x16x32_bf16 v[180:183], v[64:67], v[20:23], v[180:183]
    v_mfma_f32_16x16x32_bf16 v[184:187], v[64:67], v[24:27], v[184:187]
    v_mfma_f32_16x16x32_bf16 v[188:191], v[64:67], v[28:31], v[188:191]
    ds_read_b64_tr_b16 v[64:65], v97 offset:12288
    ds_read_b64_tr_b16 v[66:67], v97 offset:13824
    v_mfma_f32_16x16x32_bf16 v[192:195], v[68:71], v[16:19], v[192:195]
    v_mfma_f32_16x16x32_bf16 v[196:199], v[68:71], v[20:23], v[196:199]
    v_mfma_f32_16x16x32_bf16 v[200:203], v[68:71], v[24:27], v[200:203]
    v_mfma_f32_16x16x32_bf16 v[204:207], v[68:71], v[28:31], v[204:207]
    ds_read_b64_tr_b16 v[68:69], v98 offset:12288
    ds_read_b64_tr_b16 v[70:71], v98 offset:13824
    v_mfma_f32_16x16x32_bf16 v[208:211], v[72:75], v[16:19], v[208:211]
    v_mfma_f32_16x16x32_bf16 v[212:215], v[72:75], v[20:23], v[212:215]
    v_mfma_f32_16x16x32_bf16 v[216:219], v[72:75], v[24:27], v[216:219]
    v_mfma_f32_16x16x32_bf16 v[220:223], v[72:75], v[28:31], v[220:223]
    ds_read_b64_tr_b16 v[72:73], v96 offset:24576
    ds_read_b64_tr_b16 v[74:75], v96 offset:26112
    v_mfma_f32_16x16x32_bf16 v[224:227], v[76:79], v[16:19], v[224:227]
    v_mfma_f32_16x16x32_bf16 v[228:231], v[76:79], v[20:23], v[228:231]
    v_mfma_f32_16x16x32_bf16 v[232:235], v[76:79], v[24:27], v[232:235]
    v_mfma_f32_16x16x32_bf16 v[236:239], v[76:79], v[28:31], v[236:239]
    ds_read_b64_tr_b16 v[76:77], v97 offset:24576
    ds_read_b64_tr_b16 v[78:79], v97 offset:26112
    v_mfma_f32_16x16x32_bf16 v[240:243], v[80:83], v[16:19], v[240:243]
    v_mfma_f32_16x16x32_bf16 v[244:247], v[80:83], v[20:23], v[244:247]
    v_mfma_f32_16x16x32_bf16 v[248:251], v[80:83], v[24:27], v[248:251]
    v_mfma_f32_16x16x32_bf16 v[252:255], v[80:83], v[28:31], v[252:255]
    ds_read_b64_tr_b16 v[80:81], v98 offset:24576
    ds_read_b64_tr_b16 v[82:83], v98 offset:26112
    s_mov_b32 s70, s71
    s_add_u32 s71, s71, 45056
    s_cmp_eq_u32 s71, 135168
    s_cselect_b32 s71, 0, s71
    s_waitcnt lgkmcnt(14)
    v_mfma_f32_16x16x32_bf16 v[112:115], v[48:51], v[32:35], v[112:115]
    v_mfma_f32_16x16x32_bf16 v[116:119], v[48:51], v[36:39], v[116:119]
    v_mfma_f32_16x16x32_bf16 v[120:123], v[48:51], v[40:43], v[120:123]
    v_mfma_f32_16x16x32_bf16 v[124:127], v[48:51], v[44:47], v[124:127]
    s_waitcnt lgkmcnt(12)
    v_mfma_f32_16x16x32_bf16 v[128:131], v[52:55], v[32:35], v[128:131]
    v_mfma_f32_16x16x32_bf16 v[132:135], v[52:55], v[36:39], v[132:135]
    v_mfma_f32_16x16x32_bf16 v[136:139], v[52:55], v[40:43], v[136:139]
    v_mfma_f32_16x16x32_bf16 v[140:143], v[52:55], v[44:47], v[140:143]
    s_waitcnt lgkmcnt(0)
    s_barrier
    v_mfma_f32_16x16x32_bf16 v[144:147], v[56:59], v[32:35], v[144:147]
    v_mfma_f32_16x16x32_bf16 v[148:151], v[56:59], v[36:39], v[148:151]
    v_mfma_f32_16x16x32_bf16 v[152:155], v[56:59], v[40:43], v[152:155]
    v_mfma_f32_16x16x32_bf16 v[156:159], v[56:59], v[44:47], v[156:159]
    v_mfma_f32_16x16x32_bf16 v[160:163], v[60:63], v[32:35], v[160:163]
    v_mfma_f32_16x16x32_bf16 v[164:167], v[60:63], v[36:39], v[164:167]
    v_mfma_f32_16x16x32_bf16 v[168:171], v[60:63], v[40:43], v[168:171]
    v_mfma_f32_16x16x32_bf16 v[172:175], v[60:63], v[44:47], v[172:175]
    v_mfma_f32_16x16x32_bf16 v[176:179], v[64:67], v[32:35], v[176:179]
    v_mfma_f32_16x16x32_bf16 v[180:183], v[64:67], v[36:39], v[180:183]
    v_mfma_f32_16x16x32_bf16 v[184:187], v[64:67], v[40:43], v[184:187]
    v_mfma_f32_16x16x32_bf16 v[188:191], v[64:67], v[44:47], v[188:191]
    v_mfma_f32_16x16x32_bf16 v[192:195], v[68:71], v[32:35], v[192:195]
    v_mfma_f32_16x16x32_bf16 v[196:199], v[68:71], v[36:39], v[196:199]
    v_mfma_f32_16x16x32_bf16 v[200:203], v[68:71], v[40:43], v[200:203]
    v_mfma_f32_16x16x32_bf16 v[204:207], v[68:71], v[44:47], v[204:207]
    v_mfma_f32_16x16x32_bf16 v[208:211], v[72:75], v[32:35], v[208:211]
    v_mfma_f32_16x16x32_bf16 v[212:215], v[72:75], v[36:39], v[212:215]
    v_mfma_f32_16x16x32_bf16 v[216:219], v[72:75], v[40:43], v[216:219]
    v_mfma_f32_16x16x32_bf16 v[220:223], v[72:75], v[44:47], v[220:223]
    v_mfma_f32_16x16x32_bf16 v[224:227], v[76:79], v[32:35], v[224:227]
    v_mfma_f32_16x16x32_bf16 v[228:231], v[76:79], v[36:39], v[228:231]
    v_mfma_f32_16x16x32_bf16 v[232:235], v[76:79], v[40:43], v[232:235]
    v_mfma_f32_16x16x32_bf16 v[236:239], v[76:79], v[44:47], v[236:239]
    v_mfma_f32_16x16x32_bf16 v[240:243], v[80:83], v[32:35], v[240:243]
    v_mfma_f32_16x16x32_bf16 v[244:247], v[80:83], v[36:39], v[244:247]
    v_mfma_f32_16x16x32_bf16 v[248:251], v[80:83], v[40:43], v[248:251]
    v_mfma_f32_16x16x32_bf16 v[252:255], v[80:83], v[44:47], v[252:255]
    s_nop 7
    s_nop 1
    v_lshlrev_b32 v14, 4, v1
    s_lshl_b32 s42, s39, 1
    s_lshl_b32 s43, s56, 2
    s_add_u32 s42, s42, s43
    s_lshl_b32 s42, s42, 5
    s_add_u32 s73, s42, s57
    s_mul_i32 s73, s73, 12288
    s_lshl_b32 s42, s41, 10
    s_add_u32 s74, s73, s42
    s_lshr_b32 s42, s41, 1
    s_lshl_b32 s42, s42, 10
    s_add_u32 s42, s42, 4096
    s_and_b32 s43, s41, 1
    s_lshl_b32 s43, s43, 3
    s_add_u32 s42, s42, s43
    s_add_u32 s75, s73, s42
    v_cvt_pk_bf16_f32 v16, v112, v113
    v_cvt_pk_bf16_f32 v17, v114, v115
    v_cvt_pk_bf16_f32 v18, v128, v129
    v_cvt_pk_bf16_f32 v19, v130, v131
    v_cvt_pk_bf16_f32 v20, v144, v145
    v_cvt_pk_bf16_f32 v21, v146, v147
    v_cvt_pk_bf16_f32 v22, v116, v117
    v_cvt_pk_bf16_f32 v23, v118, v119
    v_cvt_pk_bf16_f32 v24, v132, v133
    v_cvt_pk_bf16_f32 v25, v134, v135
    v_cvt_pk_bf16_f32 v26, v148, v149
    v_cvt_pk_bf16_f32 v27, v150, v151
    v_cvt_pk_bf16_f32 v28, v120, v121
    v_cvt_pk_bf16_f32 v29, v122, v123
    v_cvt_pk_bf16_f32 v30, v136, v137
    v_cvt_pk_bf16_f32 v31, v138, v139
    v_cvt_pk_bf16_f32 v32, v152, v153
    v_cvt_pk_bf16_f32 v33, v154, v155
    v_cvt_pk_bf16_f32 v34, v124, v125
    v_cvt_pk_bf16_f32 v35, v126, v127
    v_cvt_pk_bf16_f32 v36, v140, v141
    v_cvt_pk_bf16_f32 v37, v142, v143
    v_cvt_pk_bf16_f32 v38, v156, v157
    v_cvt_pk_bf16_f32 v39, v158, v159
    s_add_u32 s42, s74, 34603008
    s_add_u32 s43, s75, 34603008
    buffer_store_dwordx4 v[16:19], v15, s[32:35], s42 offen sc1
    buffer_store_dwordx2 v[20:21], v15, s[32:35], s43 offen sc1
    s_add_u32 s42, s74, 34609152
    s_add_u32 s43, s75, 34609152
    buffer_store_dwordx4 v[22:25], v15, s[32:35], s42 offen sc1
    buffer_store_dwordx2 v[26:27], v15, s[32:35], s43 offen sc1
    s_add_u32 s42, s74, 34996224
    s_add_u32 s43, s75, 34996224
    buffer_store_dwordx4 v[28:31], v15, s[32:35], s42 offen sc1
    buffer_store_dwordx2 v[32:33], v15, s[32:35], s43 offen sc1
    s_add_u32 s42, s74, 35002368
    s_add_u32 s43, s75, 35002368
    buffer_store_dwordx4 v[34:37], v15, s[32:35], s42 offen sc1
    buffer_store_dwordx2 v[38:39], v15, s[32:35], s43 offen sc1
    v_cvt_pk_bf16_f32 v40, v160, v161
    v_cvt_pk_bf16_f32 v41, v162, v163
    v_cvt_pk_bf16_f32 v42, v176, v177
    v_cvt_pk_bf16_f32 v43, v178, v179
    v_cvt_pk_bf16_f32 v44, v192, v193
    v_cvt_pk_bf16_f32 v45, v194, v195
    v_cvt_pk_bf16_f32 v46, v164, v165
    v_cvt_pk_bf16_f32 v47, v166, v167
    v_cvt_pk_bf16_f32 v48, v180, v181
    v_cvt_pk_bf16_f32 v49, v182, v183
    v_cvt_pk_bf16_f32 v50, v196, v197
    v_cvt_pk_bf16_f32 v51, v198, v199
    v_cvt_pk_bf16_f32 v52, v168, v169
    v_cvt_pk_bf16_f32 v53, v170, v171
    v_cvt_pk_bf16_f32 v54, v184, v185
    v_cvt_pk_bf16_f32 v55, v186, v187
    v_cvt_pk_bf16_f32 v56, v200, v201
    v_cvt_pk_bf16_f32 v57, v202, v203
    v_cvt_pk_bf16_f32 v58, v172, v173
    v_cvt_pk_bf16_f32 v59, v174, v175
    v_cvt_pk_bf16_f32 v60, v188, v189
    v_cvt_pk_bf16_f32 v61, v190, v191
    v_cvt_pk_bf16_f32 v62, v204, v205
    v_cvt_pk_bf16_f32 v63, v206, v207
    s_add_u32 s42, s74, 60817408
    s_add_u32 s43, s75, 60817408
    buffer_store_dwordx4 v[40:43], v15, s[32:35], s42 offen sc1
    buffer_store_dwordx2 v[44:45], v15, s[32:35], s43 offen sc1
    s_add_u32 s42, s74, 60823552
    s_add_u32 s43, s75, 60823552
    buffer_store_dwordx4 v[46:49], v15, s[32:35], s42 offen sc1
    buffer_store_dwordx2 v[50:51], v15, s[32:35], s43 offen sc1
    s_add_u32 s42, s74, 61210624
    s_add_u32 s43, s75, 61210624
    buffer_store_dwordx4 v[52:55], v15, s[32:35], s42 offen sc1
    buffer_store_dwordx2 v[56:57], v15, s[32:35], s43 offen sc1
    s_add_u32 s42, s74, 61216768
    s_add_u32 s43, s75, 61216768
    buffer_store_dwordx4 v[58:61], v15, s[32:35], s42 offen sc1
    buffer_store_dwordx2 v[62:63], v15, s[32:35], s43 offen sc1
    v_cvt_pk_bf16_f32 v64, v208, v209
    v_cvt_pk_bf16_f32 v65, v210, v211
    v_cvt_pk_bf16_f32 v66, v224, v225
    v_cvt_pk_bf16_f32 v67, v226, v227
    v_cvt_pk_bf16_f32 v68, v240, v241
    v_cvt_pk_bf16_f32 v69, v242, v243
    v_cvt_pk_bf16_f32 v70, v212, v213
    v_cvt_pk_bf16_f32 v71, v214, v215
    v_cvt_pk_bf16_f32 v72, v228, v229
    v_cvt_pk_bf16_f32 v73, v230, v231
    v_cvt_pk_bf16_f32 v74, v244, v245
    v_cvt_pk_bf16_f32 v75, v246, v247
    v_cvt_pk_bf16_f32 v76, v216, v217
    v_cvt_pk_bf16_f32 v77, v218, v219
    v_cvt_pk_bf16_f32 v78, v232, v233
    v_cvt_pk_bf16_f32 v79, v234, v235
    v_cvt_pk_bf16_f32 v80, v248, v249
    v_cvt_pk_bf16_f32 v81, v250, v251
    v_cvt_pk_bf16_f32 v82, v220, v221
    v_cvt_pk_bf16_f32 v83, v222, v223
    v_cvt_pk_bf16_f32 v84, v236, v237
    v_cvt_pk_bf16_f32 v85, v238, v239
    v_cvt_pk_bf16_f32 v86, v252, v253
    v_cvt_pk_bf16_f32 v87, v254, v255
    s_add_u32 s42, s74, 87031808
    s_add_u32 s43, s75, 87031808
    buffer_store_dwordx4 v[64:67], v15, s[32:35], s42 offen sc1
    buffer_store_dwordx2 v[68:69], v15, s[32:35], s43 offen sc1
    s_add_u32 s42, s74, 87037952
    s_add_u32 s43, s75, 87037952
    buffer_store_dwordx4 v[70:73], v15, s[32:35], s42 offen sc1
    buffer_store_dwordx2 v[74:75], v15, s[32:35], s43 offen sc1
    s_add_u32 s42, s74, 87425024
    s_add_u32 s43, s75, 87425024
    buffer_store_dwordx4 v[76:79], v15, s[32:35], s42 offen sc1
    buffer_store_dwordx2 v[80:81], v15, s[32:35], s43 offen sc1
    s_add_u32 s42, s74, 87431168
    s_add_u32 s43, s75, 87431168
    buffer_store_dwordx4 v[82:85], v15, s[32:35], s42 offen sc1
    buffer_store_dwordx2 v[86:87], v15, s[32:35], s43 offen sc1
    s_branch WDONE
B_T1F:
    s_load_dwordx4 s[4:7], s[0:1], 16
    s_load_dwordx2 s[48:49], s[0:1], 32
    s_waitcnt lgkmcnt(0)
    s_mov_b32 s8, s4
    s_mov_b32 s9, s5
    s_mov_b32 s10, 7864320
    s_mov_b32 s11, 0x00020000
    s_mov_b32 s12, s6
    s_mov_b32 s13, s7
    s_mov_b32 s14, 7864320
    s_mov_b32 s15, 0x00020000
    s_mov_b32 s16, s48
    s_mov_b32 s17, s49
    s_mov_b32 s18, 7864320
    s_mov_b32 s19, 0x00020000
    s_add_u32 s20, s52, 1048576
    s_addc_u32 s21, s53, 0
    s_mov_b32 s22, 2621440
    s_mov_b32 s23, 0x00020000
    s_cmp_eq_u32 s58, 1
    s_cselect_b32 s8, s12, s8
    s_cselect_b32 s9, s13, s9
    s_cmp_eq_u32 s58, 2
    s_cselect_b32 s8, s16, s8
    s_cselect_b32 s9, s17, s9
    s_mov_b32 s12, s8
    s_mov_b32 s13, s9
    s_cmp_lt_u32 s40, 4
    s_cselect_b32 s24, s8, s12
    s_cselect_b32 s25, s9, s13
    s_mov_b32 s26, 7864320
    s_mov_b32 s27, 0x00020000
    s_mov_b32 s47, 0x78
    v_lshl_add_u32 v4, s40, 6, v1
    v_mul_u32_u24 v5, 2731, v4
    v_lshrrev_b32 v5, 16, v5
    v_mul_u32_u24 v6, 24, v5
    v_sub_u32 v6, v4, v6
    v_lshrrev_b32 v7, 1, v6
    v_and_b32 v6, 1, v6
    v_bfe_u32 v8, v5, 1, 1
    v_bfe_u32 v9, v5, 3, 1
    v_lshl_or_b32 v8, v9, 1, v8
    v_xor_b32 v7, v7, v8
    v_mul_u32_u24 v88, 12288, v5
    v_lshl_add_u32 v88, v7, 5, v88
    v_lshl_add_u32 v88, v6, 4, v88
    s_add_u32 s42, s41, 8
    v_lshl_add_u32 v4, s42, 6, v1
    v_mul_u32_u24 v5, 2731, v4
    v_lshrrev_b32 v5, 16, v5
    v_mul_u32_u24 v6, 24, v5
    v_sub_u32 v6, v4, v6
    v_lshrrev_b32 v7, 1, v6
    v_and_b32 v6, 1, v6
    v_bfe_u32 v8, v5, 1, 1
    v_bfe_u32 v9, v5, 3, 1
    v_lshl_or_b32 v8, v9, 1, v8
    v_xor_b32 v7, v7, v8
    v_mul_u32_u24 v89, 12288, v5
    v_lshl_add_u32 v89, v7, 5, v89
    v_lshl_add_u32 v89, v6, 4, v89
    v_lshl_add_u32 v4, s40, 6, v1
    v_lshrrev_b32 v5, 2, v4
    v_and_b32 v6, 3, v4
    v_bfe_u32 v7, v5, 2, 2
    v_lshlrev_b32 v7, 1, v7
    v_lshrrev_b32 v7, v7, s47
    v_and_b32 v7, 3, v7
    v_xor_b32 v6, v6, v7
    s_lshl_b32 s43, s56, 7
    v_add_u32 v5, s43, v5
    v_mul_u32_u24 v90, 1280, v5
    v_lshl_add_u32 v90, v6, 4, v90
    s_lshl_b32 s44, s40, 10
    s_lshl_b32 s42, s42, 10
    s_mov_b32 s60, s44
    s_add_u32 s61, s44, 12288
    s_add_u32 s62, s44, 24576
    s_add_u32 s63, s44, 36864
    s_cmp_lt_u32 s40, 4
    s_mov_b32 s64, 0
    s_add_u32 s64, s64, s42
    s_add_u32 s65, s42, 24576
    s_mul_i32 s66, s57, 384
    s_mov_b32 s67, 0
    v_lshrrev_b32 v4, 2, v2
    v_lshlrev_b32 v4, 1, v4
    v_lshrrev_b32 v4, v4, s47
    v_and_b32 v4, 3, v4
    v_xor_b32 v4, v4, v3
    v_lshl_add_u32 v5, s39, 6, v2
    v_lshlrev_b32 v5, 6, v5
    v_lshl_add_u32 v5, v4, 4, v5
    v_add_u32 v91, 36864, v5
    v_lshrrev_b32 v4, 2, v2
    v_lshl_add_u32 v5, v3, 3, v4
    v_lshrrev_b32 v6, 1, v4
    v_and_b32 v7, 1, v3
    v_lshl_or_b32 v6, v7, 1, v6
    v_and_b32 v7, 3, v2
    v_mul_u32_u24 v8, 384, v5
    v_lshl_add_u32 v8, v7, 3, v8
    s_mul_i32 s42, s41, 3
    s_add_u32 s43, s42, 0
    v_xor_b32 v9, s43, v6
    v_lshl_add_u32 v92, v9, 5, v8
    s_add_u32 s43, s42, 1
    v_xor_b32 v9, s43, v6
    v_lshl_add_u32 v93, v9, 5, v8
    s_add_u32 s43, s42, 2
    v_xor_b32 v9, s43, v6
    v_lshl_add_u32 v94, v9, 5, v8
    v_lshlrev_b32 v15, 4, v1
    v_mov_b32 v112, 0
    v_mov_b32 v113, 0
    v_mov_b32 v114, 0
    v_mov_b32 v115, 0
    v_mov_b32 v116, 0
    v_mov_b32 v117, 0
    v_mov_b32 v118, 0
    v_mov_b32 v119, 0
    v_mov_b32 v120, 0
    v_mov_b32 v121, 0
    v_mov_b32 v122, 0
    v_mov_b32 v123, 0
    v_mov_b32 v124, 0
    v_mov_b32 v125, 0
    v_mov_b32 v126, 0
    v_mov_b32 v127, 0
    v_mov_b32 v128, 0
    v_mov_b32 v129, 0
    v_mov_b32 v130, 0
    v_mov_b32 v131, 0
    v_mov_b32 v132, 0
    v_mov_b32 v133, 0
    v_mov_b32 v134, 0
    v_mov_b32 v135, 0
    v_mov_b32 v136, 0
    v_mov_b32 v137, 0
    v_mov_b32 v138, 0
    v_mov_b32 v139, 0
    v_mov_b32 v140, 0
    v_mov_b32 v141, 0
    v_mov_b32 v142, 0
    v_mov_b32 v143, 0
    v_mov_b32 v144, 0
    v_mov_b32 v145, 0
    v_mov_b32 v146, 0
    v_mov_b32 v147, 0
    v_mov_b32 v148, 0
    v_mov_b32 v149, 0
    v_mov_b32 v150, 0
    v_mov_b32 v151, 0
    v_mov_b32 v152, 0
    v_mov_b32 v153, 0
    v_mov_b32 v154, 0
    v_mov_b32 v155, 0
    v_mov_b32 v156, 0
    v_mov_b32 v157, 0
    v_mov_b32 v158, 0
    v_mov_b32 v159, 0
    s_mov_b32 s70, 0
    s_add_u32 m0, s60, s70
    s_nop 0
    buffer_load_dwordx4 v88, s[8:11], s66 offen lds
    s_add_u32 m0, s63, s70
    s_nop 0
    buffer_load_dwordx4 v90, s[20:23], s67 offen lds
    s_add_u32 m0, s64, s70
    s_nop 0
    buffer_load_dwordx4 v89, s[24:27], s66 offen lds
    s_add_u32 s66, s66, 393216
    s_add_u32 s67, s67, 64
    s_mov_b32 s70, 45056
    s_add_u32 m0, s60, s70
    s_nop 0
    buffer_load_dwordx4 v88, s[8:11], s66 offen lds
    s_add_u32 m0, s63, s70
    s_nop 0
    buffer_load_dwordx4 v90, s[20:23], s67 offen lds
    s_add_u32 m0, s64, s70
    s_nop 0
    buffer_load_dwordx4 v89, s[24:27], s66 offen lds
    s_add_u32 s66, s66, 393216
    s_add_u32 s67, s67, 64
    s_mov_b32 s70, 90112
    s_add_u32 m0, s60, s70
    s_nop 0
    buffer_load_dwordx4 v88, s[8:11], s66 offen lds
    s_add_u32 m0, s63, s70
    s_nop 0
    buffer_load_dwordx4 v90, s[20:23], s67 offen lds
    s_add_u32 m0, s64, s70
    s_nop 0
    buffer_load_dwordx4 v89, s[24:27], s66 offen lds
    s_add_u32 s66, s66, 393216
    s_add_u32 s67, s67, 64
    s_waitcnt vmcnt(6)
    s_barrier
    v_add_u32 v95, 0, v91
    v_add_u32 v96, 0, v92
    v_add_u32 v97, 0, v93
    v_add_u32 v98, 0, v94
    ds_read_b128 v[16:19], v95 offset:0
    ds_read_b128 v[20:23], v95 offset:1024
    ds_read_b128 v[24:27], v95 offset:2048
    ds_read_b128 v[28:31], v95 offset:3072
    ds_read_b64_tr_b16 v[48:49], v96 offset:0
    ds_read_b64_tr_b16 v[50:51], v96 offset:1536
    ds_read_b64_tr_b16 v[52:53], v97 offset:0
    ds_read_b64_tr_b16 v[54:55], v97 offset:1536
    ds_read_b64_tr_b16 v[56:57], v98 offset:0
    ds_read_b64_tr_b16 v[58:59], v98 offset:1536
    s_mov_b32 s70, 0
    s_mov_b32 s71, 45056
    s_mov_b32 s72, 0
T1F_LOOP:
    s_waitcnt vmcnt(3) lgkmcnt(0)
    s_barrier
    v_add_u32 v95, s71, v91
    v_add_u32 v96, s71, v92
    v_add_u32 v97, s71, v93
    v_add_u32 v98, s71, v94
    ds_read_b128 v[32:35], v95 offset:0
    ds_read_b128 v[36:39], v95 offset:1024
    ds_read_b128 v[40:43], v95 offset:2048
    ds_read_b128 v[44:47], v95 offset:3072
    ds_read_b64_tr_b16 v[60:61], v96 offset:0
    ds_read_b64_tr_b16 v[62:63], v96 offset:1536
    ds_read_b64_tr_b16 v[64:65], v97 offset:0
    ds_read_b64_tr_b16 v[66:67], v97 offset:1536
    ds_read_b64_tr_b16 v[68:69], v98 offset:0
    ds_read_b64_tr_b16 v[70:71], v98 offset:1536
    s_add_u32 m0, s60, s70
    s_nop 0
    buffer_load_dwordx4 v88, s[8:11], s66 offen lds
    s_add_u32 m0, s63, s70
    s_nop 0
    buffer_load_dwordx4 v90, s[20:23], s67 offen lds
    s_add_u32 m0, s64, s70
    s_nop 0
    buffer_load_dwordx4 v89, s[24:27], s66 offen lds
    s_add_u32 s66, s66, 393216
    s_add_u32 s67, s67, 64
    v_mfma_f32_16x16x32_bf16 v[112:115], v[48:51], v[16:19], v[112:115]
    v_mfma_f32_16x16x32_bf16 v[116:119], v[48:51], v[20:23], v[116:119]
    v_mfma_f32_16x16x32_bf16 v[120:123], v[48:51], v[24:27], v[120:123]
    v_mfma_f32_16x16x32_bf16 v[124:127], v[48:51], v[28:31], v[124:127]
    v_mfma_f32_16x16x32_bf16 v[128:131], v[52:55], v[16:19], v[128:131]
    v_mfma_f32_16x16x32_bf16 v[132:135], v[52:55], v[20:23], v[132:135]
    v_mfma_f32_16x16x32_bf16 v[136:139], v[52:55], v[24:27], v[136:139]
    v_mfma_f32_16x16x32_bf16 v[140:143], v[52:55], v[28:31], v[140:143]
    v_mfma_f32_16x16x32_bf16 v[144:147], v[56:59], v[16:19], v[144:147]
    v_mfma_f32_16x16x32_bf16 v[148:151], v[56:59], v[20:23], v[148:151]
    v_mfma_f32_16x16x32_bf16 v[152:155], v[56:59], v[24:27], v[152:155]
    v_mfma_f32_16x16x32_bf16 v[156:159], v[56:59], v[28:31], v[156:159]
    s_mov_b32 s70, s71
    s_add_u32 s71, s71, 45056
    s_cmp_eq_u32 s71, 135168
    s_cselect_b32 s71, 0, s71
    s_waitcnt vmcnt(3) lgkmcnt(0)
    s_barrier
    v_add_u32 v95, s71, v91
    v_add_u32 v96, s71, v92
    v_add_u32 v97, s71, v93
    v_add_u32 v98, s71, v94
    ds_read_b128 v[16:19], v95 offset:0
    ds_read_b128 v[20:23], v95 offset:1024
    ds_read_b128 v[24:27], v95 offset:2048
    ds_read_b128 v[28:31], v95 offset:3072
    ds_read_b64_tr_b16 v[48:49], v96 offset:0
    ds_read_b64_tr_b16 v[50:51], v96 offset:1536
    ds_read_b64_tr_b16 v[52:53], v97 offset:0
    ds_read_b64_tr_b16 v[54:55], v97 offset:1536
    ds_read_b64_tr_b16 v[56:57], v98 offset:0
    ds_read_b64_tr_b16 v[58:59], v98 offset:1536
    s_add_u32 m0, s60, s70
    s_nop 0
    buffer_load_dwordx4 v88, s[8:11], s66 offen lds
    s_add_u32 m0, s63, s70
    s_nop 0
    buffer_load_dwordx4 v90, s[20:23], s67 offen lds
    s_add_u32 m0, s64, s70
    s_nop 0
    buffer_load_dwordx4 v89, s[24:27], s66 offen lds
    s_add_u32 s66, s66, 393216
    s_add_u32 s67, s67, 64
    v_mfma_f32_16x16x32_bf16 v[112:115], v[60:63], v[32:35], v[112:115]
    v_mfma_f32_16x16x32_bf16 v[116:119], v[60:63], v[36:39], v[116:119]
    v_mfma_f32_16x16x32_bf16 v[120:123], v[60:63], v[40:43], v[120:123]
    v_mfma_f32_16x16x32_bf16 v[124:127], v[60:63], v[44:47], v[124:127]
    v_mfma_f32_16x16x32_bf16 v[128:131], v[64:67], v[32:35], v[128:131]
    v_mfma_f32_16x16x32_bf16 v[132:135], v[64:67], v[36:39], v[132:135]
    v_mfma_f32_16x16x32_bf16 v[136:139], v[64:67], v[40:43], v[136:139]
    v_mfma_f32_16x16x32_bf16 v[140:143], v[64:67], v[44:47], v[140:143]
    v_mfma_f32_16x16x32_bf16 v[144:147], v[68:71], v[32:35], v[144:147]
    v_mfma_f32_16x16x32_bf16 v[148:151], v[68:71], v[36:39], v[148:151]
    v_mfma_f32_16x16x32_bf16 v[152:155], v[68:71], v[40:43], v[152:155]
    v_mfma_f32_16x16x32_bf16 v[156:159], v[68:71], v[44:47], v[156:159]
    s_mov_b32 s70, s71
    s_add_u32 s71, s71, 45056
    s_cmp_eq_u32 s71, 135168
    s_cselect_b32 s71, 0, s71
    s_add_u32 s72, s72, 1
    s_cmp_lt_u32 s72, 8
    s_cbranch_scc1 T1F_LOOP
    s_waitcnt vmcnt(3) lgkmcnt(0)
    s_barrier
    v_add_u32 v95, s71, v91
    v_add_u32 v96, s71, v92
    v_add_u32 v97, s71, v93
    v_add_u32 v98, s71, v94
    ds_read_b128 v[32:35], v95 offset:0
    ds_read_b128 v[36:39], v95 offset:1024
    ds_read_b128 v[40:43], v95 offset:2048
    ds_read_b128 v[44:47], v95 offset:3072
    ds_read_b64_tr_b16 v[60:61], v96 offset:0
    ds_read_b64_tr_b16 v[62:63], v96 offset:1536
    ds_read_b64_tr_b16 v[64:65], v97 offset:0
    ds_read_b64_tr_b16 v[66:67], v97 offset:1536
    ds_read_b64_tr_b16 v[68:69], v98 offset:0
    ds_read_b64_tr_b16 v[70:71], v98 offset:1536
    s_add_u32 m0, s60, s70
    s_nop 0
    buffer_load_dwordx4 v88, s[8:11], s66 offen lds
    s_add_u32 m0, s63, s70
    s_nop 0
    buffer_load_dwordx4 v90, s[20:23], s67 offen lds
    s_add_u32 m0, s64, s70
    s_nop 0
    buffer_load_dwordx4 v89, s[24:27], s66 offen lds
    s_add_u32 s66, s66, 393216
    s_add_u32 s67, s67, 64
    v_mfma_f32_16x16x32_bf16 v[112:115], v[48:51], v[16:19], v[112:115]
    v_mfma_f32_16x16x32_bf16 v[116:119], v[48:51], v[20:23], v[116:119]
    v_mfma_f32_16x16x32_bf16 v[120:123], v[48:51], v[24:27], v[120:123]
    v_mfma_f32_16x16x32_bf16 v[124:127], v[48:51], v[28:31], v[124:127]
    v_mfma_f32_16x16x32_bf16 v[128:131], v[52:55], v[16:19], v[128:131]
    v_mfma_f32_16x16x32_bf16 v[132:135], v[52:55], v[20:23], v[132:135]
    v_mfma_f32_16x16x32_bf16 v[136:139], v[52:55], v[24:27], v[136:139]
    v_mfma_f32_16x16x32_bf16 v[140:143], v[52:55], v[28:31], v[140:143]
    v_mfma_f32_16x16x32_bf16 v[144:147], v[56:59], v[16:19], v[144:147]
    v_mfma_f32_16x16x32_bf16 v[148:151], v[56:59], v[20:23], v[148:151]
    v_mfma_f32_16x16x32_bf16 v[152:155], v[56:59], v[24:27], v[152:155]
    v_mfma_f32_16x16x32_bf16 v[156:159], v[56:59], v[28:31], v[156:159]
    s_mov_b32 s70, s71
    s_add_u32 s71, s71, 45056
    s_cmp_eq_u32 s71, 135168
    s_cselect_b32 s71, 0, s71
    s_waitcnt vmcnt(3) lgkmcnt(0)
    s_barrier
    v_add_u32 v95, s71, v91
    v_add_u32 v96, s71, v92
    v_add_u32 v97, s71, v93
    v_add_u32 v98, s71, v94
    ds_read_b128 v[16:19], v95 offset:0
    ds_read_b128 v[20:23], v95 offset:1024
    ds_read_b128 v[24:27], v95 offset:2048
    ds_read_b128 v[28:31], v95 offset:3072
    ds_read_b64_tr_b16 v[48:49], v96 offset:0
    ds_read_b64_tr_b16 v[50:51], v96 offset:1536
    ds_read_b64_tr_b16 v[52:53], v97 offset:0
    ds_read_b64_tr_b16 v[54:55], v97 offset:1536
    ds_read_b64_tr_b16 v[56:57], v98 offset:0
    ds_read_b64_tr_b16 v[58:59], v98 offset:1536
    v_mfma_f32_16x16x32_bf16 v[112:115], v[60:63], v[32:35], v[112:115]
    v_mfma_f32_16x16x32_bf16 v[116:119], v[60:63], v[36:39], v[116:119]
    v_mfma_f32_16x16x32_bf16 v[120:123], v[60:63], v[40:43], v[120:123]
    v_mfma_f32_16x16x32_bf16 v[124:127], v[60:63], v[44:47], v[124:127]
    v_mfma_f32_16x16x32_bf16 v[128:131], v[64:67], v[32:35], v[128:131]
    v_mfma_f32_16x16x32_bf16 v[132:135], v[64:67], v[36:39], v[132:135]
    v_mfma_f32_16x16x32_bf16 v[136:139], v[64:67], v[40:43], v[136:139]
    v_mfma_f32_16x16x32_bf16 v[140:143], v[64:67], v[44:47], v[140:143]
    v_mfma_f32_16x16x32_bf16 v[144:147], v[68:71], v[32:35], v[144:147]
    v_mfma_f32_16x16x32_bf16 v[148:151], v[68:71], v[36:39], v[148:151]
    v_mfma_f32_16x16x32_bf16 v[152:155], v[68:71], v[40:43], v[152:155]
    v_mfma_f32_16x16x32_bf16 v[156:159], v[68:71], v[44:47], v[156:159]
    s_mov_b32 s70, s71
    s_add_u32 s71, s71, 45056
    s_cmp_eq_u32 s71, 135168
    s_cselect_b32 s71, 0, s71
    s_waitcnt vmcnt(0) lgkmcnt(0)
    s_barrier
    v_add_u32 v95, s71, v91
    v_add_u32 v96, s71, v92
    v_add_u32 v97, s71, v93
    v_add_u32 v98, s71, v94
    ds_read_b128 v[32:35], v95 offset:0
    ds_read_b128 v[36:39], v95 offset:1024
    ds_read_b128 v[40:43], v95 offset:2048
    ds_read_b128 v[44:47], v95 offset:3072
    ds_read_b64_tr_b16 v[60:61], v96 offset:0
    ds_read_b64_tr_b16 v[62:63], v96 offset:1536
    ds_read_b64_tr_b16 v[64:65], v97 offset:0
    ds_read_b64_tr_b16 v[66:67], v97 offset:1536
    ds_read_b64_tr_b16 v[68:69], v98 offset:0
    ds_read_b64_tr_b16 v[70:71], v98 offset:1536
    v_mfma_f32_16x16x32_bf16 v[112:115], v[48:51], v[16:19], v[112:115]
    v_mfma_f32_16x16x32_bf16 v[116:119], v[48:51], v[20:23], v[116:119]
    v_mfma_f32_16x16x32_bf16 v[120:123], v[48:51], v[24:27], v[120:123]
    v_mfma_f32_16x16x32_bf16 v[124:127], v[48:51], v[28:31], v[124:127]
    v_mfma_f32_16x16x32_bf16 v[128:131], v[52:55], v[16:19], v[128:131]
    v_mfma_f32_16x16x32_bf16 v[132:135], v[52:55], v[20:23], v[132:135]
    v_mfma_f32_16x16x32_bf16 v[136:139], v[52:55], v[24:27], v[136:139]
    v_mfma_f32_16x16x32_bf16 v[140:143], v[52:55], v[28:31], v[140:143]
    v_mfma_f32_16x16x32_bf16 v[144:147], v[56:59], v[16:19], v[144:147]
    v_mfma_f32_16x16x32_bf16 v[148:151], v[56:59], v[20:23], v[148:151]
    v_mfma_f32_16x16x32_bf16 v[152:155], v[56:59], v[24:27], v[152:155]
    v_mfma_f32_16x16x32_bf16 v[156:159], v[56:59], v[28:31], v[156:159]
    s_mov_b32 s70, s71
    s_add_u32 s71, s71, 45056
    s_cmp_eq_u32 s71, 135168
    s_cselect_b32 s71, 0, s71
    s_waitcnt lgkmcnt(0)
    v_mfma_f32_16x16x32_bf16 v[112:115], v[60:63], v[32:35], v[112:115]
    v_mfma_f32_16x16x32_bf16 v[116:119], v[60:63], v[36:39], v[116:119]
    v_mfma_f32_16x16x32_bf16 v[120:123], v[60:63], v[40:43], v[120:123]
    v_mfma_f32_16x16x32_bf16 v[124:127], v[60:63], v[44:47], v[124:127]
    v_mfma_f32_16x16x32_bf16 v[128:131], v[64:67], v[32:35], v[128:131]
    v_mfma_f32_16x16x32_bf16 v[132:135], v[64:67], v[36:39], v[132:135]
    v_mfma_f32_16x16x32_bf16 v[136:139], v[64:67], v[40:43], v[136:139]
    v_mfma_f32_16x16x32_bf16 v[140:143], v[64:67], v[44:47], v[140:143]
    v_mfma_f32_16x16x32_bf16 v[144:147], v[68:71], v[32:35], v[144:147]
    v_mfma_f32_16x16x32_bf16 v[148:151], v[68:71], v[36:39], v[148:151]
    v_mfma_f32_16x16x32_bf16 v[152:155], v[68:71], v[40:43], v[152:155]
    v_mfma_f32_16x16x32_bf16 v[156:159], v[68:71], v[44:47], v[156:159]
    s_nop 7
    s_nop 1
    v_lshlrev_b32 v14, 4, v1
    s_lshl_b32 s42, s39, 1
    s_lshl_b32 s43, s56, 2
    s_add_u32 s42, s42, s43
    s_lshl_b32 s42, s42, 5
    s_add_u32 s73, s42, s57
    s_mul_i32 s73, s73, 12288
    s_lshl_b32 s42, s41, 10
    s_add_u32 s74, s73, s42
    s_lshr_b32 s42, s41, 1
    s_lshl_b32 s42, s42, 10
    s_add_u32 s42, s42, 4096
    s_and_b32 s43, s41, 1
    s_lshl_b32 s43, s43, 3
    s_add_u32 s42, s42, s43
    s_add_u32 s75, s73, s42
    s_mov_b32 s45, 34603008
    s_cmp_eq_u32 s58, 1
    s_cselect_b32 s45, 60817408, s45
    s_cmp_eq_u32 s58, 2
    s_cselect_b32 s45, 87031808, s45
    s_add_u32 s74, s74, s45
    s_add_u32 s75, s75, s45
    v_cvt_pk_bf16_f32 v16, v112, v113
    v_cvt_pk_bf16_f32 v17, v114, v115
    v_cvt_pk_bf16_f32 v18, v128, v129
    v_cvt_pk_bf16_f32 v19, v130, v131
    v_cvt_pk_bf16_f32 v20, v144, v145
    v_cvt_pk_bf16_f32 v21, v146, v147
    v_cvt_pk_bf16_f32 v22, v116, v117
    v_cvt_pk_bf16_f32 v23, v118, v119
    v_cvt_pk_bf16_f32 v24, v132, v133
    v_cvt_pk_bf16_f32 v25, v134, v135
    v_cvt_pk_bf16_f32 v26, v148, v149
    v_cvt_pk_bf16_f32 v27, v150, v151
    v_cvt_pk_bf16_f32 v28, v120, v121
    v_cvt_pk_bf16_f32 v29, v122, v123
    v_cvt_pk_bf16_f32 v30, v136, v137
    v_cvt_pk_bf16_f32 v31, v138, v139
    v_cvt_pk_bf16_f32 v32, v152, v153
    v_cvt_pk_bf16_f32 v33, v154, v155
    v_cvt_pk_bf16_f32 v34, v124, v125
    v_cvt_pk_bf16_f32 v35, v126, v127
    v_cvt_pk_bf16_f32 v36, v140, v141
    v_cvt_pk_bf16_f32 v37, v142, v143
    v_cvt_pk_bf16_f32 v38, v156, v157
    v_cvt_pk_bf16_f32 v39, v158, v159
    s_add_u32 s42, s74, 0
    s_add_u32 s43, s75, 0
    buffer_store_dwordx4 v[16:19], v15, s[32:35], s42 offen sc1
    buffer_store_dwordx2 v[20:21], v15, s[32:35], s43 offen sc1
    s_add_u32 s42, s74, 6144
    s_add_u32 s43, s75, 6144
    buffer_store_dwordx4 v[22:25], v15, s[32:35], s42 offen sc1
    buffer_store_dwordx2 v[26:27], v15, s[32:35], s43 offen sc1
    s_add_u32 s42, s74, 393216
    s_add_u32 s43, s75, 393216
    buffer_store_dwordx4 v[28:31], v15, s[32:35], s42 offen sc1
    buffer_store_dwordx2 v[32:33], v15, s[32:35], s43 offen sc1
    s_add_u32 s42, s74, 399360
    s_add_u32 s43, s75, 399360
    buffer_store_dwordx4 v[34:37], v15, s[32:35], s42 offen sc1
    buffer_store_dwordx2 v[38:39], v15, s[32:35], s43 offen sc1
    s_branch WDONE
B_LN2:
    v_lshlrev_b32 v15, 4, v1
    v_lshlrev_b32 v13, 3, v1
    s_mul_i32 s42, s56, 40
    s_lshl_b32 s43, s40, 1
    s_add_u32 s42, s42, s43
    s_lshl_b32 s42, s42, 9
    s_add_u32 s60, s42, 135266304
    s_add_u32 s42, s60, 0
    buffer_load_dwordx2 v[100:101], v13, s[32:35], s42 offen offset:0
    buffer_load_dwordx2 v[132:133], v13, s[32:35], s42 offen offset:512
    s_add_u32 s42, s60, 2621440
    buffer_load_dwordx2 v[102:103], v13, s[32:35], s42 offen offset:0
    buffer_load_dwordx2 v[134:135], v13, s[32:35], s42 offen offset:512
    s_add_u32 s42, s60, 5242880
    buffer_load_dwordx2 v[104:105], v13, s[32:35], s42 offen offset:0
    buffer_load_dwordx2 v[136:137], v13, s[32:35], s42 offen offset:512
    s_add_u32 s42, s60, 7864320
    buffer_load_dwordx2 v[106:107], v13, s[32:35], s42 offen offset:0
    buffer_load_dwordx2 v[138:139], v13, s[32:35], s42 offen offset:512
    s_add_u32 s42, s60, 10485760
    buffer_load_dwordx2 v[108:109], v13, s[32:35], s42 offen offset:0
    buffer_load_dwordx2 v[140:141], v13, s[32:35], s42 offen offset:512
    s_add_u32 s42, s60, 13107200
    buffer_load_dwordx2 v[110:111], v13, s[32:35], s42 offen offset:0
    buffer_load_dwordx2 v[142:143], v13, s[32:35], s42 offen offset:512
    s_add_u32 s42, s60, 15728640
    buffer_load_dwordx2 v[112:113], v13, s[32:35], s42 offen offset:0
    buffer_load_dwordx2 v[144:145], v13, s[32:35], s42 offen offset:512
    s_add_u32 s42, s60, 18350080
    buffer_load_dwordx2 v[114:115], v13, s[32:35], s42 offen offset:0
    buffer_load_dwordx2 v[146:147], v13, s[32:35], s42 offen offset:512
    s_add_u32 s42, s60, 20971520
    buffer_load_dwordx2 v[116:117], v13, s[32:35], s42 offen offset:0
    buffer_load_dwordx2 v[148:149], v13, s[32:35], s42 offen offset:512
    s_add_u32 s42, s60, 23592960
    buffer_load_dwordx2 v[118:119], v13, s[32:35], s42 offen offset:0
    buffer_load_dwordx2 v[150:151], v13, s[32:35], s42 offen offset:512
    s_add_u32 s42, s60, 26214400
    buffer_load_dwordx2 v[120:121], v13, s[32:35], s42 offen offset:0
    buffer_load_dwordx2 v[152:153], v13, s[32:35], s42 offen offset:512
    s_add_u32 s42, s60, 28835840
    buffer_load_dwordx2 v[122:123], v13, s[32:35], s42 offen offset:0
    buffer_load_dwordx2 v[154:155], v13, s[32:35], s42 offen offset:512
    s_add_u32 s42, s60, 31457280
    buffer_load_dwordx2 v[124:125], v13, s[32:35], s42 offen offset:0
    buffer_load_dwordx2 v[156:157], v13, s[32:35], s42 offen offset:512
    s_add_u32 s42, s60, 34078720
    buffer_load_dwordx2 v[126:127], v13, s[32:35], s42 offen offset:0
    buffer_load_dwordx2 v[158:159], v13, s[32:35], s42 offen offset:512
    s_add_u32 s42, s60, 36700160
    buffer_load_dwordx2 v[128:129], v13, s[32:35], s42 offen offset:0
    buffer_load_dwordx2 v[160:161], v13, s[32:35], s42 offen offset:512
    s_add_u32 s42, s60, 39321600
    buffer_load_dwordx2 v[130:131], v13, s[32:35], s42 offen offset:0
    buffer_load_dwordx2 v[162:163], v13, s[32:35], s42 offen offset:512
    s_add_u32 s42, s60, 8192
    buffer_load_dwordx2 v[164:165], v13, s[32:35], s42 offen offset:0
    buffer_load_dwordx2 v[196:197], v13, s[32:35], s42 offen offset:512
    s_add_u32 s42, s60, 2629632
    buffer_load_dwordx2 v[166:167], v13, s[32:35], s42 offen offset:0
    buffer_load_dwordx2 v[198:199], v13, s[32:35], s42 offen offset:512
    s_add_u32 s42, s60, 5251072
    buffer_load_dwordx2 v[168:169], v13, s[32:35], s42 offen offset:0
    buffer_load_dwordx2 v[200:201], v13, s[32:35], s42 offen offset:512
    s_add_u32 s42, s60, 7872512
    buffer_load_dwordx2 v[170:171], v13, s[32:35], s42 offen offset:0
    buffer_load_dwordx2 v[202:203], v13, s[32:35], s42 offen offset:512
    s_add_u32 s42, s60, 10493952
    buffer_load_dwordx2 v[172:173], v13, s[32:35], s42 offen offset:0
    buffer_load_dwordx2 v[204:205], v13, s[32:35], s42 offen offset:512
    s_add_u32 s42, s60, 13115392
    buffer_load_dwordx2 v[174:175], v13, s[32:35], s42 offen offset:0
    buffer_load_dwordx2 v[206:207], v13, s[32:35], s42 offen offset:512
    s_add_u32 s42, s60, 15736832
    buffer_load_dwordx2 v[176:177], v13, s[32:35], s42 offen offset:0
    buffer_load_dwordx2 v[208:209], v13, s[32:35], s42 offen offset:512
    s_add_u32 s42, s60, 18358272
    buffer_load_dwordx2 v[178:179], v13, s[32:35], s42 offen offset:0
    buffer_load_dwordx2 v[210:211], v13, s[32:35], s42 offen offset:512
    s_add_u32 s42, s60, 20979712
    buffer_load_dwordx2 v[180:181], v13, s[32:35], s42 offen offset:0
    buffer_load_dwordx2 v[212:213], v13, s[32:35], s42 offen offset:512
    s_add_u32 s42, s60, 23601152
    buffer_load_dwordx2 v[182:183], v13, s[32:35], s42 offen offset:0
    buffer_load_dwordx2 v[214:215], v13, s[32:35], s42 offen offset:512
    s_add_u32 s42, s60, 26222592
    buffer_load_dwordx2 v[184:185], v13, s[32:35], s42 offen offset:0
    buffer_load_dwordx2 v[216:217], v13, s[32:35], s42 offen offset:512
    s_add_u32 s42, s60, 28844032
    buffer_load_dwordx2 v[186:187], v13, s[32:35], s42 offen offset:0
    buffer_load_dwordx2 v[218:219], v13, s[32:35], s42 offen offset:512
    s_add_u32 s42, s60, 31465472
    buffer_load_dwordx2 v[188:189], v13, s[32:35], s42 offen offset:0
    buffer_load_dwordx2 v[220:221], v13, s[32:35], s42 offen offset:512
    s_add_u32 s42, s60, 34086912
    buffer_load_dwordx2 v[190:191], v13, s[32:35], s42 offen offset:0
    buffer_load_dwordx2 v[222:223], v13, s[32:35], s42 offen offset:512
    s_add_u32 s42, s60, 36708352
    buffer_load_dwordx2 v[192:193], v13, s[32:35], s42 offen offset:0
    buffer_load_dwordx2 v[224:225], v13, s[32:35], s42 offen offset:512
    s_add_u32 s42, s60, 39329792
    buffer_load_dwordx2 v[194:195], v13, s[32:35], s42 offen offset:0
    buffer_load_dwordx2 v[226:227], v13, s[32:35], s42 offen offset:512
    v_lshlrev_b32 v5, 2, v3
    v_sub_u32 v5, v2, v5
    v_mov_b32 v252, 0
    v_mov_b32 v6, 0x3f80
    v_cmp_eq_u32 vcc, 0, v5
    v_cndmask_b32 v252, v252, v6, vcc
    v_mov_b32 v6, 0x3f800000
    v_cmp_eq_u32 vcc, 1, v5
    v_cndmask_b32 v252, v252, v6, vcc
    v_mov_b32 v253, 0
    v_mov_b32 v6, 0x3f80
    v_cmp_eq_u32 vcc, 2, v5
    v_cndmask_b32 v253, v253, v6, vcc
    v_mov_b32 v6, 0x3f800000
    v_cmp_eq_u32 vcc, 3, v5
    v_cndmask_b32 v253, v253, v6, vcc
    v_mov_b32 v254, v252
    v_mov_b32 v255, v253
    v_mov_b32 v244, 0
    v_mov_b32 v245, 0
    v_mov_b32 v246, 0
    v_mov_b32 v247, 0
    v_mov_b32 v248, 0
    v_mov_b32 v249, 0
    v_mov_b32 v250, 0
    v_mov_b32 v251, 0
    s_waitcnt vmcnt(32)
    v_mfma_f32_16x16x32_bf16 v[228:231], v[252:255], v[100:103], 0
    v_mfma_f32_16x16x32_bf16 v[232:235], v[252:255], v[132:135], 0
    v_mfma_f32_16x16x32_bf16 v[228:231], v[252:255], v[104:107], v[228:231]
    v_mfma_f32_16x16x32_bf16 v[232:235], v[252:255], v[136:139], v[232:235]
    v_mfma_f32_16x16x32_bf16 v[228:231], v[252:255], v[108:111], v[228:231]
    v_mfma_f32_16x16x32_bf16 v[232:235], v[252:255], v[140:143], v[232:235]
    v_mfma_f32_16x16x32_bf16 v[228:231], v[252:255], v[112:115], v[228:231]
    v_mfma_f32_16x16x32_bf16 v[232:235], v[252:255], v[144:147], v[232:235]
    v_mfma_f32_16x16x32_bf16 v[228:231], v[252:255], v[116:119], v[228:231]
    v_mfma_f32_16x16x32_bf16 v[232:235], v[252:255], v[148:151], v[232:235]
    v_mfma_f32_16x16x32_bf16 v[228:231], v[252:255], v[120:123], v[228:231]
    v_mfma_f32_16x16x32_bf16 v[232:235], v[252:255], v[152:155], v[232:235]
    v_mfma_f32_16x16x32_bf16 v[228:231], v[252:255], v[124:127], v[228:231]
    v_mfma_f32_16x16x32_bf16 v[232:235], v[252:255], v[156:159], v[232:235]
    v_mfma_f32_16x16x32_bf16 v[228:231], v[252:255], v[128:131], v[228:231]
    v_mfma_f32_16x16x32_bf16 v[232:235], v[252:255], v[160:163], v[232:235]
    s_cmp_ge_u32 s40, 4
    s_cbranch_scc1 LN2M_SK1
    s_add_u32 s42, s60, 16384
    buffer_load_dwordx2 v[100:101], v13, s[32:35], s42 offen offset:0
    buffer_load_dwordx2 v[132:133], v13, s[32:35], s42 offen offset:512
    s_add_u32 s42, s60, 2637824
    buffer_load_dwordx2 v[102:103], v13, s[32:35], s42 offen offset:0
    buffer_load_dwordx2 v[134:135], v13, s[32:35], s42 offen offset:512
    s_add_u32 s42, s60, 5259264
    buffer_load_dwordx2 v[104:105], v13, s[32:35], s42 offen offset:0
    buffer_load_dwordx2 v[136:137], v13, s[32:35], s42 offen offset:512
    s_add_u32 s42, s60, 7880704
    buffer_load_dwordx2 v[106:107], v13, s[32:35], s42 offen offset:0
    buffer_load_dwordx2 v[138:139], v13, s[32:35], s42 offen offset:512
    s_add_u32 s42, s60, 10502144
    buffer_load_dwordx2 v[108:109], v13, s[32:35], s42 offen offset:0
    buffer_load_dwordx2 v[140:141], v13, s[32:35], s42 offen offset:512
    s_add_u32 s42, s60, 13123584
    buffer_load_dwordx2 v[110:111], v13, s[32:35], s42 offen offset:0
    buffer_load_dwordx2 v[142:143], v13, s[32:35], s42 offen offset:512
    s_add_u32 s42, s60, 15745024
    buffer_load_dwordx2 v[112:113], v13, s[32:35], s42 offen offset:0
    buffer_load_dwordx2 v[144:145], v13, s[32:35], s42 offen offset:512
    s_add_u32 s42, s60, 18366464
    buffer_load_dwordx2 v[114:115], v13, s[32:35], s42 offen offset:0
    buffer_load_dwordx2 v[146:147], v13, s[32:35], s42 offen offset:512
    s_add_u32 s42, s60, 20987904
    buffer_load_dwordx2 v[116:117], v13, s[32:35], s42 offen offset:0
    buffer_load_dwordx2 v[148:149], v13, s[32:35], s42 offen offset:512
    s_add_u32 s42, s60, 23609344
    buffer_load_dwordx2 v[118:119], v13, s[32:35], s42 offen offset:0
    buffer_load_dwordx2 v[150:151], v13, s[32:35], s42 offen offset:512
    s_add_u32 s42, s60, 26230784
    buffer_load_dwordx2 v[120:121], v13, s[32:35], s42 offen offset:0
    buffer_load_dwordx2 v[152:153], v13, s[32:35], s42 offen offset:512
    s_add_u32 s42, s60, 28852224
    buffer_load_dwordx2 v[122:123], v13, s[32:35], s42 offen offset:0
    buffer_load_dwordx2 v[154:155], v13, s[32:35], s42 offen offset:512
    s_add_u32 s42, s60, 31473664
    buffer_load_dwordx2 v[124:125], v13, s[32:35], s42 offen offset:0
    buffer_load_dwordx2 v[156:157], v13, s[32:35], s42 offen offset:512
    s_add_u32 s42, s60, 34095104
    buffer_load_dwordx2 v[126:127], v13, s[32:35], s42 offen offset:0
    buffer_load_dwordx2 v[158:159], v13, s[32:35], s42 offen offset:512
    s_add_u32 s42, s60, 36716544
    buffer_load_dwordx2 v[128:129], v13, s[32:35], s42 offen offset:0
    buffer_load_dwordx2 v[160:161], v13, s[32:35], s42 offen offset:512
    s_add_u32 s42, s60, 39337984
    buffer_load_dwordx2 v[130:131], v13, s[32:35], s42 offen offset:0
    buffer_load_dwordx2 v[162:163], v13, s[32:35], s42 offen offset:512
    s_waitcnt vmcnt(32)
    v_mfma_f32_16x16x32_bf16 v[236:239], v[252:255], v[164:167], 0
    v_mfma_f32_16x16x32_bf16 v[240:243], v[252:255], v[196:199], 0
    v_mfma_f32_16x16x32_bf16 v[236:239], v[252:255], v[168:171], v[236:239]
    v_mfma_f32_16x16x32_bf16 v[240:243], v[252:255], v[200:203], v[240:243]
    v_mfma_f32_16x16x32_bf16 v[236:239], v[252:255], v[172:175], v[236:239]
    v_mfma_f32_16x16x32_bf16 v[240:243], v[252:255], v[204:207], v[240:243]
    v_mfma_f32_16x16x32_bf16 v[236:239], v[252:255], v[176:179], v[236:239]
    v_mfma_f32_16x16x32_bf16 v[240:243], v[252:255], v[208:211], v[240:243]
    v_mfma_f32_16x16x32_bf16 v[236:239], v[252:255], v[180:183], v[236:239]
    v_mfma_f32_16x16x32_bf16 v[240:243], v[252:255], v[212:215], v[240:243]
    v_mfma_f32_16x16x32_bf16 v[236:239], v[252:255], v[184:187], v[236:239]
    v_mfma_f32_16x16x32_bf16 v[240:243], v[252:255], v[216:219], v[240:243]
    v_mfma_f32_16x16x32_bf16 v[236:239], v[252:255], v[188:191], v[236:239]
    v_mfma_f32_16x16x32_bf16 v[240:243], v[252:255], v[220:223], v[240:243]
    v_mfma_f32_16x16x32_bf16 v[236:239], v[252:255], v[192:195], v[236:239]
    v_mfma_f32_16x16x32_bf16 v[240:243], v[252:255], v[224:227], v[240:243]
    s_waitcnt vmcnt(0)
    v_mfma_f32_16x16x32_bf16 v[244:247], v[252:255], v[100:103], 0
    v_mfma_f32_16x16x32_bf16 v[248:251], v[252:255], v[132:135], 0
    v_mfma_f32_16x16x32_bf16 v[244:247], v[252:255], v[104:107], v[244:247]
    v_mfma_f32_16x16x32_bf16 v[248:251], v[252:255], v[136:139], v[248:251]
    v_mfma_f32_16x16x32_bf16 v[244:247], v[252:255], v[108:111], v[244:247]
    v_mfma_f32_16x16x32_bf16 v[248:251], v[252:255], v[140:143], v[248:251]
    v_mfma_f32_16x16x32_bf16 v[244:247], v[252:255], v[112:115], v[244:247]
    v_mfma_f32_16x16x32_bf16 v[248:251], v[252:255], v[144:147], v[248:251]
    v_mfma_f32_16x16x32_bf16 v[244:247], v[252:255], v[116:119], v[244:247]
    v_mfma_f32_16x16x32_bf16 v[248:251], v[252:255], v[148:151], v[248:251]
    v_mfma_f32_16x16x32_bf16 v[244:247], v[252:255], v[120:123], v[244:247]
    v_mfma_f32_16x16x32_bf16 v[248:251], v[252:255], v[152:155], v[248:251]
    v_mfma_f32_16x16x32_bf16 v[244:247], v[252:255], v[124:127], v[244:247]
    v_mfma_f32_16x16x32_bf16 v[248:251], v[252:255], v[156:159], v[248:251]
    v_mfma_f32_16x16x32_bf16 v[244:247], v[252:255], v[128:131], v[244:247]
    v_mfma_f32_16x16x32_bf16 v[248:251], v[252:255], v[160:163], v[248:251]
    s_branch LN2M_J1
LN2M_SK1:
    s_waitcnt vmcnt(0)
    v_mfma_f32_16x16x32_bf16 v[236:239], v[252:255], v[164:167], 0
    v_mfma_f32_16x16x32_bf16 v[240:243], v[252:255], v[196:199], 0
    v_mfma_f32_16x16x32_bf16 v[236:239], v[252:255], v[168:171], v[236:239]
    v_mfma_f32_16x16x32_bf16 v[240:243], v[252:255], v[200:203], v[240:243]
    v_mfma_f32_16x16x32_bf16 v[236:239], v[252:255], v[172:175], v[236:239]
    v_mfma_f32_16x16x32_bf16 v[240:243], v[252:255], v[204:207], v[240:243]
    v_mfma_f32_16x16x32_bf16 v[236:239], v[252:255], v[176:179], v[236:239]
    v_mfma_f32_16x16x32_bf16 v[240:243], v[252:255], v[208:211], v[240:243]
    v_mfma_f32_16x16x32_bf16 v[236:239], v[252:255], v[180:183], v[236:239]
    v_mfma_f32_16x16x32_bf16 v[240:243], v[252:255], v[212:215], v[240:243]
    v_mfma_f32_16x16x32_bf16 v[236:239], v[252:255], v[184:187], v[236:239]
    v_mfma_f32_16x16x32_bf16 v[240:243], v[252:255], v[216:219], v[240:243]
    v_mfma_f32_16x16x32_bf16 v[236:239], v[252:255], v[188:191], v[236:239]
    v_mfma_f32_16x16x32_bf16 v[240:243], v[252:255], v[220:223], v[240:243]
    v_mfma_f32_16x16x32_bf16 v[236:239], v[252:255], v[192:195], v[236:239]
    v_mfma_f32_16x16x32_bf16 v[240:243], v[252:255], v[224:227], v[240:243]
LN2M_J1:
    s_mul_i32 s42, s56, 20
    s_add_u32 s42, s42, s40
    s_lshl_b32 s42, s42, 10
    s_add_u32 s61, s42, 7340032
    s_add_u32 s62, s42, 4194304
    s_nop 7
    v_cvt_pk_bf16_f32 v228, v228, v228
    v_lshlrev_b32 v228, 16, v228
    v_mul_f32 v228, v228, v28
    v_cvt_pk_bf16_f32 v228, v228, v228
    v_lshlrev_b32 v228, 16, v228
    v_cvt_pk_bf16_f32 v229, v229, v229
    v_lshlrev_b32 v229, 16, v229
    v_mul_f32 v229, v229, v29
    v_cvt_pk_bf16_f32 v229, v229, v229
    v_lshlrev_b32 v229, 16, v229
    v_cvt_pk_bf16_f32 v230, v230, v230
    v_lshlrev_b32 v230, 16, v230
    v_mul_f32 v230, v230, v30
    v_cvt_pk_bf16_f32 v230, v230, v230
    v_lshlrev_b32 v230, 16, v230
    v_cvt_pk_bf16_f32 v231, v231, v231
    v_lshlrev_b32 v231, 16, v231
    v_mul_f32 v231, v231, v31
    v_cvt_pk_bf16_f32 v231, v231, v231
    v_lshlrev_b32 v231, 16, v231
    v_cvt_pk_bf16_f32 v232, v232, v232
    v_lshlrev_b32 v232, 16, v232
    v_mul_f32 v232, v232, v32
    v_cvt_pk_bf16_f32 v232, v232, v232
    v_lshlrev_b32 v232, 16, v232
    v_cvt_pk_bf16_f32 v233, v233, v233
    v_lshlrev_b32 v233, 16, v233
    v_mul_f32 v233, v233, v33
    v_cvt_pk_bf16_f32 v233, v233, v233
    v_lshlrev_b32 v233, 16, v233
    v_cvt_pk_bf16_f32 v234, v234, v234
    v_lshlrev_b32 v234, 16, v234
    v_mul_f32 v234, v234, v34
    v_cvt_pk_bf16_f32 v234, v234, v234
    v_lshlrev_b32 v234, 16, v234
    v_cvt_pk_bf16_f32 v235, v235, v235
    v_lshlrev_b32 v235, 16, v235
    v_mul_f32 v235, v235, v35
    v_cvt_pk_bf16_f32 v235, v235, v235
    v_lshlrev_b32 v235, 16, v235
    v_lshlrev_b32 v164, 16, v16
    v_and_b32 v165, 0xffff0000, v16
    v_add_f32 v228, v228, v164
    v_add_f32 v229, v229, v165
    v_lshlrev_b32 v164, 16, v17
    v_and_b32 v165, 0xffff0000, v17
    v_add_f32 v230, v230, v164
    v_add_f32 v231, v231, v165
    v_lshlrev_b32 v164, 16, v18
    v_and_b32 v165, 0xffff0000, v18
    v_add_f32 v232, v232, v164
    v_add_f32 v233, v233, v165
    v_lshlrev_b32 v164, 16, v19
    v_and_b32 v165, 0xffff0000, v19
    v_add_f32 v234, v234, v164
    v_add_f32 v235, v235, v165
    v_cvt_pk_bf16_f32 v168, v228, v229
    v_cvt_pk_bf16_f32 v169, v230, v231
    v_cvt_pk_bf16_f32 v170, v232, v233
    v_cvt_pk_bf16_f32 v171, v234, v235
    s_add_u32 s42, s61, 0
    buffer_store_dwordx4 v[168:171], v15, s[32:35], s42 offen sc1
    v_lshlrev_b32 v228, 16, v168
    v_and_b32 v229, 0xffff0000, v168
    v_lshlrev_b32 v230, 16, v169
    v_and_b32 v231, 0xffff0000, v169
    v_lshlrev_b32 v232, 16, v170
    v_and_b32 v233, 0xffff0000, v170
    v_lshlrev_b32 v234, 16, v171
    v_and_b32 v235, 0xffff0000, v171
    v_cvt_pk_bf16_f32 v236, v236, v236
    v_lshlrev_b32 v236, 16, v236
    v_mul_f32 v236, v236, v36
    v_cvt_pk_bf16_f32 v236, v236, v236
    v_lshlrev_b32 v236, 16, v236
    v_cvt_pk_bf16_f32 v237, v237, v237
    v_lshlrev_b32 v237, 16, v237
    v_mul_f32 v237, v237, v37
    v_cvt_pk_bf16_f32 v237, v237, v237
    v_lshlrev_b32 v237, 16, v237
    v_cvt_pk_bf16_f32 v238, v238, v238
    v_lshlrev_b32 v238, 16, v238
    v_mul_f32 v238, v238, v38
    v_cvt_pk_bf16_f32 v238, v238, v238
    v_lshlrev_b32 v238, 16, v238
    v_cvt_pk_bf16_f32 v239, v239, v239
    v_lshlrev_b32 v239, 16, v239
    v_mul_f32 v239, v239, v39
    v_cvt_pk_bf16_f32 v239, v239, v239
    v_lshlrev_b32 v239, 16, v239
    v_cvt_pk_bf16_f32 v240, v240, v240
    v_lshlrev_b32 v240, 16, v240
    v_mul_f32 v240, v240, v40
    v_cvt_pk_bf16_f32 v240, v240, v240
    v_lshlrev_b32 v240, 16, v240
    v_cvt_pk_bf16_f32 v241, v241, v241
    v_lshlrev_b32 v241, 16, v241
    v_mul_f32 v241, v241, v41
    v_cvt_pk_bf16_f32 v241, v241, v241
    v_lshlrev_b32 v241, 16, v241
    v_cvt_pk_bf16_f32 v242, v242, v242
    v_lshlrev_b32 v242, 16, v242
    v_mul_f32 v242, v242, v42
    v_cvt_pk_bf16_f32 v242, v242, v242
    v_lshlrev_b32 v242, 16, v242
    v_cvt_pk_bf16_f32 v243, v243, v243
    v_lshlrev_b32 v243, 16, v243
    v_mul_f32 v243, v243, v43
    v_cvt_pk_bf16_f32 v243, v243, v243
    v_lshlrev_b32 v243, 16, v243
    v_lshlrev_b32 v164, 16, v20
    v_and_b32 v165, 0xffff0000, v20
    v_add_f32 v236, v236, v164
    v_add_f32 v237, v237, v165
    v_lshlrev_b32 v164, 16, v21
    v_and_b32 v165, 0xffff0000, v21
    v_add_f32 v238, v238, v164
    v_add_f32 v239, v239, v165
    v_lshlrev_b32 v164, 16, v22
    v_and_b32 v165, 0xffff0000, v22
    v_add_f32 v240, v240, v164
    v_add_f32 v241, v241, v165
    v_lshlrev_b32 v164, 16, v23
    v_and_b32 v165, 0xffff0000, v23
    v_add_f32 v242, v242, v164
    v_add_f32 v243, v243, v165
    v_cvt_pk_bf16_f32 v168, v236, v237
    v_cvt_pk_bf16_f32 v169, v238, v239
    v_cvt_pk_bf16_f32 v170, v240, v241
    v_cvt_pk_bf16_f32 v171, v242, v243
    s_add_u32 s42, s61, 8192
    buffer_store_dwordx4 v[168:171], v15, s[32:35], s42 offen sc1
    v_lshlrev_b32 v236, 16, v168
    v_and_b32 v237, 0xffff0000, v168
    v_lshlrev_b32 v238, 16, v169
    v_and_b32 v239, 0xffff0000, v169
    v_lshlrev_b32 v240, 16, v170
    v_and_b32 v241, 0xffff0000, v170
    v_lshlrev_b32 v242, 16, v171
    v_and_b32 v243, 0xffff0000, v171
    s_cmp_ge_u32 s40, 4
    s_cbranch_scc1 LN2M_SK2
    v_cvt_pk_bf16_f32 v244, v244, v244
    v_lshlrev_b32 v244, 16, v244
    v_mul_f32 v244, v244, v44
    v_cvt_pk_bf16_f32 v244, v244, v244
    v_lshlrev_b32 v244, 16, v244
    v_cvt_pk_bf16_f32 v245, v245, v245
    v_lshlrev_b32 v245, 16, v245
    v_mul_f32 v245, v245, v45
    v_cvt_pk_bf16_f32 v245, v245, v245
    v_lshlrev_b32 v245, 16, v245
    v_cvt_pk_bf16_f32 v246, v246, v246
    v_lshlrev_b32 v246, 16, v246
    v_mul_f32 v246, v246, v46
    v_cvt_pk_bf16_f32 v246, v246, v246
    v_lshlrev_b32 v246, 16, v246
    v_cvt_pk_bf16_f32 v247, v247, v247
    v_lshlrev_b32 v247, 16, v247
    v_mul_f32 v247, v247, v47
    v_cvt_pk_bf16_f32 v247, v247, v247
    v_lshlrev_b32 v247, 16, v247
    v_cvt_pk_bf16_f32 v248, v248, v248
    v_lshlrev_b32 v248, 16, v248
    v_mul_f32 v248, v248, v48
    v_cvt_pk_bf16_f32 v248, v248, v248
    v_lshlrev_b32 v248, 16, v248
    v_cvt_pk_bf16_f32 v249, v249, v249
    v_lshlrev_b32 v249, 16, v249
    v_mul_f32 v249, v249, v49
    v_cvt_pk_bf16_f32 v249, v249, v249
    v_lshlrev_b32 v249, 16, v249
    v_cvt_pk_bf16_f32 v250, v250, v250
    v_lshlrev_b32 v250, 16, v250
    v_mul_f32 v250, v250, v50
    v_cvt_pk_bf16_f32 v250, v250, v250
    v_lshlrev_b32 v250, 16, v250
    v_cvt_pk_bf16_f32 v251, v251, v251
    v_lshlrev_b32 v251, 16, v251
    v_mul_f32 v251, v251, v51
    v_cvt_pk_bf16_f32 v251, v251, v251
    v_lshlrev_b32 v251, 16, v251
    v_lshlrev_b32 v164, 16, v24
    v_and_b32 v165, 0xffff0000, v24
    v_add_f32 v244, v244, v164
    v_add_f32 v245, v245, v165
    v_lshlrev_b32 v164, 16, v25
    v_and_b32 v165, 0xffff0000, v25
    v_add_f32 v246, v246, v164
    v_add_f32 v247, v247, v165
    v_lshlrev_b32 v164, 16, v26
    v_and_b32 v165, 0xffff0000, v26
    v_add_f32 v248, v248, v164
    v_add_f32 v249, v249, v165
    v_lshlrev_b32 v164, 16, v27
    v_and_b32 v165, 0xffff0000, v27
    v_add_f32 v250, v250, v164
    v_add_f32 v251, v251, v165
    v_cvt_pk_bf16_f32 v168, v244, v245
    v_cvt_pk_bf16_f32 v169, v246, v247
    v_cvt_pk_bf16_f32 v170, v248, v249
    v_cvt_pk_bf16_f32 v171, v250, v251
    s_add_u32 s42, s61, 16384
    buffer_store_dwordx4 v[168:171], v15, s[32:35], s42 offen sc1
    v_lshlrev_b32 v244, 16, v168
    v_and_b32 v245, 0xffff0000, v168
    v_lshlrev_b32 v246, 16, v169
    v_and_b32 v247, 0xffff0000, v169
    v_lshlrev_b32 v248, 16, v170
    v_and_b32 v249, 0xffff0000, v170
    v_lshlrev_b32 v250, 16, v171
    v_and_b32 v251, 0xffff0000, v171
LN2M_SK2:
    v_add_f32 v172, v228, v229
    v_add_f32 v172, v172, v230
    v_add_f32 v172, v172, v231
    v_add_f32 v172, v172, v232
    v_add_f32 v172, v172, v233
    v_add_f32 v172, v172, v234
    v_add_f32 v172, v172, v235
    v_add_f32 v172, v172, v236
    v_add_f32 v172, v172, v237
    v_add_f32 v172, v172, v238
    v_add_f32 v172, v172, v239
    v_add_f32 v172, v172, v240
    v_add_f32 v172, v172, v241
    v_add_f32 v172, v172, v242
    v_add_f32 v172, v172, v243
    v_add_f32 v172, v172, v244
    v_add_f32 v172, v172, v245
    v_add_f32 v172, v172, v246
    v_add_f32 v172, v172, v247
    v_add_f32 v172, v172, v248
    v_add_f32 v172, v172, v249
    v_add_f32 v172, v172, v250
    v_add_f32 v172, v172, v251
    v_mov_b32 v173, v172
    s_nop 1
    v_permlane32_swap_b32 v172, v173
    s_nop 1
    v_add_f32 v172, v172, v173
    v_mov_b32 v173, v172
    s_nop 1
    v_permlane16_swap_b32 v172, v173
    s_nop 1
    v_add_f32 v172, v172, v173
    v_lshlrev_b32 v6, 2, v2
    s_lshl_b32 s42, s40, 6
    v_add_u32 v7, s42, v6
    ds_write_b32 v7, v172
    s_waitcnt lgkmcnt(0)
    s_barrier
    ds_read_b32 v174, v6 offset:0
    ds_read_b32 v175, v6 offset:64
    ds_read_b32 v176, v6 offset:128
    ds_read_b32 v177, v6 offset:192
    ds_read_b32 v178, v6 offset:256
    ds_read_b32 v179, v6 offset:320
    ds_read_b32 v180, v6 offset:384
    ds_read_b32 v181, v6 offset:448
    s_waitcnt lgkmcnt(0)
    v_add_f32 v172, v174, v175
    v_add_f32 v172, v172, v176
    v_add_f32 v172, v172, v177
    v_add_f32 v172, v172, v178
    v_add_f32 v172, v172, v179
    v_add_f32 v172, v172, v180
    v_add_f32 v172, v172, v181
    s_mov_b32 s24, 0x3acccccd
    s_mov_b32 s25, 0x3727c5ac
    v_mul_f32 v172, s24, v172
    v_sub_f32 v228, v228, v172
    v_sub_f32 v229, v229, v172
    v_sub_f32 v230, v230, v172
    v_sub_f32 v231, v231, v172
    v_sub_f32 v232, v232, v172
    v_sub_f32 v233, v233, v172
    v_sub_f32 v234, v234, v172
    v_sub_f32 v235, v235, v172
    v_sub_f32 v236, v236, v172
    v_sub_f32 v237, v237, v172
    v_sub_f32 v238, v238, v172
    v_sub_f32 v239, v239, v172
    v_sub_f32 v240, v240, v172
    v_sub_f32 v241, v241, v172
    v_sub_f32 v242, v242, v172
    v_sub_f32 v243, v243, v172
    s_cmp_lt_u32 s40, 4
    s_cselect_b64 vcc, -1, 0
    v_sub_f32 v164, v244, v172
    v_cndmask_b32 v244, 0, v164, vcc
    v_sub_f32 v164, v245, v172
    v_cndmask_b32 v245, 0, v164, vcc
    v_sub_f32 v164, v246, v172
    v_cndmask_b32 v246, 0, v164, vcc
    v_sub_f32 v164, v247, v172
    v_cndmask_b32 v247, 0, v164, vcc
    v_sub_f32 v164, v248, v172
    v_cndmask_b32 v248, 0, v164, vcc
    v_sub_f32 v164, v249, v172
    v_cndmask_b32 v249, 0, v164, vcc
    v_sub_f32 v164, v250, v172
    v_cndmask_b32 v250, 0, v164, vcc
    v_sub_f32 v164, v251, v172
    v_cndmask_b32 v251, 0, v164, vcc
    v_mul_f32 v173, v228, v228
    v_fmac_f32 v173, v229, v229
    v_fmac_f32 v173, v230, v230
    v_fmac_f32 v173, v231, v231
    v_fmac_f32 v173, v232, v232
    v_fmac_f32 v173, v233, v233
    v_fmac_f32 v173, v234, v234
    v_fmac_f32 v173, v235, v235
    v_fmac_f32 v173, v236, v236
    v_fmac_f32 v173, v237, v237
    v_fmac_f32 v173, v238, v238
    v_fmac_f32 v173, v239, v239
    v_fmac_f32 v173, v240, v240
    v_fmac_f32 v173, v241, v241
    v_fmac_f32 v173, v242, v242
    v_fmac_f32 v173, v243, v243
    v_fmac_f32 v173, v244, v244
    v_fmac_f32 v173, v245, v245
    v_fmac_f32 v173, v246, v246
    v_fmac_f32 v173, v247, v247
    v_fmac_f32 v173, v248, v248
    v_fmac_f32 v173, v249, v249
    v_fmac_f32 v173, v250, v250
    v_fmac_f32 v173, v251, v251
    v_mov_b32 v174, v173
    s_nop 1
    v_permlane32_swap_b32 v173, v174
    s_nop 1
    v_add_f32 v173, v173, v174
    v_mov_b32 v174, v173
    s_nop 1
    v_permlane16_swap_b32 v173, v174
    s_nop 1
    v_add_f32 v173, v173, v174
    ds_write_b32 v7, v173 offset:512
    s_waitcnt lgkmcnt(0)
    s_barrier
    ds_read_b32 v174, v6 offset:512
    ds_read_b32 v175, v6 offset:576
    ds_read_b32 v176, v6 offset:640
    ds_read_b32 v177, v6 offset:704
    ds_read_b32 v178, v6 offset:768
    ds_read_b32 v179, v6 offset:832
    ds_read_b32 v180, v6 offset:896
    ds_read_b32 v181, v6 offset:960
    s_waitcnt lgkmcnt(0)
    v_add_f32 v173, v174, v175
    v_add_f32 v173, v173, v176
    v_add_f32 v173, v173, v177
    v_add_f32 v173, v173, v178
    v_add_f32 v173, v173, v179
    v_add_f32 v173, v173, v180
    v_add_f32 v173, v173, v181
    v_mul_f32 v173, s24, v173
    v_add_f32 v173, s25, v173
    v_rsq_f32 v173, v173
    s_nop 0
    v_add_f32 v76, 1.0, v76
    v_cvt_pk_bf16_f32 v76, v76, v76
    v_lshlrev_b32 v76, 16, v76
    v_mul_f32 v228, v228, v173
    v_fma_f32 v228, v228, v76, v52
    v_add_f32 v77, 1.0, v77
    v_cvt_pk_bf16_f32 v77, v77, v77
    v_lshlrev_b32 v77, 16, v77
    v_mul_f32 v229, v229, v173
    v_fma_f32 v229, v229, v77, v53
    v_add_f32 v78, 1.0, v78
    v_cvt_pk_bf16_f32 v78, v78, v78
    v_lshlrev_b32 v78, 16, v78
    v_mul_f32 v230, v230, v173
    v_fma_f32 v230, v230, v78, v54
    v_add_f32 v79, 1.0, v79
    v_cvt_pk_bf16_f32 v79, v79, v79
    v_lshlrev_b32 v79, 16, v79
    v_mul_f32 v231, v231, v173
    v_fma_f32 v231, v231, v79, v55
    v_add_f32 v80, 1.0, v80
    v_cvt_pk_bf16_f32 v80, v80, v80
    v_lshlrev_b32 v80, 16, v80
    v_mul_f32 v232, v232, v173
    v_fma_f32 v232, v232, v80, v56
    v_add_f32 v81, 1.0, v81
    v_cvt_pk_bf16_f32 v81, v81, v81
    v_lshlrev_b32 v81, 16, v81
    v_mul_f32 v233, v233, v173
    v_fma_f32 v233, v233, v81, v57
    v_add_f32 v82, 1.0, v82
    v_cvt_pk_bf16_f32 v82, v82, v82
    v_lshlrev_b32 v82, 16, v82
    v_mul_f32 v234, v234, v173
    v_fma_f32 v234, v234, v82, v58
    v_add_f32 v83, 1.0, v83
    v_cvt_pk_bf16_f32 v83, v83, v83
    v_lshlrev_b32 v83, 16, v83
    v_mul_f32 v235, v235, v173
    v_fma_f32 v235, v235, v83, v59
    v_cvt_pk_bf16_f32 v164, v228, v229
    v_cvt_pk_bf16_f32 v165, v230, v231
    v_cvt_pk_bf16_f32 v166, v232, v233
    v_cvt_pk_bf16_f32 v167, v234, v235
    s_add_u32 s42, s62, 0
    buffer_store_dwordx4 v[164:167], v15, s[32:35], s42 offen sc1
    v_add_f32 v84, 1.0, v84
    v_cvt_pk_bf16_f32 v84, v84, v84
    v_lshlrev_b32 v84, 16, v84
    v_mul_f32 v236, v236, v173
    v_fma_f32 v236, v236, v84, v60
    v_add_f32 v85, 1.0, v85
    v_cvt_pk_bf16_f32 v85, v85, v85
    v_lshlrev_b32 v85, 16, v85
    v_mul_f32 v237, v237, v173
    v_fma_f32 v237, v237, v85, v61
    v_add_f32 v86, 1.0, v86
    v_cvt_pk_bf16_f32 v86, v86, v86
    v_lshlrev_b32 v86, 16, v86
    v_mul_f32 v238, v238, v173
    v_fma_f32 v238, v238, v86, v62
    v_add_f32 v87, 1.0, v87
    v_cvt_pk_bf16_f32 v87, v87, v87
    v_lshlrev_b32 v87, 16, v87
    v_mul_f32 v239, v239, v173
    v_fma_f32 v239, v239, v87, v63
    v_add_f32 v88, 1.0, v88
    v_cvt_pk_bf16_f32 v88, v88, v88
    v_lshlrev_b32 v88, 16, v88
    v_mul_f32 v240, v240, v173
    v_fma_f32 v240, v240, v88, v64
    v_add_f32 v89, 1.0, v89
    v_cvt_pk_bf16_f32 v89, v89, v89
    v_lshlrev_b32 v89, 16, v89
    v_mul_f32 v241, v241, v173
    v_fma_f32 v241, v241, v89, v65
    v_add_f32 v90, 1.0, v90
    v_cvt_pk_bf16_f32 v90, v90, v90
    v_lshlrev_b32 v90, 16, v90
    v_mul_f32 v242, v242, v173
    v_fma_f32 v242, v242, v90, v66
    v_add_f32 v91, 1.0, v91
    v_cvt_pk_bf16_f32 v91, v91, v91
    v_lshlrev_b32 v91, 16, v91
    v_mul_f32 v243, v243, v173
    v_fma_f32 v243, v243, v91, v67
    v_cvt_pk_bf16_f32 v168, v236, v237
    v_cvt_pk_bf16_f32 v169, v238, v239
    v_cvt_pk_bf16_f32 v170, v240, v241
    v_cvt_pk_bf16_f32 v171, v242, v243
    s_add_u32 s42, s62, 8192
    buffer_store_dwordx4 v[168:171], v15, s[32:35], s42 offen sc1
    s_cmp_ge_u32 s40, 4
    s_cbranch_scc1 LN2M_SK3
    v_add_f32 v92, 1.0, v92
    v_cvt_pk_bf16_f32 v92, v92, v92
    v_lshlrev_b32 v92, 16, v92
    v_mul_f32 v244, v244, v173
    v_fma_f32 v244, v244, v92, v68
    v_add_f32 v93, 1.0, v93
    v_cvt_pk_bf16_f32 v93, v93, v93
    v_lshlrev_b32 v93, 16, v93
    v_mul_f32 v245, v245, v173
    v_fma_f32 v245, v245, v93, v69
    v_add_f32 v94, 1.0, v94
    v_cvt_pk_bf16_f32 v94, v94, v94
    v_lshlrev_b32 v94, 16, v94
    v_mul_f32 v246, v246, v173
    v_fma_f32 v246, v246, v94, v70
    v_add_f32 v95, 1.0, v95
    v_cvt_pk_bf16_f32 v95, v95, v95
    v_lshlrev_b32 v95, 16, v95
    v_mul_f32 v247, v247, v173
    v_fma_f32 v247, v247, v95, v71
    v_add_f32 v96, 1.0, v96
    v_cvt_pk_bf16_f32 v96, v96, v96
    v_lshlrev_b32 v96, 16, v96
    v_mul_f32 v248, v248, v173
    v_fma_f32 v248, v248, v96, v72
    v_add_f32 v97, 1.0, v97
    v_cvt_pk_bf16_f32 v97, v97, v97
    v_lshlrev_b32 v97, 16, v97
    v_mul_f32 v249, v249, v173
    v_fma_f32 v249, v249, v97, v73
    v_add_f32 v98, 1.0, v98
    v_cvt_pk_bf16_f32 v98, v98, v98
    v_lshlrev_b32 v98, 16, v98
    v_mul_f32 v250, v250, v173
    v_fma_f32 v250, v250, v98, v74
    v_add_f32 v99, 1.0, v99
    v_cvt_pk_bf16_f32 v99, v99, v99
    v_lshlrev_b32 v99, 16, v99
    v_mul_f32 v251, v251, v173
    v_fma_f32 v251, v251, v99, v75
    v_cvt_pk_bf16_f32 v164, v244, v245
    v_cvt_pk_bf16_f32 v165, v246, v247
    v_cvt_pk_bf16_f32 v166, v248, v249
    v_cvt_pk_bf16_f32 v167, v250, v251
    s_add_u32 s42, s62, 16384
    buffer_store_dwordx4 v[164:167], v15, s[32:35], s42 offen sc1
LN2M_SK3:
    s_branch WDONE
B_FA:
    s_load_dwordx4 s[4:7], s[0:1], 64
    s_waitcnt lgkmcnt(0)
    s_mov_b32 s8, s4
    s_mov_b32 s9, s5
    s_mov_b32 s10, 1966080
    s_mov_b32 s11, 0x00020000
    s_mov_b32 s12, s6
    s_mov_b32 s13, s7
    s_mov_b32 s14, 1966080
    s_mov_b32 s15, 0x00020000
    v_lshlrev_b32 v15, 4, v1
    s_lshl_b32 s42, s56, 3
    s_lshl_b32 s43, s41, 1
    s_add_u32 s66, s42, s43
    s_mul_i32 s64, s66, 20480
    s_add_u32 s64, s64, 4194304
    s_add_u32 s46, s64, 0
    buffer_load_dwordx4 v[16:19], v15, s[32:35], s46 offen offset:0
    s_add_u32 s47, s64, 20480
    buffer_load_dwordx4 v[20:23], v15, s[32:35], s47 offen offset:0
    buffer_load_dwordx4 v[24:27], v15, s[32:35], s46 offen offset:1024
    buffer_load_dwordx4 v[28:31], v15, s[32:35], s47 offen offset:1024
    s_add_u32 s46, s64, 2048
    buffer_load_dwordx4 v[32:35], v15, s[32:35], s46 offen offset:0
    s_add_u32 s47, s64, 22528
    buffer_load_dwordx4 v[36:39], v15, s[32:35], s47 offen offset:0
    buffer_load_dwordx4 v[40:43], v15, s[32:35], s46 offen offset:1024
    buffer_load_dwordx4 v[44:47], v15, s[32:35], s47 offen offset:1024
    v_mov_b32 v96, 0
    v_mov_b32 v97, 0
    v_mov_b32 v98, 0
    v_mov_b32 v99, 0
    v_mov_b32 v100, 0
    v_mov_b32 v101, 0
    v_mov_b32 v102, 0
    v_mov_b32 v103, 0
    v_mov_b32 v104, 0
    v_mov_b32 v105, 0
    v_mov_b32 v106, 0
    v_mov_b32 v107, 0
    v_mov_b32 v108, 0
    v_mov_b32 v109, 0
    v_mov_b32 v110, 0
    v_mov_b32 v111, 0
    v_mov_b32 v112, 0
    v_mov_b32 v113, 0
    v_mov_b32 v114, 0
    v_mov_b32 v115, 0
    v_mov_b32 v116, 0
    v_mov_b32 v117, 0
    v_mov_b32 v118, 0
    v_mov_b32 v119, 0
    v_mov_b32 v120, 0
    v_mov_b32 v121, 0
    v_mov_b32 v122, 0
    v_mov_b32 v123, 0
    v_mov_b32 v124, 0
    v_mov_b32 v125, 0
    v_mov_b32 v126, 0
    v_mov_b32 v127, 0
    s_waitcnt vmcnt(4)
    s_barrier
    s_add_u32 s46, s64, 4096
    buffer_load_dwordx4 v[48:51], v15, s[32:35], s46 offen offset:0
    s_add_u32 s47, s64, 24576
    buffer_load_dwordx4 v[52:55], v15, s[32:35], s47 offen offset:0
    buffer_load_dwordx4 v[56:59], v15, s[32:35], s46 offen offset:1024
    buffer_load_dwordx4 v[60:63], v15, s[32:35], s47 offen offset:1024
    ds_read_b64_tr_b16 v[64:65], v128 offset:0
    ds_read_b64_tr_b16 v[66:67], v128 offset:2048
    ds_read_b64_tr_b16 v[68:69], v129 offset:0
    ds_read_b64_tr_b16 v[70:71], v129 offset:2048
    ds_read_b64_tr_b16 v[72:73], v128 offset:4096
    ds_read_b64_tr_b16 v[74:75], v128 offset:6144
    ds_read_b64_tr_b16 v[76:77], v129 offset:4096
    ds_read_b64_tr_b16 v[78:79], v129 offset:6144
    ds_read_b64_tr_b16 v[80:81], v128 offset:8192
    ds_read_b64_tr_b16 v[82:83], v128 offset:10240
    ds_read_b64_tr_b16 v[84:85], v129 offset:8192
    ds_read_b64_tr_b16 v[86:87], v129 offset:10240
    s_waitcnt lgkmcnt(10)
    v_mfma_f32_16x16x32_bf16 v[96:99], v[64:67], v[16:19], v[96:99]
    v_mfma_f32_16x16x32_bf16 v[100:103], v[64:67], v[20:23], v[100:103]
    ds_read_b64_tr_b16 v[88:89], v128 offset:12288
    ds_read_b64_tr_b16 v[90:91], v128 offset:14336
    s_waitcnt lgkmcnt(10)
    v_mfma_f32_16x16x32_bf16 v[104:107], v[68:71], v[16:19], v[104:107]
    v_mfma_f32_16x16x32_bf16 v[108:111], v[68:71], v[20:23], v[108:111]
    ds_read_b64_tr_b16 v[92:93], v129 offset:12288
    ds_read_b64_tr_b16 v[94:95], v129 offset:14336
    s_waitcnt lgkmcnt(10)
    v_mfma_f32_16x16x32_bf16 v[96:99], v[72:75], v[24:27], v[96:99]
    v_mfma_f32_16x16x32_bf16 v[100:103], v[72:75], v[28:31], v[100:103]
    s_waitcnt lgkmcnt(8)
    v_mfma_f32_16x16x32_bf16 v[104:107], v[76:79], v[24:27], v[104:107]
    v_mfma_f32_16x16x32_bf16 v[108:111], v[76:79], v[28:31], v[108:111]
    s_waitcnt lgkmcnt(6)
    v_mfma_f32_16x16x32_bf16 v[112:115], v[80:83], v[16:19], v[112:115]
    v_mfma_f32_16x16x32_bf16 v[116:119], v[80:83], v[20:23], v[116:119]
    s_waitcnt lgkmcnt(4)
    v_mfma_f32_16x16x32_bf16 v[120:123], v[84:87], v[16:19], v[120:123]
    v_mfma_f32_16x16x32_bf16 v[124:127], v[84:87], v[20:23], v[124:127]
    s_waitcnt lgkmcnt(2)
    v_mfma_f32_16x16x32_bf16 v[112:115], v[88:91], v[24:27], v[112:115]
    v_mfma_f32_16x16x32_bf16 v[116:119], v[88:91], v[28:31], v[116:119]
    s_waitcnt lgkmcnt(0)
    v_mfma_f32_16x16x32_bf16 v[120:123], v[92:95], v[24:27], v[120:123]
    v_mfma_f32_16x16x32_bf16 v[124:127], v[92:95], v[28:31], v[124:127]
    s_waitcnt vmcnt(4)
    s_barrier
    s_add_u32 s46, s64, 6144
    buffer_load_dwordx4 v[16:19], v15, s[32:35], s46 offen offset:0
    s_add_u32 s47, s64, 26624
    buffer_load_dwordx4 v[20:23], v15, s[32:35], s47 offen offset:0
    buffer_load_dwordx4 v[24:27], v15, s[32:35], s46 offen offset:1024
    buffer_load_dwordx4 v[28:31], v15, s[32:35], s47 offen offset:1024
    ds_read_b64_tr_b16 v[64:65], v128 offset:16384
    ds_read_b64_tr_b16 v[66:67], v128 offset:18432
    ds_read_b64_tr_b16 v[68:69], v129 offset:16384
    ds_read_b64_tr_b16 v[70:71], v129 offset:18432
    ds_read_b64_tr_b16 v[72:73], v128 offset:20480
    ds_read_b64_tr_b16 v[74:75], v128 offset:22528
    ds_read_b64_tr_b16 v[76:77], v129 offset:20480
    ds_read_b64_tr_b16 v[78:79], v129 offset:22528
    ds_read_b64_tr_b16 v[80:81], v128 offset:24576
    ds_read_b64_tr_b16 v[82:83], v128 offset:26624
    ds_read_b64_tr_b16 v[84:85], v129 offset:24576
    ds_read_b64_tr_b16 v[86:87], v129 offset:26624
    s_add_u32 m0, s60, 0
    s_add_u32 s45, s58, 1572864
    buffer_load_dwordx4 v132, s[8:11], s45 offen lds
    s_add_u32 m0, s60, 8192
    s_add_u32 s45, s58, 1572864
    buffer_load_dwordx4 v132, s[12:15], s45 offen lds
    s_waitcnt lgkmcnt(10)
    v_mfma_f32_16x16x32_bf16 v[96:99], v[64:67], v[32:35], v[96:99]
    v_mfma_f32_16x16x32_bf16 v[100:103], v[64:67], v[36:39], v[100:103]
    ds_read_b64_tr_b16 v[88:89], v128 offset:28672
    ds_read_b64_tr_b16 v[90:91], v128 offset:30720
    s_waitcnt lgkmcnt(10)
    v_mfma_f32_16x16x32_bf16 v[104:107], v[68:71], v[32:35], v[104:107]
    v_mfma_f32_16x16x32_bf16 v[108:111], v[68:71], v[36:39], v[108:111]
    ds_read_b64_tr_b16 v[92:93], v129 offset:28672
    ds_read_b64_tr_b16 v[94:95], v129 offset:30720
    s_waitcnt lgkmcnt(10)
    v_mfma_f32_16x16x32_bf16 v[96:99], v[72:75], v[40:43], v[96:99]
    v_mfma_f32_16x16x32_bf16 v[100:103], v[72:75], v[44:47], v[100:103]
    s_waitcnt lgkmcnt(8)
    v_mfma_f32_16x16x32_bf16 v[104:107], v[76:79], v[40:43], v[104:107]
    v_mfma_f32_16x16x32_bf16 v[108:111], v[76:79], v[44:47], v[108:111]
    s_waitcnt lgkmcnt(6)
    v_mfma_f32_16x16x32_bf16 v[112:115], v[80:83], v[32:35], v[112:115]
    v_mfma_f32_16x16x32_bf16 v[116:119], v[80:83], v[36:39], v[116:119]
    s_waitcnt lgkmcnt(4)
    v_mfma_f32_16x16x32_bf16 v[120:123], v[84:87], v[32:35], v[120:123]
    v_mfma_f32_16x16x32_bf16 v[124:127], v[84:87], v[36:39], v[124:127]
    s_waitcnt lgkmcnt(2)
    v_mfma_f32_16x16x32_bf16 v[112:115], v[88:91], v[40:43], v[112:115]
    v_mfma_f32_16x16x32_bf16 v[116:119], v[88:91], v[44:47], v[116:119]
    s_waitcnt lgkmcnt(0)
    v_mfma_f32_16x16x32_bf16 v[120:123], v[92:95], v[40:43], v[120:123]
    v_mfma_f32_16x16x32_bf16 v[124:127], v[92:95], v[44:47], v[124:127]
    s_waitcnt vmcnt(6)
    s_barrier
    s_add_u32 s46, s64, 8192
    buffer_load_dwordx4 v[32:35], v15, s[32:35], s46 offen offset:0
    s_add_u32 s47, s64, 28672
    buffer_load_dwordx4 v[36:39], v15, s[32:35], s47 offen offset:0
    buffer_load_dwordx4 v[40:43], v15, s[32:35], s46 offen offset:1024
    buffer_load_dwordx4 v[44:47], v15, s[32:35], s47 offen offset:1024
    ds_read_b64_tr_b16 v[64:65], v128 offset:32768
    ds_read_b64_tr_b16 v[66:67], v128 offset:34816
    ds_read_b64_tr_b16 v[68:69], v129 offset:32768
    ds_read_b64_tr_b16 v[70:71], v129 offset:34816
    ds_read_b64_tr_b16 v[72:73], v128 offset:36864
    ds_read_b64_tr_b16 v[74:75], v128 offset:38912
    ds_read_b64_tr_b16 v[76:77], v129 offset:36864
    ds_read_b64_tr_b16 v[78:79], v129 offset:38912
    ds_read_b64_tr_b16 v[80:81], v128 offset:40960
    ds_read_b64_tr_b16 v[82:83], v128 offset:43008
    ds_read_b64_tr_b16 v[84:85], v129 offset:40960
    ds_read_b64_tr_b16 v[86:87], v129 offset:43008
    s_add_u32 m0, s60, 16384
    s_add_u32 s45, s58, 1769472
    buffer_load_dwordx4 v132, s[8:11], s45 offen lds
    s_add_u32 m0, s60, 24576
    s_add_u32 s45, s58, 1769472
    buffer_load_dwordx4 v132, s[12:15], s45 offen lds
    s_waitcnt lgkmcnt(10)
    v_mfma_f32_16x16x32_bf16 v[96:99], v[64:67], v[48:51], v[96:99]
    v_mfma_f32_16x16x32_bf16 v[100:103], v[64:67], v[52:55], v[100:103]
    ds_read_b64_tr_b16 v[88:89], v128 offset:45056
    ds_read_b64_tr_b16 v[90:91], v128 offset:47104
    s_waitcnt lgkmcnt(10)
    v_mfma_f32_16x16x32_bf16 v[104:107], v[68:71], v[48:51], v[104:107]
    v_mfma_f32_16x16x32_bf16 v[108:111], v[68:71], v[52:55], v[108:111]
    ds_read_b64_tr_b16 v[92:93], v129 offset:45056
    ds_read_b64_tr_b16 v[94:95], v129 offset:47104
    s_waitcnt lgkmcnt(10)
    v_mfma_f32_16x16x32_bf16 v[96:99], v[72:75], v[56:59], v[96:99]
    v_mfma_f32_16x16x32_bf16 v[100:103], v[72:75], v[60:63], v[100:103]
    s_waitcnt lgkmcnt(8)
    v_mfma_f32_16x16x32_bf16 v[104:107], v[76:79], v[56:59], v[104:107]
    v_mfma_f32_16x16x32_bf16 v[108:111], v[76:79], v[60:63], v[108:111]
    s_waitcnt lgkmcnt(6)
    v_mfma_f32_16x16x32_bf16 v[112:115], v[80:83], v[48:51], v[112:115]
    v_mfma_f32_16x16x32_bf16 v[116:119], v[80:83], v[52:55], v[116:119]
    s_waitcnt lgkmcnt(4)
    v_mfma_f32_16x16x32_bf16 v[120:123], v[84:87], v[48:51], v[120:123]
    v_mfma_f32_16x16x32_bf16 v[124:127], v[84:87], v[52:55], v[124:127]
    s_waitcnt lgkmcnt(2)
    v_mfma_f32_16x16x32_bf16 v[112:115], v[88:91], v[56:59], v[112:115]
    v_mfma_f32_16x16x32_bf16 v[116:119], v[88:91], v[60:63], v[116:119]
    s_waitcnt lgkmcnt(0)
    v_mfma_f32_16x16x32_bf16 v[120:123], v[92:95], v[56:59], v[120:123]
    v_mfma_f32_16x16x32_bf16 v[124:127], v[92:95], v[60:63], v[124:127]
    s_waitcnt vmcnt(8)
    s_barrier
    s_add_u32 s46, s64, 10240
    buffer_load_dwordx4 v[48:51], v15, s[32:35], s46 offen offset:0
    s_add_u32 s47, s64, 30720
    buffer_load_dwordx4 v[52:55], v15, s[32:35], s47 offen offset:0
    buffer_load_dwordx4 v[56:59], v15, s[32:35], s46 offen offset:1024
    buffer_load_dwordx4 v[60:63], v15, s[32:35], s47 offen offset:1024
    ds_read_b64_tr_b16 v[64:65], v128 offset:49152
    ds_read_b64_tr_b16 v[66:67], v128 offset:51200
    ds_read_b64_tr_b16 v[68:69], v129 offset:49152
    ds_read_b64_tr_b16 v[70:71], v129 offset:51200
    ds_read_b64_tr_b16 v[72:73], v128 offset:53248
    ds_read_b64_tr_b16 v[74:75], v128 offset:55296
    ds_read_b64_tr_b16 v[76:77], v129 offset:53248
    ds_read_b64_tr_b16 v[78:79], v129 offset:55296
    ds_read_b64_tr_b16 v[80:81], v128 offset:57344
    ds_read_b64_tr_b16 v[82:83], v128 offset:59392
    ds_read_b64_tr_b16 v[84:85], v129 offset:57344
    ds_read_b64_tr_b16 v[86:87], v129 offset:59392
    s_waitcnt lgkmcnt(10)
    v_mfma_f32_16x16x32_bf16 v[96:99], v[64:67], v[16:19], v[96:99]
    v_mfma_f32_16x16x32_bf16 v[100:103], v[64:67], v[20:23], v[100:103]
    ds_read_b64_tr_b16 v[88:89], v128 offset:61440
    ds_read_b64_tr_b16 v[90:91], v128 offset:63488
    s_waitcnt lgkmcnt(10)
    v_mfma_f32_16x16x32_bf16 v[104:107], v[68:71], v[16:19], v[104:107]
    v_mfma_f32_16x16x32_bf16 v[108:111], v[68:71], v[20:23], v[108:111]
    ds_read_b64_tr_b16 v[92:93], v129 offset:61440
    ds_read_b64_tr_b16 v[94:95], v129 offset:63488
    s_waitcnt lgkmcnt(10)
    v_mfma_f32_16x16x32_bf16 v[96:99], v[72:75], v[24:27], v[96:99]
    v_mfma_f32_16x16x32_bf16 v[100:103], v[72:75], v[28:31], v[100:103]
    s_waitcnt lgkmcnt(8)
    v_mfma_f32_16x16x32_bf16 v[104:107], v[76:79], v[24:27], v[104:107]
    v_mfma_f32_16x16x32_bf16 v[108:111], v[76:79], v[28:31], v[108:111]
    s_waitcnt lgkmcnt(6)
    v_mfma_f32_16x16x32_bf16 v[112:115], v[80:83], v[16:19], v[112:115]
    v_mfma_f32_16x16x32_bf16 v[116:119], v[80:83], v[20:23], v[116:119]
    s_waitcnt lgkmcnt(4)
    v_mfma_f32_16x16x32_bf16 v[120:123], v[84:87], v[16:19], v[120:123]
    v_mfma_f32_16x16x32_bf16 v[124:127], v[84:87], v[20:23], v[124:127]
    s_waitcnt lgkmcnt(2)
    v_mfma_f32_16x16x32_bf16 v[112:115], v[88:91], v[24:27], v[112:115]
    v_mfma_f32_16x16x32_bf16 v[116:119], v[88:91], v[28:31], v[116:119]
    s_waitcnt lgkmcnt(0)
    v_mfma_f32_16x16x32_bf16 v[120:123], v[92:95], v[24:27], v[120:123]
    v_mfma_f32_16x16x32_bf16 v[124:127], v[92:95], v[28:31], v[124:127]
    s_waitcnt vmcnt(6)
    s_barrier
    s_add_u32 s46, s64, 12288
    buffer_load_dwordx4 v[16:19], v15, s[32:35], s46 offen offset:0
    s_add_u32 s47, s64, 32768
    buffer_load_dwordx4 v[20:23], v15, s[32:35], s47 offen offset:0
    buffer_load_dwordx4 v[24:27], v15, s[32:35], s46 offen offset:1024
    buffer_load_dwordx4 v[28:31], v15, s[32:35], s47 offen offset:1024
    ds_read_b64_tr_b16 v[64:65], v130 offset:0
    ds_read_b64_tr_b16 v[66:67], v130 offset:2048
    ds_read_b64_tr_b16 v[68:69], v131 offset:0
    ds_read_b64_tr_b16 v[70:71], v131 offset:2048
    ds_read_b64_tr_b16 v[72:73], v130 offset:4096
    ds_read_b64_tr_b16 v[74:75], v130 offset:6144
    ds_read_b64_tr_b16 v[76:77], v131 offset:4096
    ds_read_b64_tr_b16 v[78:79], v131 offset:6144
    ds_read_b64_tr_b16 v[80:81], v130 offset:8192
    ds_read_b64_tr_b16 v[82:83], v130 offset:10240
    ds_read_b64_tr_b16 v[84:85], v131 offset:8192
    ds_read_b64_tr_b16 v[86:87], v131 offset:10240
    s_waitcnt lgkmcnt(10)
    v_mfma_f32_16x16x32_bf16 v[96:99], v[64:67], v[32:35], v[96:99]
    v_mfma_f32_16x16x32_bf16 v[100:103], v[64:67], v[36:39], v[100:103]
    ds_read_b64_tr_b16 v[88:89], v130 offset:12288
    ds_read_b64_tr_b16 v[90:91], v130 offset:14336
    s_waitcnt lgkmcnt(10)
    v_mfma_f32_16x16x32_bf16 v[104:107], v[68:71], v[32:35], v[104:107]
    v_mfma_f32_16x16x32_bf16 v[108:111], v[68:71], v[36:39], v[108:111]
    ds_read_b64_tr_b16 v[92:93], v131 offset:12288
    ds_read_b64_tr_b16 v[94:95], v131 offset:14336
    s_waitcnt lgkmcnt(10)
    v_mfma_f32_16x16x32_bf16 v[96:99], v[72:75], v[40:43], v[96:99]
    v_mfma_f32_16x16x32_bf16 v[100:103], v[72:75], v[44:47], v[100:103]
    s_waitcnt lgkmcnt(8)
    v_mfma_f32_16x16x32_bf16 v[104:107], v[76:79], v[40:43], v[104:107]
    v_mfma_f32_16x16x32_bf16 v[108:111], v[76:79], v[44:47], v[108:111]
    s_waitcnt lgkmcnt(6)
    v_mfma_f32_16x16x32_bf16 v[112:115], v[80:83], v[32:35], v[112:115]
    v_mfma_f32_16x16x32_bf16 v[116:119], v[80:83], v[36:39], v[116:119]
    s_waitcnt lgkmcnt(4)
    v_mfma_f32_16x16x32_bf16 v[120:123], v[84:87], v[32:35], v[120:123]
    v_mfma_f32_16x16x32_bf16 v[124:127], v[84:87], v[36:39], v[124:127]
    s_waitcnt lgkmcnt(2)
    v_mfma_f32_16x16x32_bf16 v[112:115], v[88:91], v[40:43], v[112:115]
    v_mfma_f32_16x16x32_bf16 v[116:119], v[88:91], v[44:47], v[116:119]
    s_waitcnt lgkmcnt(0)
    v_mfma_f32_16x16x32_bf16 v[120:123], v[92:95], v[40:43], v[120:123]
    v_mfma_f32_16x16x32_bf16 v[124:127], v[92:95], v[44:47], v[124:127]
    s_waitcnt vmcnt(4)
    s_barrier
    s_add_u32 s46, s64, 14336
    buffer_load_dwordx4 v[32:35], v15, s[32:35], s46 offen offset:0
    s_add_u32 s47, s64, 34816
    buffer_load_dwordx4 v[36:39], v15, s[32:35], s47 offen offset:0
    buffer_load_dwordx4 v[40:43], v15, s[32:35], s46 offen offset:1024
    buffer_load_dwordx4 v[44:47], v15, s[32:35], s47 offen offset:1024
    ds_read_b64_tr_b16 v[64:65], v130 offset:16384
    ds_read_b64_tr_b16 v[66:67], v130 offset:18432
    ds_read_b64_tr_b16 v[68:69], v131 offset:16384
    ds_read_b64_tr_b16 v[70:71], v131 offset:18432
    ds_read_b64_tr_b16 v[72:73], v130 offset:20480
    ds_read_b64_tr_b16 v[74:75], v130 offset:22528
    ds_read_b64_tr_b16 v[76:77], v131 offset:20480
    ds_read_b64_tr_b16 v[78:79], v131 offset:22528
    ds_read_b64_tr_b16 v[80:81], v130 offset:24576
    ds_read_b64_tr_b16 v[82:83], v130 offset:26624
    ds_read_b64_tr_b16 v[84:85], v131 offset:24576
    ds_read_b64_tr_b16 v[86:87], v131 offset:26624
    s_waitcnt lgkmcnt(10)
    v_mfma_f32_16x16x32_bf16 v[96:99], v[64:67], v[48:51], v[96:99]
    v_mfma_f32_16x16x32_bf16 v[100:103], v[64:67], v[52:55], v[100:103]
    ds_read_b64_tr_b16 v[88:89], v130 offset:28672
    ds_read_b64_tr_b16 v[90:91], v130 offset:30720
    s_waitcnt lgkmcnt(10)
    v_mfma_f32_16x16x32_bf16 v[104:107], v[68:71], v[48:51], v[104:107]
    v_mfma_f32_16x16x32_bf16 v[108:111], v[68:71], v[52:55], v[108:111]
    ds_read_b64_tr_b16 v[92:93], v131 offset:28672
    ds_read_b64_tr_b16 v[94:95], v131 offset:30720
    s_waitcnt lgkmcnt(10)
    v_mfma_f32_16x16x32_bf16 v[96:99], v[72:75], v[56:59], v[96:99]
    v_mfma_f32_16x16x32_bf16 v[100:103], v[72:75], v[60:63], v[100:103]
    s_waitcnt lgkmcnt(8)
    v_mfma_f32_16x16x32_bf16 v[104:107], v[76:79], v[56:59], v[104:107]
    v_mfma_f32_16x16x32_bf16 v[108:111], v[76:79], v[60:63], v[108:111]
    s_waitcnt lgkmcnt(6)
    v_mfma_f32_16x16x32_bf16 v[112:115], v[80:83], v[48:51], v[112:115]
    v_mfma_f32_16x16x32_bf16 v[116:119], v[80:83], v[52:55], v[116:119]
    s_waitcnt lgkmcnt(4)
    v_mfma_f32_16x16x32_bf16 v[120:123], v[84:87], v[48:51], v[120:123]
    v_mfma_f32_16x16x32_bf16 v[124:127], v[84:87], v[52:55], v[124:127]
    s_waitcnt lgkmcnt(2)
    v_mfma_f32_16x16x32_bf16 v[112:115], v[88:91], v[56:59], v[112:115]
    v_mfma_f32_16x16x32_bf16 v[116:119], v[88:91], v[60:63], v[116:119]
    s_waitcnt lgkmcnt(0)
    v_mfma_f32_16x16x32_bf16 v[120:123], v[92:95], v[56:59], v[120:123]
    v_mfma_f32_16x16x32_bf16 v[124:127], v[92:95], v[60:63], v[124:127]
    s_waitcnt vmcnt(4)
    s_barrier
    s_add_u32 s46, s64, 16384
    buffer_load_dwordx4 v[48:51], v15, s[32:35], s46 offen offset:0
    s_add_u32 s47, s64, 36864
    buffer_load_dwordx4 v[52:55], v15, s[32:35], s47 offen offset:0
    buffer_load_dwordx4 v[56:59], v15, s[32:35], s46 offen offset:1024
    buffer_load_dwordx4 v[60:63], v15, s[32:35], s47 offen offset:1024
    ds_read_b64_tr_b16 v[64:65], v130 offset:32768
    ds_read_b64_tr_b16 v[66:67], v130 offset:34816
    ds_read_b64_tr_b16 v[68:69], v131 offset:32768
    ds_read_b64_tr_b16 v[70:71], v131 offset:34816
    ds_read_b64_tr_b16 v[72:73], v130 offset:36864
    ds_read_b64_tr_b16 v[74:75], v130 offset:38912
    ds_read_b64_tr_b16 v[76:77], v131 offset:36864
    ds_read_b64_tr_b16 v[78:79], v131 offset:38912
    ds_read_b64_tr_b16 v[80:81], v130 offset:40960
    ds_read_b64_tr_b16 v[82:83], v130 offset:43008
    ds_read_b64_tr_b16 v[84:85], v131 offset:40960
    ds_read_b64_tr_b16 v[86:87], v131 offset:43008
    s_waitcnt lgkmcnt(10)
    v_mfma_f32_16x16x32_bf16 v[96:99], v[64:67], v[16:19], v[96:99]
    v_mfma_f32_16x16x32_bf16 v[100:103], v[64:67], v[20:23], v[100:103]
    ds_read_b64_tr_b16 v[88:89], v130 offset:45056
    ds_read_b64_tr_b16 v[90:91], v130 offset:47104
    s_waitcnt lgkmcnt(10)
    v_mfma_f32_16x16x32_bf16 v[104:107], v[68:71], v[16:19], v[104:107]
    v_mfma_f32_16x16x32_bf16 v[108:111], v[68:71], v[20:23], v[108:111]
    ds_read_b64_tr_b16 v[92:93], v131 offset:45056
    ds_read_b64_tr_b16 v[94:95], v131 offset:47104
    s_waitcnt lgkmcnt(10)
    v_mfma_f32_16x16x32_bf16 v[96:99], v[72:75], v[24:27], v[96:99]
    v_mfma_f32_16x16x32_bf16 v[100:103], v[72:75], v[28:31], v[100:103]
    s_waitcnt lgkmcnt(8)
    v_mfma_f32_16x16x32_bf16 v[104:107], v[76:79], v[24:27], v[104:107]
    v_mfma_f32_16x16x32_bf16 v[108:111], v[76:79], v[28:31], v[108:111]
    s_waitcnt lgkmcnt(6)
    v_mfma_f32_16x16x32_bf16 v[112:115], v[80:83], v[16:19], v[112:115]
    v_mfma_f32_16x16x32_bf16 v[116:119], v[80:83], v[20:23], v[116:119]
    s_waitcnt lgkmcnt(4)
    v_mfma_f32_16x16x32_bf16 v[120:123], v[84:87], v[16:19], v[120:123]
    v_mfma_f32_16x16x32_bf16 v[124:127], v[84:87], v[20:23], v[124:127]
    s_waitcnt lgkmcnt(2)
    v_mfma_f32_16x16x32_bf16 v[112:115], v[88:91], v[24:27], v[112:115]
    v_mfma_f32_16x16x32_bf16 v[116:119], v[88:91], v[28:31], v[116:119]
    s_waitcnt lgkmcnt(0)
    v_mfma_f32_16x16x32_bf16 v[120:123], v[92:95], v[24:27], v[120:123]
    v_mfma_f32_16x16x32_bf16 v[124:127], v[92:95], v[28:31], v[124:127]
    s_waitcnt vmcnt(4)
    s_barrier
    s_add_u32 s46, s64, 18432
    buffer_load_dwordx4 v[16:19], v15, s[32:35], s46 offen offset:0
    s_add_u32 s47, s64, 38912
    buffer_load_dwordx4 v[20:23], v15, s[32:35], s47 offen offset:0
    buffer_load_dwordx4 v[24:27], v15, s[32:35], s46 offen offset:1024
    buffer_load_dwordx4 v[28:31], v15, s[32:35], s47 offen offset:1024
    ds_read_b64_tr_b16 v[64:65], v130 offset:49152
    ds_read_b64_tr_b16 v[66:67], v130 offset:51200
    ds_read_b64_tr_b16 v[68:69], v131 offset:49152
    ds_read_b64_tr_b16 v[70:71], v131 offset:51200
    ds_read_b64_tr_b16 v[72:73], v130 offset:53248
    ds_read_b64_tr_b16 v[74:75], v130 offset:55296
    ds_read_b64_tr_b16 v[76:77], v131 offset:53248
    ds_read_b64_tr_b16 v[78:79], v131 offset:55296
    ds_read_b64_tr_b16 v[80:81], v130 offset:57344
    ds_read_b64_tr_b16 v[82:83], v130 offset:59392
    ds_read_b64_tr_b16 v[84:85], v131 offset:57344
    ds_read_b64_tr_b16 v[86:87], v131 offset:59392
    s_waitcnt lgkmcnt(10)
    v_mfma_f32_16x16x32_bf16 v[96:99], v[64:67], v[32:35], v[96:99]
    v_mfma_f32_16x16x32_bf16 v[100:103], v[64:67], v[36:39], v[100:103]
    ds_read_b64_tr_b16 v[88:89], v130 offset:61440
    ds_read_b64_tr_b16 v[90:91], v130 offset:63488
    s_waitcnt lgkmcnt(10)
    v_mfma_f32_16x16x32_bf16 v[104:107], v[68:71], v[32:35], v[104:107]
    v_mfma_f32_16x16x32_bf16 v[108:111], v[68:71], v[36:39], v[108:111]
    ds_read_b64_tr_b16 v[92:93], v131 offset:61440
    ds_read_b64_tr_b16 v[94:95], v131 offset:63488
    s_waitcnt lgkmcnt(10)
    v_mfma_f32_16x16x32_bf16 v[96:99], v[72:75], v[40:43], v[96:99]
    v_mfma_f32_16x16x32_bf16 v[100:103], v[72:75], v[44:47], v[100:103]
    s_waitcnt lgkmcnt(8)
    v_mfma_f32_16x16x32_bf16 v[104:107], v[76:79], v[40:43], v[104:107]
    v_mfma_f32_16x16x32_bf16 v[108:111], v[76:79], v[44:47], v[108:111]
    s_waitcnt lgkmcnt(6)
    v_mfma_f32_16x16x32_bf16 v[112:115], v[80:83], v[32:35], v[112:115]
    v_mfma_f32_16x16x32_bf16 v[116:119], v[80:83], v[36:39], v[116:119]
    s_waitcnt lgkmcnt(4)
    v_mfma_f32_16x16x32_bf16 v[120:123], v[84:87], v[32:35], v[120:123]
    v_mfma_f32_16x16x32_bf16 v[124:127], v[84:87], v[36:39], v[124:127]
    s_waitcnt lgkmcnt(2)
    v_mfma_f32_16x16x32_bf16 v[112:115], v[88:91], v[40:43], v[112:115]
    v_mfma_f32_16x16x32_bf16 v[116:119], v[88:91], v[44:47], v[116:119]
    s_waitcnt lgkmcnt(0)
    v_mfma_f32_16x16x32_bf16 v[120:123], v[92:95], v[40:43], v[120:123]
    v_mfma_f32_16x16x32_bf16 v[124:127], v[92:95], v[44:47], v[124:127]
    s_waitcnt vmcnt(4)
    s_barrier
    ds_read_b64_tr_b16 v[64:65], v128 offset:0
    ds_read_b64_tr_b16 v[66:67], v128 offset:2048
    ds_read_b64_tr_b16 v[68:69], v129 offset:0
    ds_read_b64_tr_b16 v[70:71], v129 offset:2048
    ds_read_b64_tr_b16 v[72:73], v128 offset:4096
    ds_read_b64_tr_b16 v[74:75], v128 offset:6144
    ds_read_b64_tr_b16 v[76:77], v129 offset:4096
    ds_read_b64_tr_b16 v[78:79], v129 offset:6144
    ds_read_b64_tr_b16 v[80:81], v128 offset:8192
    ds_read_b64_tr_b16 v[82:83], v128 offset:10240
    ds_read_b64_tr_b16 v[84:85], v129 offset:8192
    ds_read_b64_tr_b16 v[86:87], v129 offset:10240
    s_waitcnt lgkmcnt(10)
    v_mfma_f32_16x16x32_bf16 v[96:99], v[64:67], v[48:51], v[96:99]
    v_mfma_f32_16x16x32_bf16 v[100:103], v[64:67], v[52:55], v[100:103]
    ds_read_b64_tr_b16 v[88:89], v128 offset:12288
    ds_read_b64_tr_b16 v[90:91], v128 offset:14336
    s_waitcnt lgkmcnt(10)
    v_mfma_f32_16x16x32_bf16 v[104:107], v[68:71], v[48:51], v[104:107]
    v_mfma_f32_16x16x32_bf16 v[108:111], v[68:71], v[52:55], v[108:111]
    ds_read_b64_tr_b16 v[92:93], v129 offset:12288
    ds_read_b64_tr_b16 v[94:95], v129 offset:14336
    s_waitcnt lgkmcnt(10)
    v_mfma_f32_16x16x32_bf16 v[96:99], v[72:75], v[56:59], v[96:99]
    v_mfma_f32_16x16x32_bf16 v[100:103], v[72:75], v[60:63], v[100:103]
    s_waitcnt lgkmcnt(8)
    v_mfma_f32_16x16x32_bf16 v[104:107], v[76:79], v[56:59], v[104:107]
    v_mfma_f32_16x16x32_bf16 v[108:111], v[76:79], v[60:63], v[108:111]
    s_waitcnt lgkmcnt(6)
    v_mfma_f32_16x16x32_bf16 v[112:115], v[80:83], v[48:51], v[112:115]
    v_mfma_f32_16x16x32_bf16 v[116:119], v[80:83], v[52:55], v[116:119]
    s_waitcnt lgkmcnt(4)
    v_mfma_f32_16x16x32_bf16 v[120:123], v[84:87], v[48:51], v[120:123]
    v_mfma_f32_16x16x32_bf16 v[124:127], v[84:87], v[52:55], v[124:127]
    s_waitcnt lgkmcnt(2)
    v_mfma_f32_16x16x32_bf16 v[112:115], v[88:91], v[56:59], v[112:115]
    v_mfma_f32_16x16x32_bf16 v[116:119], v[88:91], v[60:63], v[116:119]
    s_waitcnt lgkmcnt(0)
    v_mfma_f32_16x16x32_bf16 v[120:123], v[92:95], v[56:59], v[120:123]
    v_mfma_f32_16x16x32_bf16 v[124:127], v[92:95], v[60:63], v[124:127]
    s_waitcnt vmcnt(0)
    s_barrier
    ds_read_b64_tr_b16 v[64:65], v128 offset:16384
    ds_read_b64_tr_b16 v[66:67], v128 offset:18432
    ds_read_b64_tr_b16 v[68:69], v129 offset:16384
    ds_read_b64_tr_b16 v[70:71], v129 offset:18432
    ds_read_b64_tr_b16 v[72:73], v128 offset:20480
    ds_read_b64_tr_b16 v[74:75], v128 offset:22528
    ds_read_b64_tr_b16 v[76:77], v129 offset:20480
    ds_read_b64_tr_b16 v[78:79], v129 offset:22528
    ds_read_b64_tr_b16 v[80:81], v128 offset:24576
    ds_read_b64_tr_b16 v[82:83], v128 offset:26624
    ds_read_b64_tr_b16 v[84:85], v129 offset:24576
    ds_read_b64_tr_b16 v[86:87], v129 offset:26624
    s_waitcnt lgkmcnt(10)
    v_mfma_f32_16x16x32_bf16 v[96:99], v[64:67], v[16:19], v[96:99]
    v_mfma_f32_16x16x32_bf16 v[100:103], v[64:67], v[20:23], v[100:103]
    ds_read_b64_tr_b16 v[88:89], v128 offset:28672
    ds_read_b64_tr_b16 v[90:91], v128 offset:30720
    s_waitcnt lgkmcnt(10)
    v_mfma_f32_16x16x32_bf16 v[104:107], v[68:71], v[16:19], v[104:107]
    v_mfma_f32_16x16x32_bf16 v[108:111], v[68:71], v[20:23], v[108:111]
    ds_read_b64_tr_b16 v[92:93], v129 offset:28672
    ds_read_b64_tr_b16 v[94:95], v129 offset:30720
    s_waitcnt lgkmcnt(10)
    v_mfma_f32_16x16x32_bf16 v[96:99], v[72:75], v[24:27], v[96:99]
    v_mfma_f32_16x16x32_bf16 v[100:103], v[72:75], v[28:31], v[100:103]
    s_waitcnt lgkmcnt(8)
    v_mfma_f32_16x16x32_bf16 v[104:107], v[76:79], v[24:27], v[104:107]
    v_mfma_f32_16x16x32_bf16 v[108:111], v[76:79], v[28:31], v[108:111]
    s_waitcnt lgkmcnt(6)
    v_mfma_f32_16x16x32_bf16 v[112:115], v[80:83], v[16:19], v[112:115]
    v_mfma_f32_16x16x32_bf16 v[116:119], v[80:83], v[20:23], v[116:119]
    s_waitcnt lgkmcnt(4)
    v_mfma_f32_16x16x32_bf16 v[120:123], v[84:87], v[16:19], v[120:123]
    v_mfma_f32_16x16x32_bf16 v[124:127], v[84:87], v[20:23], v[124:127]
    s_waitcnt lgkmcnt(2)
    v_mfma_f32_16x16x32_bf16 v[112:115], v[88:91], v[24:27], v[112:115]
    v_mfma_f32_16x16x32_bf16 v[116:119], v[88:91], v[28:31], v[116:119]
    s_waitcnt lgkmcnt(0)
    v_mfma_f32_16x16x32_bf16 v[120:123], v[92:95], v[24:27], v[120:123]
    v_mfma_f32_16x16x32_bf16 v[124:127], v[92:95], v[28:31], v[124:127]
    s_nop 7
    s_nop 1
    s_mov_b32 s60, 0xc0135761
    s_mov_b32 s61, 0xbdd2d3e8
    s_mul_i32 s42, s66, 49152
    s_lshl_b32 s43, s57, 1
    s_add_u32 s43, s43, s39
    s_lshl_b32 s43, s43, 10
    s_add_u32 s42, s42, s43
    s_add_u32 s42, s42, 13631488
    v_cvt_pk_bf16_f32 v24, v96, v112
    v_lshlrev_b32 v96, 16, v24
    v_and_b32 v112, 0xffff0000, v24
    v_mul_f32 v25, v96, v96
    v_mov_b32 v26, s60
    v_fmac_f32 v26, s61, v25
    v_mul_f32 v26, v26, v96
    v_exp_f32 v26, v26
    s_nop 0
    v_add_f32 v26, 1.0, v26
    v_rcp_f32 v26, v26
    s_nop 0
    v_mul_f32 v26, v26, v96
    v_cvt_pk_bf16_f32 v26, v26, v26
    v_lshlrev_b32 v26, 16, v26
    v_mul_f32 v96, v26, v112
    v_cvt_pk_bf16_f32 v24, v97, v113
    v_lshlrev_b32 v97, 16, v24
    v_and_b32 v113, 0xffff0000, v24
    v_mul_f32 v25, v97, v97
    v_mov_b32 v26, s60
    v_fmac_f32 v26, s61, v25
    v_mul_f32 v26, v26, v97
    v_exp_f32 v26, v26
    s_nop 0
    v_add_f32 v26, 1.0, v26
    v_rcp_f32 v26, v26
    s_nop 0
    v_mul_f32 v26, v26, v97
    v_cvt_pk_bf16_f32 v26, v26, v26
    v_lshlrev_b32 v26, 16, v26
    v_mul_f32 v97, v26, v113
    v_cvt_pk_bf16_f32 v24, v98, v114
    v_lshlrev_b32 v98, 16, v24
    v_and_b32 v114, 0xffff0000, v24
    v_mul_f32 v25, v98, v98
    v_mov_b32 v26, s60
    v_fmac_f32 v26, s61, v25
    v_mul_f32 v26, v26, v98
    v_exp_f32 v26, v26
    s_nop 0
    v_add_f32 v26, 1.0, v26
    v_rcp_f32 v26, v26
    s_nop 0
    v_mul_f32 v26, v26, v98
    v_cvt_pk_bf16_f32 v26, v26, v26
    v_lshlrev_b32 v26, 16, v26
    v_mul_f32 v98, v26, v114
    v_cvt_pk_bf16_f32 v24, v99, v115
    v_lshlrev_b32 v99, 16, v24
    v_and_b32 v115, 0xffff0000, v24
    v_mul_f32 v25, v99, v99
    v_mov_b32 v26, s60
    v_fmac_f32 v26, s61, v25
    v_mul_f32 v26, v26, v99
    v_exp_f32 v26, v26
    s_nop 0
    v_add_f32 v26, 1.0, v26
    v_rcp_f32 v26, v26
    s_nop 0
    v_mul_f32 v26, v26, v99
    v_cvt_pk_bf16_f32 v26, v26, v26
    v_lshlrev_b32 v26, 16, v26
    v_mul_f32 v99, v26, v115
    v_cvt_pk_bf16_f32 v24, v104, v120
    v_lshlrev_b32 v104, 16, v24
    v_and_b32 v120, 0xffff0000, v24
    v_mul_f32 v25, v104, v104
    v_mov_b32 v26, s60
    v_fmac_f32 v26, s61, v25
    v_mul_f32 v26, v26, v104
    v_exp_f32 v26, v26
    s_nop 0
    v_add_f32 v26, 1.0, v26
    v_rcp_f32 v26, v26
    s_nop 0
    v_mul_f32 v26, v26, v104
    v_cvt_pk_bf16_f32 v26, v26, v26
    v_lshlrev_b32 v26, 16, v26
    v_mul_f32 v104, v26, v120
    v_cvt_pk_bf16_f32 v24, v105, v121
    v_lshlrev_b32 v105, 16, v24
    v_and_b32 v121, 0xffff0000, v24
    v_mul_f32 v25, v105, v105
    v_mov_b32 v26, s60
    v_fmac_f32 v26, s61, v25
    v_mul_f32 v26, v26, v105
    v_exp_f32 v26, v26
    s_nop 0
    v_add_f32 v26, 1.0, v26
    v_rcp_f32 v26, v26
    s_nop 0
    v_mul_f32 v26, v26, v105
    v_cvt_pk_bf16_f32 v26, v26, v26
    v_lshlrev_b32 v26, 16, v26
    v_mul_f32 v105, v26, v121
    v_cvt_pk_bf16_f32 v24, v106, v122
    v_lshlrev_b32 v106, 16, v24
    v_and_b32 v122, 0xffff0000, v24
    v_mul_f32 v25, v106, v106
    v_mov_b32 v26, s60
    v_fmac_f32 v26, s61, v25
    v_mul_f32 v26, v26, v106
    v_exp_f32 v26, v26
    s_nop 0
    v_add_f32 v26, 1.0, v26
    v_rcp_f32 v26, v26
    s_nop 0
    v_mul_f32 v26, v26, v106
    v_cvt_pk_bf16_f32 v26, v26, v26
    v_lshlrev_b32 v26, 16, v26
    v_mul_f32 v106, v26, v122
    v_cvt_pk_bf16_f32 v24, v107, v123
    v_lshlrev_b32 v107, 16, v24
    v_and_b32 v123, 0xffff0000, v24
    v_mul_f32 v25, v107, v107
    v_mov_b32 v26, s60
    v_fmac_f32 v26, s61, v25
    v_mul_f32 v26, v26, v107
    v_exp_f32 v26, v26
    s_nop 0
    v_add_f32 v26, 1.0, v26
    v_rcp_f32 v26, v26
    s_nop 0
    v_mul_f32 v26, v26, v107
    v_cvt_pk_bf16_f32 v26, v26, v26
    v_lshlrev_b32 v26, 16, v26
    v_mul_f32 v107, v26, v123
    v_cvt_pk_bf16_f32 v16, v96, v97
    v_cvt_pk_bf16_f32 v17, v98, v99
    v_cvt_pk_bf16_f32 v18, v104, v105
    v_cvt_pk_bf16_f32 v19, v106, v107
    s_add_u32 s43, s42, 0
    buffer_store_dwordx4 v[16:19], v15, s[32:35], s43 offen sc1
    v_cvt_pk_bf16_f32 v24, v100, v116
    v_lshlrev_b32 v100, 16, v24
    v_and_b32 v116, 0xffff0000, v24
    v_mul_f32 v25, v100, v100
    v_mov_b32 v26, s60
    v_fmac_f32 v26, s61, v25
    v_mul_f32 v26, v26, v100
    v_exp_f32 v26, v26
    s_nop 0
    v_add_f32 v26, 1.0, v26
    v_rcp_f32 v26, v26
    s_nop 0
    v_mul_f32 v26, v26, v100
    v_cvt_pk_bf16_f32 v26, v26, v26
    v_lshlrev_b32 v26, 16, v26
    v_mul_f32 v100, v26, v116
    v_cvt_pk_bf16_f32 v24, v101, v117
    v_lshlrev_b32 v101, 16, v24
    v_and_b32 v117, 0xffff0000, v24
    v_mul_f32 v25, v101, v101
    v_mov_b32 v26, s60
    v_fmac_f32 v26, s61, v25
    v_mul_f32 v26, v26, v101
    v_exp_f32 v26, v26
    s_nop 0
    v_add_f32 v26, 1.0, v26
    v_rcp_f32 v26, v26
    s_nop 0
    v_mul_f32 v26, v26, v101
    v_cvt_pk_bf16_f32 v26, v26, v26
    v_lshlrev_b32 v26, 16, v26
    v_mul_f32 v101, v26, v117
    v_cvt_pk_bf16_f32 v24, v102, v118
    v_lshlrev_b32 v102, 16, v24
    v_and_b32 v118, 0xffff0000, v24
    v_mul_f32 v25, v102, v102
    v_mov_b32 v26, s60
    v_fmac_f32 v26, s61, v25
    v_mul_f32 v26, v26, v102
    v_exp_f32 v26, v26
    s_nop 0
    v_add_f32 v26, 1.0, v26
    v_rcp_f32 v26, v26
    s_nop 0
    v_mul_f32 v26, v26, v102
    v_cvt_pk_bf16_f32 v26, v26, v26
    v_lshlrev_b32 v26, 16, v26
    v_mul_f32 v102, v26, v118
    v_cvt_pk_bf16_f32 v24, v103, v119
    v_lshlrev_b32 v103, 16, v24
    v_and_b32 v119, 0xffff0000, v24
    v_mul_f32 v25, v103, v103
    v_mov_b32 v26, s60
    v_fmac_f32 v26, s61, v25
    v_mul_f32 v26, v26, v103
    v_exp_f32 v26, v26
    s_nop 0
    v_add_f32 v26, 1.0, v26
    v_rcp_f32 v26, v26
    s_nop 0
    v_mul_f32 v26, v26, v103
    v_cvt_pk_bf16_f32 v26, v26, v26
    v_lshlrev_b32 v26, 16, v26
    v_mul_f32 v103, v26, v119
    v_cvt_pk_bf16_f32 v24, v108, v124
    v_lshlrev_b32 v108, 16, v24
    v_and_b32 v124, 0xffff0000, v24
    v_mul_f32 v25, v108, v108
    v_mov_b32 v26, s60
    v_fmac_f32 v26, s61, v25
    v_mul_f32 v26, v26, v108
    v_exp_f32 v26, v26
    s_nop 0
    v_add_f32 v26, 1.0, v26
    v_rcp_f32 v26, v26
    s_nop 0
    v_mul_f32 v26, v26, v108
    v_cvt_pk_bf16_f32 v26, v26, v26
    v_lshlrev_b32 v26, 16, v26
    v_mul_f32 v108, v26, v124
    v_cvt_pk_bf16_f32 v24, v109, v125
    v_lshlrev_b32 v109, 16, v24
    v_and_b32 v125, 0xffff0000, v24
    v_mul_f32 v25, v109, v109
    v_mov_b32 v26, s60
    v_fmac_f32 v26, s61, v25
    v_mul_f32 v26, v26, v109
    v_exp_f32 v26, v26
    s_nop 0
    v_add_f32 v26, 1.0, v26
    v_rcp_f32 v26, v26
    s_nop 0
    v_mul_f32 v26, v26, v109
    v_cvt_pk_bf16_f32 v26, v26, v26
    v_lshlrev_b32 v26, 16, v26
    v_mul_f32 v109, v26, v125
    v_cvt_pk_bf16_f32 v24, v110, v126
    v_lshlrev_b32 v110, 16, v24
    v_and_b32 v126, 0xffff0000, v24
    v_mul_f32 v25, v110, v110
    v_mov_b32 v26, s60
    v_fmac_f32 v26, s61, v25
    v_mul_f32 v26, v26, v110
    v_exp_f32 v26, v26
    s_nop 0
    v_add_f32 v26, 1.0, v26
    v_rcp_f32 v26, v26
    s_nop 0
    v_mul_f32 v26, v26, v110
    v_cvt_pk_bf16_f32 v26, v26, v26
    v_lshlrev_b32 v26, 16, v26
    v_mul_f32 v110, v26, v126
    v_cvt_pk_bf16_f32 v24, v111, v127
    v_lshlrev_b32 v111, 16, v24
    v_and_b32 v127, 0xffff0000, v24
    v_mul_f32 v25, v111, v111
    v_mov_b32 v26, s60
    v_fmac_f32 v26, s61, v25
    v_mul_f32 v26, v26, v111
    v_exp_f32 v26, v26
    s_nop 0
    v_add_f32 v26, 1.0, v26
    v_rcp_f32 v26, v26
    s_nop 0
    v_mul_f32 v26, v26, v111
    v_cvt_pk_bf16_f32 v26, v26, v26
    v_lshlrev_b32 v26, 16, v26
    v_mul_f32 v111, v26, v127
    v_cvt_pk_bf16_f32 v20, v100, v101
    v_cvt_pk_bf16_f32 v21, v102, v103
    v_cvt_pk_bf16_f32 v22, v108, v109
    v_cvt_pk_bf16_f32 v23, v110, v111
    s_add_u32 s43, s42, 49152
    buffer_store_dwordx4 v[20:23], v15, s[32:35], s43 offen sc1
    s_branch WDONE
B_FB:
    s_load_dwordx2 s[4:5], s[0:1], 80
    s_load_dwordx2 s[6:7], s[0:1], 104
    s_waitcnt lgkmcnt(0)
    s_mov_b32 s8, s4
    s_mov_b32 s9, s5
    s_mov_b32 s10, 1966080
    s_mov_b32 s11, 0x00020000
    s_mov_b32 s12, s6
    s_mov_b32 s13, s7
    s_mov_b32 s14, 2621440
    s_mov_b32 s15, 0x00020000
    v_lshlrev_b32 v15, 4, v1
    s_lshl_b32 s42, s56, 2
    s_add_u32 s66, s42, s41
    s_mul_i32 s64, s66, 49152
    s_add_u32 s64, s64, 13631488
    s_mul_i32 s42, s66, 20
    s_lshl_b32 s43, s57, 1
    s_add_u32 s42, s42, s43
    s_add_u32 s42, s42, s39
    s_lshl_b32 s42, s42, 10
    s_add_u32 s42, s42, 7340032
    buffer_load_dwordx4 v[208:211], v15, s[32:35], s42 offen
    s_add_u32 s46, s64, 0
    buffer_load_dwordx4 v[16:19], v15, s[32:35], s46 offen offset:0
    buffer_load_dwordx4 v[20:23], v15, s[32:35], s46 offen offset:1024
    buffer_load_dwordx4 v[24:27], v15, s[32:35], s46 offen offset:2048
    buffer_load_dwordx4 v[28:31], v15, s[32:35], s46 offen offset:3072
    s_add_u32 s46, s64, 4096
    buffer_load_dwordx4 v[32:35], v15, s[32:35], s46 offen offset:0
    buffer_load_dwordx4 v[36:39], v15, s[32:35], s46 offen offset:1024
    buffer_load_dwordx4 v[40:43], v15, s[32:35], s46 offen offset:2048
    buffer_load_dwordx4 v[44:47], v15, s[32:35], s46 offen offset:3072
    v_mov_b32 v96, 0
    v_mov_b32 v97, 0
    v_mov_b32 v98, 0
    v_mov_b32 v99, 0
    v_mov_b32 v100, 0
    v_mov_b32 v101, 0
    v_mov_b32 v102, 0
    v_mov_b32 v103, 0
    s_waitcnt vmcnt(4)
    s_barrier
    s_add_u32 s46, s64, 8192
    buffer_load_dwordx4 v[48:51], v15, s[32:35], s46 offen offset:0
    buffer_load_dwordx4 v[52:55], v15, s[32:35], s46 offen offset:1024
    buffer_load_dwordx4 v[56:59], v15, s[32:35], s46 offen offset:2048
    buffer_load_dwordx4 v[60:63], v15, s[32:35], s46 offen offset:3072
    ds_read_b64_tr_b16 v[64:65], v104 offset:0
    ds_read_b64_tr_b16 v[66:67], v104 offset:2048
    ds_read_b64_tr_b16 v[68:69], v105 offset:0
    ds_read_b64_tr_b16 v[70:71], v105 offset:2048
    ds_read_b64_tr_b16 v[72:73], v104 offset:4096
    ds_read_b64_tr_b16 v[74:75], v104 offset:6144
    ds_read_b64_tr_b16 v[76:77], v105 offset:4096
    ds_read_b64_tr_b16 v[78:79], v105 offset:6144
    ds_read_b64_tr_b16 v[80:81], v104 offset:8192
    ds_read_b64_tr_b16 v[82:83], v104 offset:10240
    ds_read_b64_tr_b16 v[84:85], v105 offset:8192
    ds_read_b64_tr_b16 v[86:87], v105 offset:10240
    s_waitcnt lgkmcnt(10)
    v_mfma_f32_16x16x32_bf16 v[96:99], v[64:67], v[16:19], v[96:99]
    ds_read_b64_tr_b16 v[88:89], v104 offset:12288
    ds_read_b64_tr_b16 v[90:91], v104 offset:14336
    s_waitcnt lgkmcnt(10)
    v_mfma_f32_16x16x32_bf16 v[100:103], v[68:71], v[16:19], v[100:103]
    ds_read_b64_tr_b16 v[92:93], v105 offset:12288
    ds_read_b64_tr_b16 v[94:95], v105 offset:14336
    s_waitcnt lgkmcnt(10)
    v_mfma_f32_16x16x32_bf16 v[96:99], v[72:75], v[20:23], v[96:99]
    s_waitcnt lgkmcnt(8)
    v_mfma_f32_16x16x32_bf16 v[100:103], v[76:79], v[20:23], v[100:103]
    s_waitcnt lgkmcnt(6)
    v_mfma_f32_16x16x32_bf16 v[96:99], v[80:83], v[24:27], v[96:99]
    s_waitcnt lgkmcnt(4)
    v_mfma_f32_16x16x32_bf16 v[100:103], v[84:87], v[24:27], v[100:103]
    s_waitcnt lgkmcnt(2)
    v_mfma_f32_16x16x32_bf16 v[96:99], v[88:91], v[28:31], v[96:99]
    s_waitcnt lgkmcnt(0)
    v_mfma_f32_16x16x32_bf16 v[100:103], v[92:95], v[28:31], v[100:103]
    s_waitcnt vmcnt(4)
    s_barrier
    s_add_u32 s46, s64, 12288
    buffer_load_dwordx4 v[16:19], v15, s[32:35], s46 offen offset:0
    buffer_load_dwordx4 v[20:23], v15, s[32:35], s46 offen offset:1024
    buffer_load_dwordx4 v[24:27], v15, s[32:35], s46 offen offset:2048
    buffer_load_dwordx4 v[28:31], v15, s[32:35], s46 offen offset:3072
    ds_read_b64_tr_b16 v[64:65], v104 offset:16384
    ds_read_b64_tr_b16 v[66:67], v104 offset:18432
    ds_read_b64_tr_b16 v[68:69], v105 offset:16384
    ds_read_b64_tr_b16 v[70:71], v105 offset:18432
    ds_read_b64_tr_b16 v[72:73], v104 offset:20480
    ds_read_b64_tr_b16 v[74:75], v104 offset:22528
    ds_read_b64_tr_b16 v[76:77], v105 offset:20480
    ds_read_b64_tr_b16 v[78:79], v105 offset:22528
    ds_read_b64_tr_b16 v[80:81], v104 offset:24576
    ds_read_b64_tr_b16 v[82:83], v104 offset:26624
    ds_read_b64_tr_b16 v[84:85], v105 offset:24576
    ds_read_b64_tr_b16 v[86:87], v105 offset:26624
    s_add_u32 m0, s60, 0
    s_add_u32 s45, s58, 1310720
    buffer_load_dwordx4 v108, s[8:11], s45 offen lds
    s_add_u32 m0, s60, 8192
    s_add_u32 s45, s58, 1392640
    buffer_load_dwordx4 v108, s[8:11], s45 offen lds
    s_waitcnt lgkmcnt(10)
    v_mfma_f32_16x16x32_bf16 v[96:99], v[64:67], v[32:35], v[96:99]
    ds_read_b64_tr_b16 v[88:89], v104 offset:28672
    ds_read_b64_tr_b16 v[90:91], v104 offset:30720
    s_waitcnt lgkmcnt(10)
    v_mfma_f32_16x16x32_bf16 v[100:103], v[68:71], v[32:35], v[100:103]
    ds_read_b64_tr_b16 v[92:93], v105 offset:28672
    ds_read_b64_tr_b16 v[94:95], v105 offset:30720
    s_waitcnt lgkmcnt(10)
    v_mfma_f32_16x16x32_bf16 v[96:99], v[72:75], v[36:39], v[96:99]
    s_waitcnt lgkmcnt(8)
    v_mfma_f32_16x16x32_bf16 v[100:103], v[76:79], v[36:39], v[100:103]
    s_waitcnt lgkmcnt(6)
    v_mfma_f32_16x16x32_bf16 v[96:99], v[80:83], v[40:43], v[96:99]
    s_waitcnt lgkmcnt(4)
    v_mfma_f32_16x16x32_bf16 v[100:103], v[84:87], v[40:43], v[100:103]
    s_waitcnt lgkmcnt(2)
    v_mfma_f32_16x16x32_bf16 v[96:99], v[88:91], v[44:47], v[96:99]
    s_waitcnt lgkmcnt(0)
    v_mfma_f32_16x16x32_bf16 v[100:103], v[92:95], v[44:47], v[100:103]
    s_waitcnt vmcnt(6)
    s_barrier
    s_add_u32 s46, s64, 16384
    buffer_load_dwordx4 v[32:35], v15, s[32:35], s46 offen offset:0
    buffer_load_dwordx4 v[36:39], v15, s[32:35], s46 offen offset:1024
    buffer_load_dwordx4 v[40:43], v15, s[32:35], s46 offen offset:2048
    buffer_load_dwordx4 v[44:47], v15, s[32:35], s46 offen offset:3072
    ds_read_b64_tr_b16 v[64:65], v104 offset:32768
    ds_read_b64_tr_b16 v[66:67], v104 offset:34816
    ds_read_b64_tr_b16 v[68:69], v105 offset:32768
    ds_read_b64_tr_b16 v[70:71], v105 offset:34816
    ds_read_b64_tr_b16 v[72:73], v104 offset:36864
    ds_read_b64_tr_b16 v[74:75], v104 offset:38912
    ds_read_b64_tr_b16 v[76:77], v105 offset:36864
    ds_read_b64_tr_b16 v[78:79], v105 offset:38912
    ds_read_b64_tr_b16 v[80:81], v104 offset:40960
    ds_read_b64_tr_b16 v[82:83], v104 offset:43008
    ds_read_b64_tr_b16 v[84:85], v105 offset:40960
    ds_read_b64_tr_b16 v[86:87], v105 offset:43008
    s_add_u32 m0, s60, 16384
    s_add_u32 s45, s58, 1474560
    buffer_load_dwordx4 v108, s[8:11], s45 offen lds
    s_add_u32 m0, s60, 24576
    s_add_u32 s45, s58, 1556480
    buffer_load_dwordx4 v108, s[8:11], s45 offen lds
    s_waitcnt lgkmcnt(10)
    v_mfma_f32_16x16x32_bf16 v[96:99], v[64:67], v[48:51], v[96:99]
    ds_read_b64_tr_b16 v[88:89], v104 offset:45056
    ds_read_b64_tr_b16 v[90:91], v104 offset:47104
    s_waitcnt lgkmcnt(10)
    v_mfma_f32_16x16x32_bf16 v[100:103], v[68:71], v[48:51], v[100:103]
    ds_read_b64_tr_b16 v[92:93], v105 offset:45056
    ds_read_b64_tr_b16 v[94:95], v105 offset:47104
    s_waitcnt lgkmcnt(10)
    v_mfma_f32_16x16x32_bf16 v[96:99], v[72:75], v[52:55], v[96:99]
    s_waitcnt lgkmcnt(8)
    v_mfma_f32_16x16x32_bf16 v[100:103], v[76:79], v[52:55], v[100:103]
    s_waitcnt lgkmcnt(6)
    v_mfma_f32_16x16x32_bf16 v[96:99], v[80:83], v[56:59], v[96:99]
    s_waitcnt lgkmcnt(4)
    v_mfma_f32_16x16x32_bf16 v[100:103], v[84:87], v[56:59], v[100:103]
    s_waitcnt lgkmcnt(2)
    v_mfma_f32_16x16x32_bf16 v[96:99], v[88:91], v[60:63], v[96:99]
    s_waitcnt lgkmcnt(0)
    v_mfma_f32_16x16x32_bf16 v[100:103], v[92:95], v[60:63], v[100:103]
    s_waitcnt vmcnt(8)
    s_barrier
    s_add_u32 s46, s64, 20480
    buffer_load_dwordx4 v[48:51], v15, s[32:35], s46 offen offset:0
    buffer_load_dwordx4 v[52:55], v15, s[32:35], s46 offen offset:1024
    buffer_load_dwordx4 v[56:59], v15, s[32:35], s46 offen offset:2048
    buffer_load_dwordx4 v[60:63], v15, s[32:35], s46 offen offset:3072
    ds_read_b64_tr_b16 v[64:65], v104 offset:49152
    ds_read_b64_tr_b16 v[66:67], v104 offset:51200
    ds_read_b64_tr_b16 v[68:69], v105 offset:49152
    ds_read_b64_tr_b16 v[70:71], v105 offset:51200
    ds_read_b64_tr_b16 v[72:73], v104 offset:53248
    ds_read_b64_tr_b16 v[74:75], v104 offset:55296
    ds_read_b64_tr_b16 v[76:77], v105 offset:53248
    ds_read_b64_tr_b16 v[78:79], v105 offset:55296
    ds_read_b64_tr_b16 v[80:81], v104 offset:57344
    ds_read_b64_tr_b16 v[82:83], v104 offset:59392
    ds_read_b64_tr_b16 v[84:85], v105 offset:57344
    ds_read_b64_tr_b16 v[86:87], v105 offset:59392
    s_add_u32 m0, s60, 32768
    s_add_u32 s45, s58, 1638400
    buffer_load_dwordx4 v108, s[8:11], s45 offen lds
    s_add_u32 m0, s60, 40960
    s_add_u32 s45, s58, 1720320
    buffer_load_dwordx4 v108, s[8:11], s45 offen lds
    s_waitcnt lgkmcnt(10)
    v_mfma_f32_16x16x32_bf16 v[96:99], v[64:67], v[16:19], v[96:99]
    ds_read_b64_tr_b16 v[88:89], v104 offset:61440
    ds_read_b64_tr_b16 v[90:91], v104 offset:63488
    s_waitcnt lgkmcnt(10)
    v_mfma_f32_16x16x32_bf16 v[100:103], v[68:71], v[16:19], v[100:103]
    ds_read_b64_tr_b16 v[92:93], v105 offset:61440
    ds_read_b64_tr_b16 v[94:95], v105 offset:63488
    s_waitcnt lgkmcnt(10)
    v_mfma_f32_16x16x32_bf16 v[96:99], v[72:75], v[20:23], v[96:99]
    s_waitcnt lgkmcnt(8)
    v_mfma_f32_16x16x32_bf16 v[100:103], v[76:79], v[20:23], v[100:103]
    s_waitcnt lgkmcnt(6)
    v_mfma_f32_16x16x32_bf16 v[96:99], v[80:83], v[24:27], v[96:99]
    s_waitcnt lgkmcnt(4)
    v_mfma_f32_16x16x32_bf16 v[100:103], v[84:87], v[24:27], v[100:103]
    s_waitcnt lgkmcnt(2)
    v_mfma_f32_16x16x32_bf16 v[96:99], v[88:91], v[28:31], v[96:99]
    s_waitcnt lgkmcnt(0)
    v_mfma_f32_16x16x32_bf16 v[100:103], v[92:95], v[28:31], v[100:103]
    s_waitcnt vmcnt(8)
    s_barrier
    s_add_u32 s46, s64, 24576
    buffer_load_dwordx4 v[16:19], v15, s[32:35], s46 offen offset:0
    buffer_load_dwordx4 v[20:23], v15, s[32:35], s46 offen offset:1024
    buffer_load_dwordx4 v[24:27], v15, s[32:35], s46 offen offset:2048
    buffer_load_dwordx4 v[28:31], v15, s[32:35], s46 offen offset:3072
    ds_read_b64_tr_b16 v[64:65], v106 offset:0
    ds_read_b64_tr_b16 v[66:67], v106 offset:2048
    ds_read_b64_tr_b16 v[68:69], v107 offset:0
    ds_read_b64_tr_b16 v[70:71], v107 offset:2048
    ds_read_b64_tr_b16 v[72:73], v106 offset:4096
    ds_read_b64_tr_b16 v[74:75], v106 offset:6144
    ds_read_b64_tr_b16 v[76:77], v107 offset:4096
    ds_read_b64_tr_b16 v[78:79], v107 offset:6144
    ds_read_b64_tr_b16 v[80:81], v106 offset:8192
    ds_read_b64_tr_b16 v[82:83], v106 offset:10240
    ds_read_b64_tr_b16 v[84:85], v107 offset:8192
    ds_read_b64_tr_b16 v[86:87], v107 offset:10240
    s_add_u32 m0, s60, 49152
    s_add_u32 s45, s58, 1802240
    buffer_load_dwordx4 v108, s[8:11], s45 offen lds
    s_add_u32 m0, s60, 57344
    s_add_u32 s45, s58, 1884160
    buffer_load_dwordx4 v108, s[8:11], s45 offen lds
    s_waitcnt lgkmcnt(10)
    v_mfma_f32_16x16x32_bf16 v[96:99], v[64:67], v[32:35], v[96:99]
    ds_read_b64_tr_b16 v[88:89], v106 offset:12288
    ds_read_b64_tr_b16 v[90:91], v106 offset:14336
    s_waitcnt lgkmcnt(10)
    v_mfma_f32_16x16x32_bf16 v[100:103], v[68:71], v[32:35], v[100:103]
    ds_read_b64_tr_b16 v[92:93], v107 offset:12288
    ds_read_b64_tr_b16 v[94:95], v107 offset:14336
    s_waitcnt lgkmcnt(10)
    v_mfma_f32_16x16x32_bf16 v[96:99], v[72:75], v[36:39], v[96:99]
    s_waitcnt lgkmcnt(8)
    v_mfma_f32_16x16x32_bf16 v[100:103], v[76:79], v[36:39], v[100:103]
    s_waitcnt lgkmcnt(6)
    v_mfma_f32_16x16x32_bf16 v[96:99], v[80:83], v[40:43], v[96:99]
    s_waitcnt lgkmcnt(4)
    v_mfma_f32_16x16x32_bf16 v[100:103], v[84:87], v[40:43], v[100:103]
    s_waitcnt lgkmcnt(2)
    v_mfma_f32_16x16x32_bf16 v[96:99], v[88:91], v[44:47], v[96:99]
    s_waitcnt lgkmcnt(0)
    v_mfma_f32_16x16x32_bf16 v[100:103], v[92:95], v[44:47], v[100:103]
    s_waitcnt vmcnt(8)
    s_barrier
    s_add_u32 s46, s64, 28672
    buffer_load_dwordx4 v[32:35], v15, s[32:35], s46 offen offset:0
    buffer_load_dwordx4 v[36:39], v15, s[32:35], s46 offen offset:1024
    buffer_load_dwordx4 v[40:43], v15, s[32:35], s46 offen offset:2048
    buffer_load_dwordx4 v[44:47], v15, s[32:35], s46 offen offset:3072
    ds_read_b64_tr_b16 v[64:65], v106 offset:16384
    ds_read_b64_tr_b16 v[66:67], v106 offset:18432
    ds_read_b64_tr_b16 v[68:69], v107 offset:16384
    ds_read_b64_tr_b16 v[70:71], v107 offset:18432
    ds_read_b64_tr_b16 v[72:73], v106 offset:20480
    ds_read_b64_tr_b16 v[74:75], v106 offset:22528
    ds_read_b64_tr_b16 v[76:77], v107 offset:20480
    ds_read_b64_tr_b16 v[78:79], v107 offset:22528
    ds_read_b64_tr_b16 v[80:81], v106 offset:24576
    ds_read_b64_tr_b16 v[82:83], v106 offset:26624
    ds_read_b64_tr_b16 v[84:85], v107 offset:24576
    ds_read_b64_tr_b16 v[86:87], v107 offset:26624
    s_waitcnt lgkmcnt(10)
    v_mfma_f32_16x16x32_bf16 v[96:99], v[64:67], v[48:51], v[96:99]
    ds_read_b64_tr_b16 v[88:89], v106 offset:28672
    ds_read_b64_tr_b16 v[90:91], v106 offset:30720
    s_waitcnt lgkmcnt(10)
    v_mfma_f32_16x16x32_bf16 v[100:103], v[68:71], v[48:51], v[100:103]
    ds_read_b64_tr_b16 v[92:93], v107 offset:28672
    ds_read_b64_tr_b16 v[94:95], v107 offset:30720
    s_waitcnt lgkmcnt(10)
    v_mfma_f32_16x16x32_bf16 v[96:99], v[72:75], v[52:55], v[96:99]
    s_waitcnt lgkmcnt(8)
    v_mfma_f32_16x16x32_bf16 v[100:103], v[76:79], v[52:55], v[100:103]
    s_waitcnt lgkmcnt(6)
    v_mfma_f32_16x16x32_bf16 v[96:99], v[80:83], v[56:59], v[96:99]
    s_waitcnt lgkmcnt(4)
    v_mfma_f32_16x16x32_bf16 v[100:103], v[84:87], v[56:59], v[100:103]
    s_waitcnt lgkmcnt(2)
    v_mfma_f32_16x16x32_bf16 v[96:99], v[88:91], v[60:63], v[96:99]
    s_waitcnt lgkmcnt(0)
    v_mfma_f32_16x16x32_bf16 v[100:103], v[92:95], v[60:63], v[100:103]
    s_waitcnt vmcnt(6)
    s_barrier
    s_add_u32 s46, s64, 32768
    buffer_load_dwordx4 v[48:51], v15, s[32:35], s46 offen offset:0
    buffer_load_dwordx4 v[52:55], v15, s[32:35], s46 offen offset:1024
    buffer_load_dwordx4 v[56:59], v15, s[32:35], s46 offen offset:2048
    buffer_load_dwordx4 v[60:63], v15, s[32:35], s46 offen offset:3072
    ds_read_b64_tr_b16 v[64:65], v106 offset:32768
    ds_read_b64_tr_b16 v[66:67], v106 offset:34816
    ds_read_b64_tr_b16 v[68:69], v107 offset:32768
    ds_read_b64_tr_b16 v[70:71], v107 offset:34816
    ds_read_b64_tr_b16 v[72:73], v106 offset:36864
    ds_read_b64_tr_b16 v[74:75], v106 offset:38912
    ds_read_b64_tr_b16 v[76:77], v107 offset:36864
    ds_read_b64_tr_b16 v[78:79], v107 offset:38912
    ds_read_b64_tr_b16 v[80:81], v106 offset:40960
    ds_read_b64_tr_b16 v[82:83], v106 offset:43008
    ds_read_b64_tr_b16 v[84:85], v107 offset:40960
    ds_read_b64_tr_b16 v[86:87], v107 offset:43008
    s_waitcnt lgkmcnt(10)
    v_mfma_f32_16x16x32_bf16 v[96:99], v[64:67], v[16:19], v[96:99]
    ds_read_b64_tr_b16 v[88:89], v106 offset:45056
    ds_read_b64_tr_b16 v[90:91], v106 offset:47104
    s_waitcnt lgkmcnt(10)
    v_mfma_f32_16x16x32_bf16 v[100:103], v[68:71], v[16:19], v[100:103]
    ds_read_b64_tr_b16 v[92:93], v107 offset:45056
    ds_read_b64_tr_b16 v[94:95], v107 offset:47104
    s_waitcnt lgkmcnt(10)
    v_mfma_f32_16x16x32_bf16 v[96:99], v[72:75], v[20:23], v[96:99]
    s_waitcnt lgkmcnt(8)
    v_mfma_f32_16x16x32_bf16 v[100:103], v[76:79], v[20:23], v[100:103]
    s_waitcnt lgkmcnt(6)
    v_mfma_f32_16x16x32_bf16 v[96:99], v[80:83], v[24:27], v[96:99]
    s_waitcnt lgkmcnt(4)
    v_mfma_f32_16x16x32_bf16 v[100:103], v[84:87], v[24:27], v[100:103]
    s_waitcnt lgkmcnt(2)
    v_mfma_f32_16x16x32_bf16 v[96:99], v[88:91], v[28:31], v[96:99]
    s_waitcnt lgkmcnt(0)
    v_mfma_f32_16x16x32_bf16 v[100:103], v[92:95], v[28:31], v[100:103]
    s_waitcnt vmcnt(4)
    s_barrier
    s_add_u32 s46, s64, 36864
    buffer_load_dwordx4 v[16:19], v15, s[32:35], s46 offen offset:0
    buffer_load_dwordx4 v[20:23], v15, s[32:35], s46 offen offset:1024
    buffer_load_dwordx4 v[24:27], v15, s[32:35], s46 offen offset:2048
    buffer_load_dwordx4 v[28:31], v15, s[32:35], s46 offen offset:3072
    ds_read_b64_tr_b16 v[64:65], v106 offset:49152
    ds_read_b64_tr_b16 v[66:67], v106 offset:51200
    ds_read_b64_tr_b16 v[68:69], v107 offset:49152
    ds_read_b64_tr_b16 v[70:71], v107 offset:51200
    ds_read_b64_tr_b16 v[72:73], v106 offset:53248
    ds_read_b64_tr_b16 v[74:75], v106 offset:55296
    ds_read_b64_tr_b16 v[76:77], v107 offset:53248
    ds_read_b64_tr_b16 v[78:79], v107 offset:55296
    ds_read_b64_tr_b16 v[80:81], v106 offset:57344
    ds_read_b64_tr_b16 v[82:83], v106 offset:59392
    ds_read_b64_tr_b16 v[84:85], v107 offset:57344
    ds_read_b64_tr_b16 v[86:87], v107 offset:59392
    s_waitcnt lgkmcnt(10)
    v_mfma_f32_16x16x32_bf16 v[96:99], v[64:67], v[32:35], v[96:99]
    ds_read_b64_tr_b16 v[88:89], v106 offset:61440
    ds_read_b64_tr_b16 v[90:91], v106 offset:63488
    s_waitcnt lgkmcnt(10)
    v_mfma_f32_16x16x32_bf16 v[100:103], v[68:71], v[32:35], v[100:103]
    ds_read_b64_tr_b16 v[92:93], v107 offset:61440
    ds_read_b64_tr_b16 v[94:95], v107 offset:63488
    s_waitcnt lgkmcnt(10)
    v_mfma_f32_16x16x32_bf16 v[96:99], v[72:75], v[36:39], v[96:99]
    s_waitcnt lgkmcnt(8)
    v_mfma_f32_16x16x32_bf16 v[100:103], v[76:79], v[36:39], v[100:103]
    s_waitcnt lgkmcnt(6)
    v_mfma_f32_16x16x32_bf16 v[96:99], v[80:83], v[40:43], v[96:99]
    s_waitcnt lgkmcnt(4)
    v_mfma_f32_16x16x32_bf16 v[100:103], v[84:87], v[40:43], v[100:103]
    s_waitcnt lgkmcnt(2)
    v_mfma_f32_16x16x32_bf16 v[96:99], v[88:91], v[44:47], v[96:99]
    s_waitcnt lgkmcnt(0)
    v_mfma_f32_16x16x32_bf16 v[100:103], v[92:95], v[44:47], v[100:103]
    s_waitcnt vmcnt(4)
    s_barrier
    s_add_u32 s46, s64, 40960
    buffer_load_dwordx4 v[32:35], v15, s[32:35], s46 offen offset:0
    buffer_load_dwordx4 v[36:39], v15, s[32:35], s46 offen offset:1024
    buffer_load_dwordx4 v[40:43], v15, s[32:35], s46 offen offset:2048
    buffer_load_dwordx4 v[44:47], v15, s[32:35], s46 offen offset:3072
    ds_read_b64_tr_b16 v[64:65], v104 offset:0
    ds_read_b64_tr_b16 v[66:67], v104 offset:2048
    ds_read_b64_tr_b16 v[68:69], v105 offset:0
    ds_read_b64_tr_b16 v[70:71], v105 offset:2048
    ds_read_b64_tr_b16 v[72:73], v104 offset:4096
    ds_read_b64_tr_b16 v[74:75], v104 offset:6144
    ds_read_b64_tr_b16 v[76:77], v105 offset:4096
    ds_read_b64_tr_b16 v[78:79], v105 offset:6144
    ds_read_b64_tr_b16 v[80:81], v104 offset:8192
    ds_read_b64_tr_b16 v[82:83], v104 offset:10240
    ds_read_b64_tr_b16 v[84:85], v105 offset:8192
    ds_read_b64_tr_b16 v[86:87], v105 offset:10240
    s_waitcnt lgkmcnt(10)
    v_mfma_f32_16x16x32_bf16 v[96:99], v[64:67], v[48:51], v[96:99]
    ds_read_b64_tr_b16 v[88:89], v104 offset:12288
    ds_read_b64_tr_b16 v[90:91], v104 offset:14336
    s_waitcnt lgkmcnt(10)
    v_mfma_f32_16x16x32_bf16 v[100:103], v[68:71], v[48:51], v[100:103]
    ds_read_b64_tr_b16 v[92:93], v105 offset:12288
    ds_read_b64_tr_b16 v[94:95], v105 offset:14336
    s_waitcnt lgkmcnt(10)
    v_mfma_f32_16x16x32_bf16 v[96:99], v[72:75], v[52:55], v[96:99]
    s_waitcnt lgkmcnt(8)
    v_mfma_f32_16x16x32_bf16 v[100:103], v[76:79], v[52:55], v[100:103]
    s_waitcnt lgkmcnt(6)
    v_mfma_f32_16x16x32_bf16 v[96:99], v[80:83], v[56:59], v[96:99]
    s_waitcnt lgkmcnt(4)
    v_mfma_f32_16x16x32_bf16 v[100:103], v[84:87], v[56:59], v[100:103]
    s_waitcnt lgkmcnt(2)
    v_mfma_f32_16x16x32_bf16 v[96:99], v[88:91], v[60:63], v[96:99]
    s_waitcnt lgkmcnt(0)
    v_mfma_f32_16x16x32_bf16 v[100:103], v[92:95], v[60:63], v[100:103]
    s_waitcnt vmcnt(4)
    s_barrier
    s_add_u32 s46, s64, 45056
    buffer_load_dwordx4 v[48:51], v15, s[32:35], s46 offen offset:0
    buffer_load_dwordx4 v[52:55], v15, s[32:35], s46 offen offset:1024
    buffer_load_dwordx4 v[56:59], v15, s[32:35], s46 offen offset:2048
    buffer_load_dwordx4 v[60:63], v15, s[32:35], s46 offen offset:3072
    ds_read_b64_tr_b16 v[64:65], v104 offset:16384
    ds_read_b64_tr_b16 v[66:67], v104 offset:18432
    ds_read_b64_tr_b16 v[68:69], v105 offset:16384
    ds_read_b64_tr_b16 v[70:71], v105 offset:18432
    ds_read_b64_tr_b16 v[72:73], v104 offset:20480
    ds_read_b64_tr_b16 v[74:75], v104 offset:22528
    ds_read_b64_tr_b16 v[76:77], v105 offset:20480
    ds_read_b64_tr_b16 v[78:79], v105 offset:22528
    ds_read_b64_tr_b16 v[80:81], v104 offset:24576
    ds_read_b64_tr_b16 v[82:83], v104 offset:26624
    ds_read_b64_tr_b16 v[84:85], v105 offset:24576
    ds_read_b64_tr_b16 v[86:87], v105 offset:26624
    s_waitcnt lgkmcnt(10)
    v_mfma_f32_16x16x32_bf16 v[96:99], v[64:67], v[16:19], v[96:99]
    ds_read_b64_tr_b16 v[88:89], v104 offset:28672
    ds_read_b64_tr_b16 v[90:91], v104 offset:30720
    s_waitcnt lgkmcnt(10)
    v_mfma_f32_16x16x32_bf16 v[100:103], v[68:71], v[16:19], v[100:103]
    ds_read_b64_tr_b16 v[92:93], v105 offset:28672
    ds_read_b64_tr_b16 v[94:95], v105 offset:30720
    s_waitcnt lgkmcnt(10)
    v_mfma_f32_16x16x32_bf16 v[96:99], v[72:75], v[20:23], v[96:99]
    s_waitcnt lgkmcnt(8)
    v_mfma_f32_16x16x32_bf16 v[100:103], v[76:79], v[20:23], v[100:103]
    s_waitcnt lgkmcnt(6)
    v_mfma_f32_16x16x32_bf16 v[96:99], v[80:83], v[24:27], v[96:99]
    s_waitcnt lgkmcnt(4)
    v_mfma_f32_16x16x32_bf16 v[100:103], v[84:87], v[24:27], v[100:103]
    s_waitcnt lgkmcnt(2)
    v_mfma_f32_16x16x32_bf16 v[96:99], v[88:91], v[28:31], v[96:99]
    s_waitcnt lgkmcnt(0)
    v_mfma_f32_16x16x32_bf16 v[100:103], v[92:95], v[28:31], v[100:103]
    s_waitcnt vmcnt(4)
    s_barrier
    ds_read_b64_tr_b16 v[64:65], v104 offset:32768
    ds_read_b64_tr_b16 v[66:67], v104 offset:34816
    ds_read_b64_tr_b16 v[68:69], v105 offset:32768
    ds_read_b64_tr_b16 v[70:71], v105 offset:34816
    ds_read_b64_tr_b16 v[72:73], v104 offset:36864
    ds_read_b64_tr_b16 v[74:75], v104 offset:38912
    ds_read_b64_tr_b16 v[76:77], v105 offset:36864
    ds_read_b64_tr_b16 v[78:79], v105 offset:38912
    ds_read_b64_tr_b16 v[80:81], v104 offset:40960
    ds_read_b64_tr_b16 v[82:83], v104 offset:43008
    ds_read_b64_tr_b16 v[84:85], v105 offset:40960
    ds_read_b64_tr_b16 v[86:87], v105 offset:43008
    s_waitcnt lgkmcnt(10)
    v_mfma_f32_16x16x32_bf16 v[96:99], v[64:67], v[32:35], v[96:99]
    ds_read_b64_tr_b16 v[88:89], v104 offset:45056
    ds_read_b64_tr_b16 v[90:91], v104 offset:47104
    s_waitcnt lgkmcnt(10)
    v_mfma_f32_16x16x32_bf16 v[100:103], v[68:71], v[32:35], v[100:103]
    ds_read_b64_tr_b16 v[92:93], v105 offset:45056
    ds_read_b64_tr_b16 v[94:95], v105 offset:47104
    s_waitcnt lgkmcnt(10)
    v_mfma_f32_16x16x32_bf16 v[96:99], v[72:75], v[36:39], v[96:99]
    s_waitcnt lgkmcnt(8)
    v_mfma_f32_16x16x32_bf16 v[100:103], v[76:79], v[36:39], v[100:103]
    s_waitcnt lgkmcnt(6)
    v_mfma_f32_16x16x32_bf16 v[96:99], v[80:83], v[40:43], v[96:99]
    s_waitcnt lgkmcnt(4)
    v_mfma_f32_16x16x32_bf16 v[100:103], v[84:87], v[40:43], v[100:103]
    s_waitcnt lgkmcnt(2)
    v_mfma_f32_16x16x32_bf16 v[96:99], v[88:91], v[44:47], v[96:99]
    s_waitcnt lgkmcnt(0)
    v_mfma_f32_16x16x32_bf16 v[100:103], v[92:95], v[44:47], v[100:103]
    s_waitcnt vmcnt(0)
    s_barrier
    ds_read_b64_tr_b16 v[64:65], v104 offset:49152
    ds_read_b64_tr_b16 v[66:67], v104 offset:51200
    ds_read_b64_tr_b16 v[68:69], v105 offset:49152
    ds_read_b64_tr_b16 v[70:71], v105 offset:51200
    ds_read_b64_tr_b16 v[72:73], v104 offset:53248
    ds_read_b64_tr_b16 v[74:75], v104 offset:55296
    ds_read_b64_tr_b16 v[76:77], v105 offset:53248
    ds_read_b64_tr_b16 v[78:79], v105 offset:55296
    ds_read_b64_tr_b16 v[80:81], v104 offset:57344
    ds_read_b64_tr_b16 v[82:83], v104 offset:59392
    ds_read_b64_tr_b16 v[84:85], v105 offset:57344
    ds_read_b64_tr_b16 v[86:87], v105 offset:59392
    s_waitcnt lgkmcnt(10)
    v_mfma_f32_16x16x32_bf16 v[96:99], v[64:67], v[48:51], v[96:99]
    ds_read_b64_tr_b16 v[88:89], v104 offset:61440
    ds_read_b64_tr_b16 v[90:91], v104 offset:63488
    s_waitcnt lgkmcnt(10)
    v_mfma_f32_16x16x32_bf16 v[100:103], v[68:71], v[48:51], v[100:103]
    ds_read_b64_tr_b16 v[92:93], v105 offset:61440
    ds_read_b64_tr_b16 v[94:95], v105 offset:63488
    s_waitcnt lgkmcnt(10)
    v_mfma_f32_16x16x32_bf16 v[96:99], v[72:75], v[52:55], v[96:99]
    s_waitcnt lgkmcnt(8)
    v_mfma_f32_16x16x32_bf16 v[100:103], v[76:79], v[52:55], v[100:103]
    s_waitcnt lgkmcnt(6)
    v_mfma_f32_16x16x32_bf16 v[96:99], v[80:83], v[56:59], v[96:99]
    s_waitcnt lgkmcnt(4)
    v_mfma_f32_16x16x32_bf16 v[100:103], v[84:87], v[56:59], v[100:103]
    s_waitcnt lgkmcnt(2)
    v_mfma_f32_16x16x32_bf16 v[96:99], v[88:91], v[60:63], v[96:99]
    s_waitcnt lgkmcnt(0)
    v_mfma_f32_16x16x32_bf16 v[100:103], v[92:95], v[60:63], v[100:103]
    s_nop 7
    s_nop 1
    s_lshl_b32 s42, s66, 4
    v_add_u32 v4, s42, v2
    v_mul_u32_u24 v4, 1280, v4
    v_lshl_add_u32 v4, v3, 3, v4
    s_lshl_b32 s42, s67, 1
    v_add_u32 v4, s42, v4
    v_cvt_pk_bf16_f32 v96, v96, v96
    v_lshlrev_b32 v96, 16, v96
    v_mul_f32 v96, v96, v200
    v_cvt_pk_bf16_f32 v96, v96, v96
    v_lshlrev_b32 v96, 16, v96
    v_cvt_pk_bf16_f32 v97, v97, v97
    v_lshlrev_b32 v97, 16, v97
    v_mul_f32 v97, v97, v201
    v_cvt_pk_bf16_f32 v97, v97, v97
    v_lshlrev_b32 v97, 16, v97
    v_cvt_pk_bf16_f32 v98, v98, v98
    v_lshlrev_b32 v98, 16, v98
    v_mul_f32 v98, v98, v202
    v_cvt_pk_bf16_f32 v98, v98, v98
    v_lshlrev_b32 v98, 16, v98
    v_cvt_pk_bf16_f32 v99, v99, v99
    v_lshlrev_b32 v99, 16, v99
    v_mul_f32 v99, v99, v203
    v_cvt_pk_bf16_f32 v99, v99, v99
    v_lshlrev_b32 v99, 16, v99
    v_lshlrev_b32 v16, 16, v208
    v_and_b32 v17, 0xffff0000, v208
    v_lshlrev_b32 v18, 16, v209
    v_and_b32 v19, 0xffff0000, v209
    v_add_f32 v96, v96, v16
    v_add_f32 v97, v97, v17
    v_add_f32 v98, v98, v18
    v_add_f32 v99, v99, v19
    v_cvt_pk_bf16_f32 v208, v96, v97
    v_cvt_pk_bf16_f32 v209, v98, v99
    buffer_store_dwordx2 v[208:209], v4, s[12:15], 0 offen offset:0
    v_cvt_pk_bf16_f32 v100, v100, v100
    v_lshlrev_b32 v100, 16, v100
    v_mul_f32 v100, v100, v204
    v_cvt_pk_bf16_f32 v100, v100, v100
    v_lshlrev_b32 v100, 16, v100
    v_cvt_pk_bf16_f32 v101, v101, v101
    v_lshlrev_b32 v101, 16, v101
    v_mul_f32 v101, v101, v205
    v_cvt_pk_bf16_f32 v101, v101, v101
    v_lshlrev_b32 v101, 16, v101
    v_cvt_pk_bf16_f32 v102, v102, v102
    v_lshlrev_b32 v102, 16, v102
    v_mul_f32 v102, v102, v206
    v_cvt_pk_bf16_f32 v102, v102, v102
    v_lshlrev_b32 v102, 16, v102
    v_cvt_pk_bf16_f32 v103, v103, v103
    v_lshlrev_b32 v103, 16, v103
    v_mul_f32 v103, v103, v207
    v_cvt_pk_bf16_f32 v103, v103, v103
    v_lshlrev_b32 v103, 16, v103
    v_lshlrev_b32 v16, 16, v210
    v_and_b32 v17, 0xffff0000, v210
    v_lshlrev_b32 v18, 16, v211
    v_and_b32 v19, 0xffff0000, v211
    v_add_f32 v100, v100, v16
    v_add_f32 v101, v101, v17
    v_add_f32 v102, v102, v18
    v_add_f32 v103, v103, v19
    v_cvt_pk_bf16_f32 v210, v100, v101
    v_cvt_pk_bf16_f32 v211, v102, v103
    buffer_store_dwordx2 v[210:211], v4, s[12:15], 0 offen offset:32
    s_branch WDONE
B_SUMP:
    s_load_dwordx2 s[4:5], s[0:1], 0
    s_waitcnt lgkmcnt(0)
    s_mov_b32 s12, s4
    s_mov_b32 s13, s5
    s_mov_b32 s14, 2621440
    s_mov_b32 s15, 0x00020000
    v_lshlrev_b32 v13, 3, v1
    v_lshlrev_b32 v15, 4, v1
    v_mov_b32 v11, 0
    s_mul_i32 s58, s57, 5
    s_add_u32 s58, s58, s40
    s_min_u32 s58, s58, 39
    v_lshlrev_b32 v5, 4, v3
    s_lshl_b32 s42, s58, 6
    s_add_u32 s43, s42, 5120
    buffer_load_dwordx4 v[16:19], v5, s[32:35], s43 offen
    s_add_u32 s43, s42, 10240
    buffer_load_dwordx4 v[20:23], v5, s[32:35], s43 offen
    v_lshlrev_b32 v5, 2, v3
    v_sub_u32 v5, v2, v5
    v_mov_b32 v24, 0
    v_mov_b32 v6, 0x3f80
    v_cmp_eq_u32 vcc, 0, v5
    v_cndmask_b32 v24, v24, v6, vcc
    v_mov_b32 v6, 0x3f800000
    v_cmp_eq_u32 vcc, 1, v5
    v_cndmask_b32 v24, v24, v6, vcc
    v_mov_b32 v25, 0
    v_mov_b32 v6, 0x3f80
    v_cmp_eq_u32 vcc, 2, v5
    v_cndmask_b32 v25, v25, v6, vcc
    v_mov_b32 v6, 0x3f800000
    v_cmp_eq_u32 vcc, 3, v5
    v_cndmask_b32 v25, v25, v6, vcc
    v_mov_b32 v26, v24
    v_mov_b32 v27, v25
    v_mul_u32_u24 v4, 1280, v2
    v_lshl_add_u32 v4, v3, 3, v4
    v_and_b32 v8, 15, v1
    v_lshlrev_b32 v8, 10, v8
    s_lshl_b32 s59, s57, 7
    s_add_u32 s59, s59, 136192
    s_lshl_b32 s61, s56, 3
    s_add_u32 s61, s61, s57
    s_lshl_b32 s61, s61, 7
    s_add_u32 s61, s61, 152576
    s_lshr_b32 s62, s58, 1
    s_lshl_b32 s62, s62, 10
    s_and_b32 s42, s58, 1
    s_lshl_b32 s42, s42, 3
    s_add_u32 s62, s62, s42
    v_lshlrev_b32 v10, 3, v2
    s_lshl_b32 s65, s58, 7
    s_add_u32 s65, s65, 11534336
    v_mov_b32 v112, -1
    v_mov_b32 v113, -1
    s_cmp_ge_u32 s40, 5
    s_cbranch_scc1 SP_NI
    s_add_u32 s63, s56, 120
    s_mul_i32 s44, s63, 20480
    s_add_u32 s44, s44, s62
    s_add_u32 s45, s44, 4194304
    s_add_u32 s44, s44, 7340032
    s_mul_i32 s46, s63, 5120
    s_add_u32 s46, s46, s65
    buffer_store_dwordx2 v[112:113], v15, s[32:35], s44 offen sc1
    buffer_store_dwordx2 v[112:113], v15, s[32:35], s45 offen sc1
    buffer_store_dwordx2 v[112:113], v10, s[32:35], s46 offen sc1
    s_add_u32 s63, s56, 122
    s_mul_i32 s44, s63, 20480
    s_add_u32 s44, s44, s62
    s_add_u32 s45, s44, 4194304
    s_add_u32 s44, s44, 7340032
    s_mul_i32 s46, s63, 5120
    s_add_u32 s46, s46, s65
    buffer_store_dwordx2 v[112:113], v15, s[32:35], s44 offen sc1
    buffer_store_dwordx2 v[112:113], v15, s[32:35], s45 offen sc1
    buffer_store_dwordx2 v[112:113], v10, s[32:35], s46 offen sc1
    s_add_u32 s63, s56, 124
    s_mul_i32 s44, s63, 20480
    s_add_u32 s44, s44, s62
    s_add_u32 s45, s44, 4194304
    s_add_u32 s44, s44, 7340032
    s_mul_i32 s46, s63, 5120
    s_add_u32 s46, s46, s65
    buffer_store_dwordx2 v[112:113], v15, s[32:35], s44 offen sc1
    buffer_store_dwordx2 v[112:113], v15, s[32:35], s45 offen sc1
    buffer_store_dwordx2 v[112:113], v10, s[32:35], s46 offen sc1
    s_add_u32 s63, s56, 126
    s_mul_i32 s44, s63, 20480
    s_add_u32 s44, s44, s62
    s_add_u32 s45, s44, 4194304
    s_add_u32 s44, s44, 7340032
    s_mul_i32 s46, s63, 5120
    s_add_u32 s46, s46, s65
    buffer_store_dwordx2 v[112:113], v15, s[32:35], s44 offen sc1
    buffer_store_dwordx2 v[112:113], v15, s[32:35], s45 offen sc1
    buffer_store_dwordx2 v[112:113], v10, s[32:35], s46 offen sc1
SP_NI:
    s_waitcnt vmcnt(0)
    v_add_f32 v20, 1.0, v20
    v_cvt_pk_bf16_f32 v20, v20, v20
    v_lshlrev_b32 v20, 16, v20
    v_add_f32 v21, 1.0, v21
    v_cvt_pk_bf16_f32 v21, v21, v21
    v_lshlrev_b32 v21, 16, v21
    v_add_f32 v22, 1.0, v22
    v_cvt_pk_bf16_f32 v22, v22, v22
    v_lshlrev_b32 v22, 16, v22
    v_add_f32 v23, 1.0, v23
    v_cvt_pk_bf16_f32 v23, v23, v23
    v_lshlrev_b32 v23, 16, v23
    s_mov_b32 s60, 44
    s_mov_b32 s70, 0
SPF_LOOP:
    s_lshl_b32 s63, s60, 1
    s_add_u32 s63, s63, s56
    s_add_u32 s64, s60, 1
    s_cmp_eq_u32 s40, 5
    s_cbranch_scc1 SPF_POLL
    s_cmp_ge_u32 s40, 5
    s_cbranch_scc1 SPF_B1
    s_mul_i32 s42, s63, 20480
    s_lshl_b32 s43, s58, 5
    s_add_u32 s42, s42, s43
    buffer_load_dwordx2 v[28:29], v4, s[12:15], s42 offen
    s_branch SPF_B1
SPF_POLL:
    s_cmp_ge_u32 s70, s64
    s_cbranch_scc1 SPFW_P4
SPFW_P2:
    buffer_load_dword v6, v8, s[32:35], s59 offen sc1
    s_waitcnt vmcnt(0)
    v_cmp_gt_u32 vcc, s64, v6
    s_cmp_eq_u64 vcc, 0
    s_cbranch_scc1 SPFW_P3
    s_add_u32 s98, s98, 1
    s_cmp_ge_u32 s98, 0x40000
    s_cbranch_scc1 SPFW_P3
    s_sleep 4
    s_branch SPFW_P2
SPFW_P3:
    s_nop 1
    v_min_u32_dpp v6, v6, v6 row_ror:8 row_mask:0xf bank_mask:0xf
    s_nop 1
    v_min_u32_dpp v6, v6, v6 row_ror:4 row_mask:0xf bank_mask:0xf
    s_nop 1
    v_min_u32_dpp v6, v6, v6 row_ror:2 row_mask:0xf bank_mask:0xf
    s_nop 1
    v_min_u32_dpp v6, v6, v6 row_ror:1 row_mask:0xf bank_mask:0xf
    s_nop 1
    v_readlane_b32 s71, v6, 0
    v_readlane_b32 s72, v6, 16
    v_readlane_b32 s73, v6, 32
    v_readlane_b32 s74, v6, 48
    s_min_u32 s71, s71, s72
    s_min_u32 s73, s73, s74
    s_min_u32 s70, s71, s73
SPFW_P4:
SPF_B1:
    s_barrier
    s_cmp_ge_u32 s40, 5
    s_cbranch_scc1 SPF_B2
    s_mul_i32 s47, s63, 20480
    s_lshl_b32 s43, s58, 9
    s_add_u32 s47, s47, s43
    s_add_u32 s47, s47, 135266304
    s_mul_i32 s44, s63, 20480
    s_add_u32 s44, s44, s62
    s_add_u32 s45, s44, 4194304
    s_add_u32 s44, s44, 7340032
    s_mul_i32 s46, s63, 5120
    s_add_u32 s46, s46, s65
    s_mov_b32 s42, s47
    buffer_load_dwordx2 v[32:33], v13, s[32:35], s42 offen
    s_add_u32 s42, s42, 2621440
    buffer_load_dwordx2 v[34:35], v13, s[32:35], s42 offen
    s_add_u32 s42, s42, 2621440
    buffer_load_dwordx2 v[36:37], v13, s[32:35], s42 offen
    s_add_u32 s42, s42, 2621440
    buffer_load_dwordx2 v[38:39], v13, s[32:35], s42 offen
    s_add_u32 s42, s42, 2621440
    buffer_load_dwordx2 v[40:41], v13, s[32:35], s42 offen
    s_add_u32 s42, s42, 2621440
    buffer_load_dwordx2 v[42:43], v13, s[32:35], s42 offen
    s_add_u32 s42, s42, 2621440
    buffer_load_dwordx2 v[44:45], v13, s[32:35], s42 offen
    s_add_u32 s42, s42, 2621440
    buffer_load_dwordx2 v[46:47], v13, s[32:35], s42 offen
    s_add_u32 s42, s42, 2621440
    buffer_load_dwordx2 v[48:49], v13, s[32:35], s42 offen
    s_add_u32 s42, s42, 2621440
    buffer_load_dwordx2 v[50:51], v13, s[32:35], s42 offen
    s_add_u32 s42, s42, 2621440
    buffer_load_dwordx2 v[52:53], v13, s[32:35], s42 offen
    s_add_u32 s42, s42, 2621440
    buffer_load_dwordx2 v[54:55], v13, s[32:35], s42 offen
    s_add_u32 s42, s42, 2621440
    buffer_load_dwordx2 v[56:57], v13, s[32:35], s42 offen
    s_add_u32 s42, s42, 2621440
    buffer_load_dwordx2 v[58:59], v13, s[32:35], s42 offen
    s_add_u32 s42, s42, 2621440
    buffer_load_dwordx2 v[60:61], v13, s[32:35], s42 offen
    s_add_u32 s42, s42, 2621440
    buffer_load_dwordx2 v[62:63], v13, s[32:35], s42 offen
    s_waitcnt vmcnt(14)
    v_mfma_f32_16x16x32_bf16 v[96:99], v[24:27], v[32:35], 0
    s_waitcnt vmcnt(12)
    v_mfma_f32_16x16x32_bf16 v[96:99], v[24:27], v[36:39], v[96:99]
    s_waitcnt vmcnt(10)
    v_mfma_f32_16x16x32_bf16 v[96:99], v[24:27], v[40:43], v[96:99]
    s_waitcnt vmcnt(8)
    v_mfma_f32_16x16x32_bf16 v[96:99], v[24:27], v[44:47], v[96:99]
    s_waitcnt vmcnt(6)
    v_mfma_f32_16x16x32_bf16 v[96:99], v[24:27], v[48:51], v[96:99]
    s_waitcnt vmcnt(4)
    v_mfma_f32_16x16x32_bf16 v[96:99], v[24:27], v[52:55], v[96:99]
    s_waitcnt vmcnt(2)
    v_mfma_f32_16x16x32_bf16 v[96:99], v[24:27], v[56:59], v[96:99]
    s_waitcnt vmcnt(0)
    v_mfma_f32_16x16x32_bf16 v[96:99], v[24:27], v[60:63], v[96:99]
    v_lshlrev_b32 v100, 16, v28
    v_and_b32 v101, 0xffff0000, v28
    v_lshlrev_b32 v102, 16, v29
    v_and_b32 v103, 0xffff0000, v29
    s_nop 7
    v_cvt_pk_bf16_f32 v96, v96, v96
    v_lshlrev_b32 v96, 16, v96
    v_mul_f32 v96, v96, v16
    v_cvt_pk_bf16_f32 v96, v96, v96
    v_lshlrev_b32 v96, 16, v96
    v_add_f32 v96, v96, v100
    v_cvt_pk_bf16_f32 v97, v97, v97
    v_lshlrev_b32 v97, 16, v97
    v_mul_f32 v97, v97, v17
    v_cvt_pk_bf16_f32 v97, v97, v97
    v_lshlrev_b32 v97, 16, v97
    v_add_f32 v97, v97, v101
    v_cvt_pk_bf16_f32 v98, v98, v98
    v_lshlrev_b32 v98, 16, v98
    v_mul_f32 v98, v98, v18
    v_cvt_pk_bf16_f32 v98, v98, v98
    v_lshlrev_b32 v98, 16, v98
    v_add_f32 v98, v98, v102
    v_cvt_pk_bf16_f32 v99, v99, v99
    v_lshlrev_b32 v99, 16, v99
    v_mul_f32 v99, v99, v19
    v_cvt_pk_bf16_f32 v99, v99, v99
    v_lshlrev_b32 v99, 16, v99
    v_add_f32 v99, v99, v103
    v_cvt_pk_bf16_f32 v104, v96, v97
    v_cvt_pk_bf16_f32 v105, v98, v99
    v_lshlrev_b32 v96, 16, v104
    v_and_b32 v97, 0xffff0000, v104
    v_lshlrev_b32 v98, 16, v105
    v_and_b32 v99, 0xffff0000, v105
    v_mul_f32 v100, v96, v20
    v_mul_f32 v101, v97, v21
    v_mul_f32 v102, v98, v22
    v_mul_f32 v103, v99, v23
    v_cvt_pk_bf16_f32 v106, v100, v101
    v_cvt_pk_bf16_f32 v107, v102, v103
    buffer_store_dwordx2 v[106:107], v15, s[32:35], s45 offen sc1
    v_add_f32 v108, v96, v97
    v_add_f32 v100, v98, v99
    v_mul_f32 v109, v96, v96
    v_add_f32 v108, v108, v100
    v_fmac_f32 v109, v97, v97
    v_fmac_f32 v109, v98, v98
    v_fmac_f32 v109, v99, v99
    v_mov_b32 v110, v108
    s_nop 1
    v_permlane32_swap_b32 v108, v110
    s_nop 1
    v_add_f32 v108, v108, v110
    v_mov_b32 v110, v108
    s_nop 1
    v_permlane16_swap_b32 v108, v110
    s_nop 1
    v_add_f32 v108, v108, v110
    v_mov_b32 v110, v109
    s_nop 1
    v_permlane32_swap_b32 v109, v110
    s_nop 1
    v_add_f32 v109, v109, v110
    v_mov_b32 v110, v109
    s_nop 1
    v_permlane16_swap_b32 v109, v110
    s_nop 1
    v_add_f32 v109, v109, v110
    s_mov_b64 exec, 0xffff
    buffer_store_dwordx2 v[108:109], v10, s[32:35], s46 offen sc1
    s_mov_b64 exec, -1
    buffer_store_dwordx2 v[104:105], v15, s[32:35], s44 offen sc1
SPF_B2:
    s_waitcnt vmcnt(0)
    s_barrier
    s_cmp_lg_u32 s40, 0
    s_cbranch_scc1 SPF_NF
    v_mov_b32 v6, s64
    v_mov_b32 v5, 0
    s_mov_b64 exec, 1
    buffer_store_dword v6, v5, s[32:35], s61 offen sc1
    s_mov_b64 exec, -1
SPF_NF:
    s_add_u32 s60, s60, 1
    s_cmp_lt_u32 s60, 60
    s_cbranch_scc1 SPF_LOOP
SPS_LOOP:
    s_lshl_b32 s63, s60, 1
    s_add_u32 s63, s63, s56
    s_add_u32 s64, s60, 1
    s_cmp_ge_u32 s40, 5
    s_cbranch_scc1 SPS_B2
    s_mul_i32 s42, s63, 20480
    s_lshl_b32 s43, s58, 5
    s_add_u32 s42, s42, s43
    buffer_load_dwordx2 v[28:29], v4, s[12:15], s42 offen
    s_mul_i32 s47, s63, 20480
    s_lshl_b32 s43, s58, 9
    s_add_u32 s47, s47, s43
    s_add_u32 s47, s47, 135266304
    s_mul_i32 s44, s63, 20480
    s_add_u32 s44, s44, s62
    s_add_u32 s45, s44, 4194304
    s_add_u32 s44, s44, 7340032
    s_mul_i32 s46, s63, 5120
    s_add_u32 s46, s46, s65
    s_add_u32 s66, s47, 39321600
SPS_S1:
    buffer_load_dword v6, v11, s[32:35], s66 offen sc1
    s_waitcnt vmcnt(0)
    v_readfirstlane_b32 s43, v6
    s_cmp_lg_u32 s43, -1
    s_cbranch_scc1 SPS_S1X
    s_add_u32 s98, s98, 1
    s_cmp_ge_u32 s98, 0x40000
    s_cbranch_scc1 SPS_S1X
    s_sleep 2
    s_branch SPS_S1
SPS_S1X:
SPS_S2:
    s_mov_b32 s42, s47
    buffer_load_dwordx2 v[32:33], v13, s[32:35], s42 offen sc1
    s_add_u32 s42, s42, 2621440
    buffer_load_dwordx2 v[34:35], v13, s[32:35], s42 offen sc1
    s_add_u32 s42, s42, 2621440
    buffer_load_dwordx2 v[36:37], v13, s[32:35], s42 offen sc1
    s_add_u32 s42, s42, 2621440
    buffer_load_dwordx2 v[38:39], v13, s[32:35], s42 offen sc1
    s_add_u32 s42, s42, 2621440
    buffer_load_dwordx2 v[40:41], v13, s[32:35], s42 offen sc1
    s_add_u32 s42, s42, 2621440
    buffer_load_dwordx2 v[42:43], v13, s[32:35], s42 offen sc1
    s_add_u32 s42, s42, 2621440
    buffer_load_dwordx2 v[44:45], v13, s[32:35], s42 offen sc1
    s_add_u32 s42, s42, 2621440
    buffer_load_dwordx2 v[46:47], v13, s[32:35], s42 offen sc1
    s_add_u32 s42, s42, 2621440
    buffer_load_dwordx2 v[48:49], v13, s[32:35], s42 offen sc1
    s_add_u32 s42, s42, 2621440
    buffer_load_dwordx2 v[50:51], v13, s[32:35], s42 offen sc1
    s_add_u32 s42, s42, 2621440
    buffer_load_dwordx2 v[52:53], v13, s[32:35], s42 offen sc1
    s_add_u32 s42, s42, 2621440
    buffer_load_dwordx2 v[54:55], v13, s[32:35], s42 offen sc1
    s_add_u32 s42, s42, 2621440
    buffer_load_dwordx2 v[56:57], v13, s[32:35], s42 offen sc1
    s_add_u32 s42, s42, 2621440
    buffer_load_dwordx2 v[58:59], v13, s[32:35], s42 offen sc1
    s_add_u32 s42, s42, 2621440
    buffer_load_dwordx2 v[60:61], v13, s[32:35], s42 offen sc1
    s_add_u32 s42, s42, 2621440
    buffer_load_dwordx2 v[62:63], v13, s[32:35], s42 offen sc1
    s_waitcnt vmcnt(0)
    v_max_u32 v6, v32, v34
    v_max3_u32 v6, v6, v36, v38
    v_max3_u32 v6, v6, v40, v42
    v_max3_u32 v6, v6, v44, v46
    v_max3_u32 v6, v6, v48, v50
    v_max3_u32 v6, v6, v52, v54
    v_max3_u32 v6, v6, v56, v58
    v_max3_u32 v6, v6, v60, v62
    v_cmp_eq_u32 vcc, -1, v6
    s_add_u32 s98, s98, 1
    s_cmp_lt_u32 s98, 0x40000
    s_cselect_b64 s[90:91], vcc, 0
    s_cmp_lg_u64 s[90:91], 0
    s_cbranch_scc1 SPS_S2
    v_mfma_f32_16x16x32_bf16 v[96:99], v[24:27], v[32:35], 0
    v_mfma_f32_16x16x32_bf16 v[96:99], v[24:27], v[36:39], v[96:99]
    v_mfma_f32_16x16x32_bf16 v[96:99], v[24:27], v[40:43], v[96:99]
    v_mfma_f32_16x16x32_bf16 v[96:99], v[24:27], v[44:47], v[96:99]
    v_mfma_f32_16x16x32_bf16 v[96:99], v[24:27], v[48:51], v[96:99]
    v_mfma_f32_16x16x32_bf16 v[96:99], v[24:27], v[52:55], v[96:99]
    v_mfma_f32_16x16x32_bf16 v[96:99], v[24:27], v[56:59], v[96:99]
    v_mfma_f32_16x16x32_bf16 v[96:99], v[24:27], v[60:63], v[96:99]
    v_lshlrev_b32 v100, 16, v28
    v_and_b32 v101, 0xffff0000, v28
    v_lshlrev_b32 v102, 16, v29
    v_and_b32 v103, 0xffff0000, v29
    s_nop 7
    v_cvt_pk_bf16_f32 v96, v96, v96
    v_lshlrev_b32 v96, 16, v96
    v_mul_f32 v96, v96, v16
    v_cvt_pk_bf16_f32 v96, v96, v96
    v_lshlrev_b32 v96, 16, v96
    v_add_f32 v96, v96, v100
    v_cvt_pk_bf16_f32 v97, v97, v97
    v_lshlrev_b32 v97, 16, v97
    v_mul_f32 v97, v97, v17
    v_cvt_pk_bf16_f32 v97, v97, v97
    v_lshlrev_b32 v97, 16, v97
    v_add_f32 v97, v97, v101
    v_cvt_pk_bf16_f32 v98, v98, v98
    v_lshlrev_b32 v98, 16, v98
    v_mul_f32 v98, v98, v18
    v_cvt_pk_bf16_f32 v98, v98, v98
    v_lshlrev_b32 v98, 16, v98
    v_add_f32 v98, v98, v102
    v_cvt_pk_bf16_f32 v99, v99, v99
    v_lshlrev_b32 v99, 16, v99
    v_mul_f32 v99, v99, v19
    v_cvt_pk_bf16_f32 v99, v99, v99
    v_lshlrev_b32 v99, 16, v99
    v_add_f32 v99, v99, v103
    v_cvt_pk_bf16_f32 v104, v96, v97
    v_cvt_pk_bf16_f32 v105, v98, v99
    v_lshlrev_b32 v96, 16, v104
    v_and_b32 v97, 0xffff0000, v104
    v_lshlrev_b32 v98, 16, v105
    v_and_b32 v99, 0xffff0000, v105
    v_mul_f32 v100, v96, v20
    v_mul_f32 v101, v97, v21
    v_mul_f32 v102, v98, v22
    v_mul_f32 v103, v99, v23
    v_cvt_pk_bf16_f32 v106, v100, v101
    v_cvt_pk_bf16_f32 v107, v102, v103
    buffer_store_dwordx2 v[106:107], v15, s[32:35], s45 offen sc1
    v_add_f32 v108, v96, v97
    v_add_f32 v100, v98, v99
    v_mul_f32 v109, v96, v96
    v_add_f32 v108, v108, v100
    v_fmac_f32 v109, v97, v97
    v_fmac_f32 v109, v98, v98
    v_fmac_f32 v109, v99, v99
    v_mov_b32 v110, v108
    s_nop 1
    v_permlane32_swap_b32 v108, v110
    s_nop 1
    v_add_f32 v108, v108, v110
    v_mov_b32 v110, v108
    s_nop 1
    v_permlane16_swap_b32 v108, v110
    s_nop 1
    v_add_f32 v108, v108, v110
    v_mov_b32 v110, v109
    s_nop 1
    v_permlane32_swap_b32 v109, v110
    s_nop 1
    v_add_f32 v109, v109, v110
    v_mov_b32 v110, v109
    s_nop 1
    v_permlane16_swap_b32 v109, v110
    s_nop 1
    v_add_f32 v109, v109, v110
    s_mov_b64 exec, 0xffff
    buffer_store_dwordx2 v[108:109], v10, s[32:35], s46 offen sc1
    s_mov_b64 exec, -1
    buffer_store_dwordx2 v[104:105], v15, s[32:35], s44 offen sc1
SPS_B2:
    s_add_u32 s60, s60, 1
    s_cmp_lt_u32 s60, 64
    s_cbranch_scc1 SPS_LOOP
    s_branch WDONE
B_FAP:
    s_load_dwordx4 s[4:7], s[0:1], 64
    s_waitcnt lgkmcnt(0)
    s_mov_b32 s8, s4
    s_mov_b32 s9, s5
    s_mov_b32 s10, 1966080
    s_mov_b32 s11, 0x00020000
    s_mov_b32 s12, s6
    s_mov_b32 s13, s7
    s_mov_b32 s14, 1966080
    s_mov_b32 s15, 0x00020000
    v_lshlrev_b32 v15, 4, v1
    v_mov_b32 v12, 0
    v_lshrrev_b32 v4, 2, v1
    v_mul_u32_u24 v4, 3072, v4
    v_and_b32 v5, 3, v1
    v_lshl_add_u32 v4, v5, 4, v4
    s_mul_i32 s42, s40, 49152
    s_lshl_b32 s43, s56, 6
    s_add_u32 s42, s42, s43
    s_lshl_b32 s44, s40, 10
    s_add_u32 m0, s44, 0
    s_add_u32 s43, s42, 0
    buffer_load_dwordx4 v4, s[8:11], s43 offen lds
    s_add_u32 m0, s44, 8192
    s_add_u32 s43, s42, 393216
    buffer_load_dwordx4 v4, s[8:11], s43 offen lds
    s_add_u32 m0, s44, 16384
    s_add_u32 s43, s42, 786432
    buffer_load_dwordx4 v4, s[8:11], s43 offen lds
    s_add_u32 m0, s44, 24576
    s_add_u32 s43, s42, 1179648
    buffer_load_dwordx4 v4, s[8:11], s43 offen lds
    s_add_u32 m0, s44, 32768
    s_add_u32 s43, s42, 1572864
    buffer_load_dwordx4 v4, s[8:11], s43 offen lds
    s_add_u32 m0, s44, 40960
    s_add_u32 s43, s42, 0
    buffer_load_dwordx4 v4, s[12:15], s43 offen lds
    s_add_u32 m0, s44, 49152
    s_add_u32 s43, s42, 393216
    buffer_load_dwordx4 v4, s[12:15], s43 offen lds
    s_add_u32 m0, s44, 57344
    s_add_u32 s43, s42, 786432
    buffer_load_dwordx4 v4, s[12:15], s43 offen lds
    s_add_u32 m0, s44, 65536
    s_add_u32 s43, s42, 1179648
    buffer_load_dwordx4 v4, s[12:15], s43 offen lds
    s_add_u32 m0, s44, 73728
    s_add_u32 s43, s42, 1572864
    buffer_load_dwordx4 v4, s[12:15], s43 offen lds
    v_cmp_eq_u32 vcc, 0, v2
    v_mov_b32 v5, 7680
    v_mov_b32 v6, 10240
    v_cndmask_b32 v5, v5, v6, vcc
    v_lshl_add_u32 v5, v3, 4, v5
    s_mul_i32 s42, s41, 640
    s_add_u32 s42, s42, 0
    buffer_load_dwordx4 v[160:163], v5, s[32:35], s42 offen offset:0
    buffer_load_dwordx4 v[164:167], v5, s[32:35], s42 offen offset:64
    buffer_load_dwordx4 v[168:171], v5, s[32:35], s42 offen offset:128
    buffer_load_dwordx4 v[172:175], v5, s[32:35], s42 offen offset:192
    buffer_load_dwordx4 v[176:179], v5, s[32:35], s42 offen offset:256
    buffer_load_dwordx4 v[180:183], v5, s[32:35], s42 offen offset:320
    buffer_load_dwordx4 v[184:187], v5, s[32:35], s42 offen offset:384
    buffer_load_dwordx4 v[188:191], v5, s[32:35], s42 offen offset:448
    buffer_load_dwordx4 v[192:195], v5, s[32:35], s42 offen offset:512
    buffer_load_dwordx4 v[196:199], v5, s[32:35], s42 offen offset:576
    s_lshl_b32 s62, s56, 10
    s_lshl_b32 s43, s41, 3
    s_add_u32 s62, s62, s43
    s_add_u32 s62, s62, 13631488
    v_mov_b32 v148, -1
    v_mov_b32 v149, -1
    s_cmp_ge_u32 s41, 2
    s_cbranch_scc1 FP_NI
    s_add_u32 s63, s39, 120
    s_mul_i32 s42, s63, 49152
    s_add_u32 s42, s42, s62
    buffer_store_dwordx2 v[148:149], v15, s[32:35], s42 offen sc1
    s_add_u32 s63, s39, 122
    s_mul_i32 s42, s63, 49152
    s_add_u32 s42, s42, s62
    buffer_store_dwordx2 v[148:149], v15, s[32:35], s42 offen sc1
    s_add_u32 s63, s39, 124
    s_mul_i32 s42, s63, 49152
    s_add_u32 s42, s42, s62
    buffer_store_dwordx2 v[148:149], v15, s[32:35], s42 offen sc1
    s_add_u32 s63, s39, 126
    s_mul_i32 s42, s63, 49152
    s_add_u32 s42, s42, s62
    buffer_store_dwordx2 v[148:149], v15, s[32:35], s42 offen sc1
FP_NI:
    s_waitcnt vmcnt(0)
    s_barrier
    v_lshrrev_b32 v6, 2, v2
    v_lshl_add_u32 v6, v3, 2, v6
    v_lshlrev_b32 v6, 6, v6
    v_and_b32 v7, 3, v2
    v_lshl_add_u32 v6, v7, 3, v6
    s_mul_i32 s42, s41, 10240
    v_add_u32 v6, s42, v6
    ds_read_b64_tr_b16 v[16:17], v6 offset:0
    ds_read_b64_tr_b16 v[18:19], v6 offset:1024
    ds_read_b64_tr_b16 v[20:21], v6 offset:32
    ds_read_b64_tr_b16 v[22:23], v6 offset:1056
    ds_read_b64_tr_b16 v[24:25], v6 offset:40960
    ds_read_b64_tr_b16 v[26:27], v6 offset:41984
    ds_read_b64_tr_b16 v[28:29], v6 offset:40992
    ds_read_b64_tr_b16 v[30:31], v6 offset:42016
    s_waitcnt lgkmcnt(0)
    ds_read_b64_tr_b16 v[32:33], v6 offset:2048
    ds_read_b64_tr_b16 v[34:35], v6 offset:3072
    ds_read_b64_tr_b16 v[36:37], v6 offset:2080
    ds_read_b64_tr_b16 v[38:39], v6 offset:3104
    ds_read_b64_tr_b16 v[40:41], v6 offset:43008
    ds_read_b64_tr_b16 v[42:43], v6 offset:44032
    ds_read_b64_tr_b16 v[44:45], v6 offset:43040
    ds_read_b64_tr_b16 v[46:47], v6 offset:44064
    s_waitcnt lgkmcnt(0)
    ds_read_b64_tr_b16 v[48:49], v6 offset:4096
    ds_read_b64_tr_b16 v[50:51], v6 offset:5120
    ds_read_b64_tr_b16 v[52:53], v6 offset:4128
    ds_read_b64_tr_b16 v[54:55], v6 offset:5152
    ds_read_b64_tr_b16 v[56:57], v6 offset:45056
    ds_read_b64_tr_b16 v[58:59], v6 offset:46080
    ds_read_b64_tr_b16 v[60:61], v6 offset:45088
    ds_read_b64_tr_b16 v[62:63], v6 offset:46112
    s_waitcnt lgkmcnt(0)
    ds_read_b64_tr_b16 v[64:65], v6 offset:6144
    ds_read_b64_tr_b16 v[66:67], v6 offset:7168
    ds_read_b64_tr_b16 v[68:69], v6 offset:6176
    ds_read_b64_tr_b16 v[70:71], v6 offset:7200
    ds_read_b64_tr_b16 v[72:73], v6 offset:47104
    ds_read_b64_tr_b16 v[74:75], v6 offset:48128
    ds_read_b64_tr_b16 v[76:77], v6 offset:47136
    ds_read_b64_tr_b16 v[78:79], v6 offset:48160
    s_waitcnt lgkmcnt(0)
    ds_read_b64_tr_b16 v[80:81], v6 offset:8192
    ds_read_b64_tr_b16 v[82:83], v6 offset:9216
    ds_read_b64_tr_b16 v[84:85], v6 offset:8224
    ds_read_b64_tr_b16 v[86:87], v6 offset:9248
    ds_read_b64_tr_b16 v[88:89], v6 offset:49152
    ds_read_b64_tr_b16 v[90:91], v6 offset:50176
    ds_read_b64_tr_b16 v[92:93], v6 offset:49184
    ds_read_b64_tr_b16 v[94:95], v6 offset:50208
    s_waitcnt lgkmcnt(0)
    v_cmp_eq_u32 s[44:45], 0, v2
    v_cmp_gt_u32 vcc, 2, v2
    v_add_f32 v148, 1.0, v160
    v_cndmask_b32 v160, v160, v148, s[44:45]
    v_add_f32 v148, 1.0, v161
    v_cndmask_b32 v161, v161, v148, s[44:45]
    v_add_f32 v148, 1.0, v162
    v_cndmask_b32 v162, v162, v148, s[44:45]
    v_add_f32 v148, 1.0, v163
    v_cndmask_b32 v163, v163, v148, s[44:45]
    v_add_f32 v148, 1.0, v164
    v_cndmask_b32 v164, v164, v148, s[44:45]
    v_add_f32 v148, 1.0, v165
    v_cndmask_b32 v165, v165, v148, s[44:45]
    v_add_f32 v148, 1.0, v166
    v_cndmask_b32 v166, v166, v148, s[44:45]
    v_add_f32 v148, 1.0, v167
    v_cndmask_b32 v167, v167, v148, s[44:45]
    v_cvt_pk_bf16_f32 v96, v160, v161
    v_cndmask_b32 v96, 0, v96, vcc
    v_cvt_pk_bf16_f32 v97, v162, v163
    v_cndmask_b32 v97, 0, v97, vcc
    v_cvt_pk_bf16_f32 v98, v164, v165
    v_cndmask_b32 v98, 0, v98, vcc
    v_cvt_pk_bf16_f32 v99, v166, v167
    v_cndmask_b32 v99, 0, v99, vcc
    v_add_f32 v148, 1.0, v168
    v_cndmask_b32 v168, v168, v148, s[44:45]
    v_add_f32 v148, 1.0, v169
    v_cndmask_b32 v169, v169, v148, s[44:45]
    v_add_f32 v148, 1.0, v170
    v_cndmask_b32 v170, v170, v148, s[44:45]
    v_add_f32 v148, 1.0, v171
    v_cndmask_b32 v171, v171, v148, s[44:45]
    v_add_f32 v148, 1.0, v172
    v_cndmask_b32 v172, v172, v148, s[44:45]
    v_add_f32 v148, 1.0, v173
    v_cndmask_b32 v173, v173, v148, s[44:45]
    v_add_f32 v148, 1.0, v174
    v_cndmask_b32 v174, v174, v148, s[44:45]
    v_add_f32 v148, 1.0, v175
    v_cndmask_b32 v175, v175, v148, s[44:45]
    v_cvt_pk_bf16_f32 v100, v168, v169
    v_cndmask_b32 v100, 0, v100, vcc
    v_cvt_pk_bf16_f32 v101, v170, v171
    v_cndmask_b32 v101, 0, v101, vcc
    v_cvt_pk_bf16_f32 v102, v172, v173
    v_cndmask_b32 v102, 0, v102, vcc
    v_cvt_pk_bf16_f32 v103, v174, v175
    v_cndmask_b32 v103, 0, v103, vcc
    v_add_f32 v148, 1.0, v176
    v_cndmask_b32 v176, v176, v148, s[44:45]
    v_add_f32 v148, 1.0, v177
    v_cndmask_b32 v177, v177, v148, s[44:45]
    v_add_f32 v148, 1.0, v178
    v_cndmask_b32 v178, v178, v148, s[44:45]
    v_add_f32 v148, 1.0, v179
    v_cndmask_b32 v179, v179, v148, s[44:45]
    v_add_f32 v148, 1.0, v180
    v_cndmask_b32 v180, v180, v148, s[44:45]
    v_add_f32 v148, 1.0, v181
    v_cndmask_b32 v181, v181, v148, s[44:45]
    v_add_f32 v148, 1.0, v182
    v_cndmask_b32 v182, v182, v148, s[44:45]
    v_add_f32 v148, 1.0, v183
    v_cndmask_b32 v183, v183, v148, s[44:45]
    v_cvt_pk_bf16_f32 v104, v176, v177
    v_cndmask_b32 v104, 0, v104, vcc
    v_cvt_pk_bf16_f32 v105, v178, v179
    v_cndmask_b32 v105, 0, v105, vcc
    v_cvt_pk_bf16_f32 v106, v180, v181
    v_cndmask_b32 v106, 0, v106, vcc
    v_cvt_pk_bf16_f32 v107, v182, v183
    v_cndmask_b32 v107, 0, v107, vcc
    v_add_f32 v148, 1.0, v184
    v_cndmask_b32 v184, v184, v148, s[44:45]
    v_add_f32 v148, 1.0, v185
    v_cndmask_b32 v185, v185, v148, s[44:45]
    v_add_f32 v148, 1.0, v186
    v_cndmask_b32 v186, v186, v148, s[44:45]
    v_add_f32 v148, 1.0, v187
    v_cndmask_b32 v187, v187, v148, s[44:45]
    v_add_f32 v148, 1.0, v188
    v_cndmask_b32 v188, v188, v148, s[44:45]
    v_add_f32 v148, 1.0, v189
    v_cndmask_b32 v189, v189, v148, s[44:45]
    v_add_f32 v148, 1.0, v190
    v_cndmask_b32 v190, v190, v148, s[44:45]
    v_add_f32 v148, 1.0, v191
    v_cndmask_b32 v191, v191, v148, s[44:45]
    v_cvt_pk_bf16_f32 v108, v184, v185
    v_cndmask_b32 v108, 0, v108, vcc
    v_cvt_pk_bf16_f32 v109, v186, v187
    v_cndmask_b32 v109, 0, v109, vcc
    v_cvt_pk_bf16_f32 v110, v188, v189
    v_cndmask_b32 v110, 0, v110, vcc
    v_cvt_pk_bf16_f32 v111, v190, v191
    v_cndmask_b32 v111, 0, v111, vcc
    v_add_f32 v148, 1.0, v192
    v_cndmask_b32 v192, v192, v148, s[44:45]
    v_add_f32 v148, 1.0, v193
    v_cndmask_b32 v193, v193, v148, s[44:45]
    v_add_f32 v148, 1.0, v194
    v_cndmask_b32 v194, v194, v148, s[44:45]
    v_add_f32 v148, 1.0, v195
    v_cndmask_b32 v195, v195, v148, s[44:45]
    v_add_f32 v148, 1.0, v196
    v_cndmask_b32 v196, v196, v148, s[44:45]
    v_add_f32 v148, 1.0, v197
    v_cndmask_b32 v197, v197, v148, s[44:45]
    v_add_f32 v148, 1.0, v198
    v_cndmask_b32 v198, v198, v148, s[44:45]
    v_add_f32 v148, 1.0, v199
    v_cndmask_b32 v199, v199, v148, s[44:45]
    v_cvt_pk_bf16_f32 v112, v192, v193
    v_cndmask_b32 v112, 0, v112, vcc
    v_cvt_pk_bf16_f32 v113, v194, v195
    v_cndmask_b32 v113, 0, v113, vcc
    v_cvt_pk_bf16_f32 v114, v196, v197
    v_cndmask_b32 v114, 0, v114, vcc
    v_cvt_pk_bf16_f32 v115, v198, v199
    v_cndmask_b32 v115, 0, v115, vcc
    s_lshl_b32 s42, s40, 12
    s_add_u32 s42, s42, 81920
    v_add_u32 v7, s42, v15
    s_lshl_b32 s42, s39, 14
    s_lshl_b32 s43, s41, 10
    s_add_u32 s42, s42, s43
    s_add_u32 s42, s42, 81920
    v_add_u32 v8, s42, v15
    v_mfma_f32_16x16x32_bf16 v[116:119], v[16:19], v[96:99], 0
    v_mfma_f32_16x16x32_bf16 v[120:123], v[20:23], v[96:99], 0
    v_mfma_f32_16x16x32_bf16 v[124:127], v[24:27], v[96:99], 0
    v_mfma_f32_16x16x32_bf16 v[128:131], v[28:31], v[96:99], 0
    v_mfma_f32_16x16x32_bf16 v[116:119], v[32:35], v[100:103], v[116:119]
    v_mfma_f32_16x16x32_bf16 v[120:123], v[36:39], v[100:103], v[120:123]
    v_mfma_f32_16x16x32_bf16 v[124:127], v[40:43], v[100:103], v[124:127]
    v_mfma_f32_16x16x32_bf16 v[128:131], v[44:47], v[100:103], v[128:131]
    v_mfma_f32_16x16x32_bf16 v[116:119], v[48:51], v[104:107], v[116:119]
    v_mfma_f32_16x16x32_bf16 v[120:123], v[52:55], v[104:107], v[120:123]
    v_mfma_f32_16x16x32_bf16 v[124:127], v[56:59], v[104:107], v[124:127]
    v_mfma_f32_16x16x32_bf16 v[128:131], v[60:63], v[104:107], v[128:131]
    v_mfma_f32_16x16x32_bf16 v[116:119], v[64:67], v[108:111], v[116:119]
    v_mfma_f32_16x16x32_bf16 v[120:123], v[68:71], v[108:111], v[120:123]
    v_mfma_f32_16x16x32_bf16 v[124:127], v[72:75], v[108:111], v[124:127]
    v_mfma_f32_16x16x32_bf16 v[128:131], v[76:79], v[108:111], v[128:131]
    v_mfma_f32_16x16x32_bf16 v[116:119], v[80:83], v[112:115], v[116:119]
    v_mfma_f32_16x16x32_bf16 v[120:123], v[84:87], v[112:115], v[120:123]
    v_mfma_f32_16x16x32_bf16 v[124:127], v[88:91], v[112:115], v[124:127]
    v_mfma_f32_16x16x32_bf16 v[128:131], v[92:95], v[112:115], v[128:131]
    s_nop 7
    s_nop 1
    ds_write_b128 v7, v[116:119] offset:0
    ds_write_b128 v7, v[120:123] offset:1024
    ds_write_b128 v7, v[124:127] offset:2048
    ds_write_b128 v7, v[128:131] offset:3072
    s_waitcnt lgkmcnt(0)
    s_barrier
    s_cmp_ge_u32 s41, 2
    s_cbranch_scc1 FP_NU
    ds_read_b128 v[160:163], v8 offset:0
    ds_read_b128 v[164:167], v8 offset:2048
    ds_read_b128 v[168:171], v8 offset:4096
    ds_read_b128 v[172:175], v8 offset:6144
    ds_read_b128 v[176:179], v8 offset:8192
    ds_read_b128 v[180:183], v8 offset:10240
    ds_read_b128 v[184:187], v8 offset:12288
    ds_read_b128 v[188:191], v8 offset:14336
    s_waitcnt lgkmcnt(4)
    v_add_f32 v116, v160, v168
    v_add_f32 v117, v161, v169
    v_add_f32 v118, v162, v170
    v_add_f32 v119, v163, v171
    v_add_f32 v120, v164, v172
    v_add_f32 v121, v165, v173
    v_add_f32 v122, v166, v174
    v_add_f32 v123, v167, v175
    s_waitcnt lgkmcnt(0)
    v_add_f32 v176, v176, v184
    v_add_f32 v177, v177, v185
    v_add_f32 v178, v178, v186
    v_add_f32 v179, v179, v187
    v_add_f32 v180, v180, v188
    v_add_f32 v181, v181, v189
    v_add_f32 v182, v182, v190
    v_add_f32 v183, v183, v191
    v_add_f32 v116, v116, v176
    v_add_f32 v117, v117, v177
    v_add_f32 v118, v118, v178
    v_add_f32 v119, v119, v179
    v_add_f32 v120, v120, v180
    v_add_f32 v121, v121, v181
    v_add_f32 v122, v122, v182
    v_add_f32 v123, v123, v183
    v_and_b32 v5, 48, v1
    v_lshlrev_b32 v5, 2, v5
    v_add_u32 v6, 4, v5
    ds_bpermute_b32 v132, v5, v116
    ds_bpermute_b32 v140, v6, v116
    ds_bpermute_b32 v133, v5, v117
    ds_bpermute_b32 v141, v6, v117
    ds_bpermute_b32 v134, v5, v118
    ds_bpermute_b32 v142, v6, v118
    ds_bpermute_b32 v135, v5, v119
    ds_bpermute_b32 v143, v6, v119
    ds_bpermute_b32 v136, v5, v120
    ds_bpermute_b32 v144, v6, v120
    ds_bpermute_b32 v137, v5, v121
    ds_bpermute_b32 v145, v6, v121
    ds_bpermute_b32 v138, v5, v122
    ds_bpermute_b32 v146, v6, v122
    ds_bpermute_b32 v139, v5, v123
    ds_bpermute_b32 v147, v6, v123
    s_waitcnt lgkmcnt(0)
FP_NU:
    v_and_b32 v9, 15, v1
    v_lshlrev_b32 v9, 7, v9
    s_and_b32 s42, s56, 15
    s_lshl_b32 s42, s42, 7
    v_mov_b32 v10, s42
    s_mov_b32 s59, 152576
    s_lshl_b32 s61, s56, 7
    s_add_u32 s61, s61, 154624
    v_mul_u32_u24 v11, 1280, v3
    v_lshl_add_u32 v11, v2, 3, v11
    s_mov_b32 s24, 0x3acccccd
    s_mov_b32 s25, 0x3727c5ac
    s_mov_b32 s26, 0xc0135761
    s_mov_b32 s27, 0xbdd2d3e8
    s_mov_b32 s60, 44
    s_mov_b32 s70, 0
FPF_LOOP:
    s_lshl_b32 s63, s60, 1
    s_add_u32 s63, s63, s39
    s_add_u32 s64, s60, 1
    s_cmp_lg_u32 s40, 7
    s_cbranch_scc1 FPF_B1
    s_cmp_ge_u32 s70, s64
    s_cbranch_scc1 FPFW_P4
FPFW_P1:
    buffer_load_dword v6, v10, s[32:35], s59 offen sc1
    s_waitcnt vmcnt(0)
    v_readfirstlane_b32 s43, v6
    s_cmp_ge_u32 s43, s64
    s_cbranch_scc1 FPFW_P2
    s_add_u32 s98, s98, 1
    s_cmp_ge_u32 s98, 0x40000
    s_cbranch_scc1 FPFW_P3
    s_sleep 4
    s_branch FPFW_P1
FPFW_P2:
    buffer_load_dword v6, v9, s[32:35], s59 offen sc1
    s_waitcnt vmcnt(0)
    v_cmp_gt_u32 vcc, s64, v6
    s_cmp_eq_u64 vcc, 0
    s_cbranch_scc1 FPFW_P3
    s_add_u32 s98, s98, 1
    s_cmp_ge_u32 s98, 0x40000
    s_cbranch_scc1 FPFW_P3
    s_branch FPFW_P2
FPFW_P3:
    s_nop 1
    v_min_u32_dpp v6, v6, v6 row_ror:8 row_mask:0xf bank_mask:0xf
    s_nop 1
    v_min_u32_dpp v6, v6, v6 row_ror:4 row_mask:0xf bank_mask:0xf
    s_nop 1
    v_min_u32_dpp v6, v6, v6 row_ror:2 row_mask:0xf bank_mask:0xf
    s_nop 1
    v_min_u32_dpp v6, v6, v6 row_ror:1 row_mask:0xf bank_mask:0xf
    s_nop 1
    v_readlane_b32 s71, v6, 0
    v_readlane_b32 s72, v6, 16
    v_readlane_b32 s73, v6, 32
    v_readlane_b32 s74, v6, 48
    s_min_u32 s71, s71, s72
    s_min_u32 s73, s73, s74
    s_min_u32 s70, s71, s73
FPFW_P4:
FPF_B1:
    s_barrier
    s_mul_i32 s46, s63, 5120
    s_add_u32 s46, s46, 11534336
    s_mul_i32 s44, s63, 20480
    s_mul_i32 s43, s41, 5120
    s_add_u32 s44, s44, s43
    s_add_u32 s44, s44, 4194304
    s_add_u32 s45, s44, 4096
    s_cmp_ge_u32 s41, 2
    s_cbranch_scc1 FPF_NS
    buffer_load_dwordx2 v[192:193], v11, s[32:35], s46 offen offset:0
    buffer_load_dwordx2 v[194:195], v11, s[32:35], s46 offen offset:128
    buffer_load_dwordx2 v[196:197], v11, s[32:35], s46 offen offset:256
    buffer_load_dwordx2 v[198:199], v11, s[32:35], s46 offen offset:384
    buffer_load_dwordx2 v[200:201], v11, s[32:35], s46 offen offset:512
    buffer_load_dwordx2 v[202:203], v11, s[32:35], s46 offen offset:640
    buffer_load_dwordx2 v[204:205], v11, s[32:35], s46 offen offset:768
    buffer_load_dwordx2 v[206:207], v11, s[32:35], s46 offen offset:896
    buffer_load_dwordx2 v[208:209], v11, s[32:35], s46 offen offset:1024
    buffer_load_dwordx2 v[210:211], v11, s[32:35], s46 offen offset:1152
FPF_NS:
    buffer_load_dwordx4 v[96:99], v15, s[32:35], s44 offen offset:0
    buffer_load_dwordx4 v[100:103], v15, s[32:35], s44 offen offset:1024
    buffer_load_dwordx4 v[104:107], v15, s[32:35], s44 offen offset:2048
    buffer_load_dwordx4 v[108:111], v15, s[32:35], s44 offen offset:3072
    buffer_load_dwordx4 v[112:115], v15, s[32:35], s45 offen offset:0
    s_waitcnt vmcnt(4)
    v_mfma_f32_16x16x32_bf16 v[116:119], v[16:19], v[96:99], 0
    v_mfma_f32_16x16x32_bf16 v[120:123], v[20:23], v[96:99], 0
    v_mfma_f32_16x16x32_bf16 v[124:127], v[24:27], v[96:99], 0
    v_mfma_f32_16x16x32_bf16 v[128:131], v[28:31], v[96:99], 0
    s_waitcnt vmcnt(3)
    v_mfma_f32_16x16x32_bf16 v[116:119], v[32:35], v[100:103], v[116:119]
    v_mfma_f32_16x16x32_bf16 v[120:123], v[36:39], v[100:103], v[120:123]
    v_mfma_f32_16x16x32_bf16 v[124:127], v[40:43], v[100:103], v[124:127]
    v_mfma_f32_16x16x32_bf16 v[128:131], v[44:47], v[100:103], v[128:131]
    s_waitcnt vmcnt(2)
    v_mfma_f32_16x16x32_bf16 v[116:119], v[48:51], v[104:107], v[116:119]
    v_mfma_f32_16x16x32_bf16 v[120:123], v[52:55], v[104:107], v[120:123]
    v_mfma_f32_16x16x32_bf16 v[124:127], v[56:59], v[104:107], v[124:127]
    v_mfma_f32_16x16x32_bf16 v[128:131], v[60:63], v[104:107], v[128:131]
    s_waitcnt vmcnt(1)
    v_mfma_f32_16x16x32_bf16 v[116:119], v[64:67], v[108:111], v[116:119]
    v_mfma_f32_16x16x32_bf16 v[120:123], v[68:71], v[108:111], v[120:123]
    v_mfma_f32_16x16x32_bf16 v[124:127], v[72:75], v[108:111], v[124:127]
    v_mfma_f32_16x16x32_bf16 v[128:131], v[76:79], v[108:111], v[128:131]
    s_waitcnt vmcnt(0)
    v_mfma_f32_16x16x32_bf16 v[116:119], v[80:83], v[112:115], v[116:119]
    v_mfma_f32_16x16x32_bf16 v[120:123], v[84:87], v[112:115], v[120:123]
    v_mfma_f32_16x16x32_bf16 v[124:127], v[88:91], v[112:115], v[124:127]
    v_mfma_f32_16x16x32_bf16 v[128:131], v[92:95], v[112:115], v[128:131]
    s_nop 7
    s_nop 1
    ds_write_b128 v7, v[116:119] offset:0
    ds_write_b128 v7, v[120:123] offset:1024
    ds_write_b128 v7, v[124:127] offset:2048
    ds_write_b128 v7, v[128:131] offset:3072
    s_waitcnt lgkmcnt(0)
    s_barrier
    s_cmp_ge_u32 s41, 2
    s_cbranch_scc1 FPF_B3
    ds_read_b128 v[160:163], v8 offset:0
    ds_read_b128 v[164:167], v8 offset:2048
    ds_read_b128 v[168:171], v8 offset:4096
    ds_read_b128 v[172:175], v8 offset:6144
    ds_read_b128 v[176:179], v8 offset:8192
    ds_read_b128 v[180:183], v8 offset:10240
    ds_read_b128 v[184:187], v8 offset:12288
    ds_read_b128 v[188:191], v8 offset:14336
    s_waitcnt lgkmcnt(4)
    v_add_f32 v116, v160, v168
    v_add_f32 v117, v161, v169
    v_add_f32 v118, v162, v170
    v_add_f32 v119, v163, v171
    v_add_f32 v120, v164, v172
    v_add_f32 v121, v165, v173
    v_add_f32 v122, v166, v174
    v_add_f32 v123, v167, v175
    s_waitcnt lgkmcnt(0)
    v_add_f32 v176, v176, v184
    v_add_f32 v177, v177, v185
    v_add_f32 v178, v178, v186
    v_add_f32 v179, v179, v187
    v_add_f32 v180, v180, v188
    v_add_f32 v181, v181, v189
    v_add_f32 v182, v182, v190
    v_add_f32 v183, v183, v191
    v_add_f32 v116, v116, v176
    v_add_f32 v117, v117, v177
    v_add_f32 v118, v118, v178
    v_add_f32 v119, v119, v179
    v_add_f32 v120, v120, v180
    v_add_f32 v121, v121, v181
    v_add_f32 v122, v122, v182
    v_add_f32 v123, v123, v183
    v_add_f32 v192, v192, v194
    v_add_f32 v193, v193, v195
    v_add_f32 v196, v196, v198
    v_add_f32 v197, v197, v199
    v_add_f32 v200, v200, v202
    v_add_f32 v201, v201, v203
    v_add_f32 v204, v204, v206
    v_add_f32 v205, v205, v207
    v_add_f32 v208, v208, v210
    v_add_f32 v209, v209, v211
    v_add_f32 v192, v192, v196
    v_add_f32 v193, v193, v197
    v_add_f32 v200, v200, v204
    v_add_f32 v201, v201, v205
    v_add_f32 v192, v192, v200
    v_add_f32 v193, v193, v201
    v_add_f32 v192, v192, v208
    v_add_f32 v193, v193, v209
    v_mov_b32 v196, v192
    s_nop 1
    v_permlane32_swap_b32 v192, v196
    s_nop 1
    v_add_f32 v192, v192, v196
    v_mov_b32 v196, v192
    s_nop 1
    v_permlane16_swap_b32 v192, v196
    s_nop 1
    v_add_f32 v192, v192, v196
    v_mov_b32 v196, v193
    s_nop 1
    v_permlane32_swap_b32 v193, v196
    s_nop 1
    v_add_f32 v193, v193, v196
    v_mov_b32 v196, v193
    s_nop 1
    v_permlane16_swap_b32 v193, v196
    s_nop 1
    v_add_f32 v193, v193, v196
    v_mul_f32 v192, s24, v192
    v_mul_f32 v193, s24, v193
    v_fma_f32 v193, -v192, v192, v193
    v_max_f32 v193, 0, v193
    v_add_f32 v193, s25, v193
    v_rsq_f32 v193, v193
    s_nop 0
    v_mul_f32 v192, v192, v193
    v_fma_f32 v148, -v192, v132, v140
    v_fma_f32 v116, v193, v116, v148
    v_fma_f32 v148, -v192, v133, v141
    v_fma_f32 v117, v193, v117, v148
    v_fma_f32 v148, -v192, v134, v142
    v_fma_f32 v118, v193, v118, v148
    v_fma_f32 v148, -v192, v135, v143
    v_fma_f32 v119, v193, v119, v148
    v_fma_f32 v148, -v192, v136, v144
    v_fma_f32 v120, v193, v120, v148
    v_fma_f32 v148, -v192, v137, v145
    v_fma_f32 v121, v193, v121, v148
    v_fma_f32 v148, -v192, v138, v146
    v_fma_f32 v122, v193, v122, v148
    v_fma_f32 v148, -v192, v139, v147
    v_fma_f32 v123, v193, v123, v148
    v_cvt_pk_bf16_f32 v148, v116, v120
    v_lshlrev_b32 v116, 16, v148
    v_and_b32 v120, 0xffff0000, v148
    v_mul_f32 v149, v116, v116
    v_mov_b32 v150, s26
    v_fmac_f32 v150, s27, v149
    v_mul_f32 v150, v150, v116
    v_exp_f32 v150, v150
    s_nop 0
    v_add_f32 v150, 1.0, v150
    v_rcp_f32 v150, v150
    s_nop 0
    v_mul_f32 v150, v150, v116
    v_cvt_pk_bf16_f32 v150, v150, v150
    v_lshlrev_b32 v150, 16, v150
    v_mul_f32 v116, v150, v120
    v_cvt_pk_bf16_f32 v148, v117, v121
    v_lshlrev_b32 v117, 16, v148
    v_and_b32 v121, 0xffff0000, v148
    v_mul_f32 v149, v117, v117
    v_mov_b32 v150, s26
    v_fmac_f32 v150, s27, v149
    v_mul_f32 v150, v150, v117
    v_exp_f32 v150, v150
    s_nop 0
    v_add_f32 v150, 1.0, v150
    v_rcp_f32 v150, v150
    s_nop 0
    v_mul_f32 v150, v150, v117
    v_cvt_pk_bf16_f32 v150, v150, v150
    v_lshlrev_b32 v150, 16, v150
    v_mul_f32 v117, v150, v121
    v_cvt_pk_bf16_f32 v148, v118, v122
    v_lshlrev_b32 v118, 16, v148
    v_and_b32 v122, 0xffff0000, v148
    v_mul_f32 v149, v118, v118
    v_mov_b32 v150, s26
    v_fmac_f32 v150, s27, v149
    v_mul_f32 v150, v150, v118
    v_exp_f32 v150, v150
    s_nop 0
    v_add_f32 v150, 1.0, v150
    v_rcp_f32 v150, v150
    s_nop 0
    v_mul_f32 v150, v150, v118
    v_cvt_pk_bf16_f32 v150, v150, v150
    v_lshlrev_b32 v150, 16, v150
    v_mul_f32 v118, v150, v122
    v_cvt_pk_bf16_f32 v148, v119, v123
    v_lshlrev_b32 v119, 16, v148
    v_and_b32 v123, 0xffff0000, v148
    v_mul_f32 v149, v119, v119
    v_mov_b32 v150, s26
    v_fmac_f32 v150, s27, v149
    v_mul_f32 v150, v150, v119
    v_exp_f32 v150, v150
    s_nop 0
    v_add_f32 v150, 1.0, v150
    v_rcp_f32 v150, v150
    s_nop 0
    v_mul_f32 v150, v150, v119
    v_cvt_pk_bf16_f32 v150, v150, v150
    v_lshlrev_b32 v150, 16, v150
    v_mul_f32 v119, v150, v123
    v_cvt_pk_bf16_f32 v148, v116, v117
    v_cvt_pk_bf16_f32 v149, v118, v119
    s_mul_i32 s42, s63, 49152
    s_add_u32 s42, s42, s62
    buffer_store_dwordx2 v[148:149], v15, s[32:35], s42 offen sc1
FPF_B3:
    s_waitcnt vmcnt(0)
    s_barrier
    s_cmp_lg_u32 s40, 0
    s_cbranch_scc1 FPF_NF
    v_mov_b32 v6, s64
    v_mov_b32 v5, 0
    s_mov_b64 exec, 1
    buffer_store_dword v6, v5, s[32:35], s61 offen sc1
    s_mov_b64 exec, -1
FPF_NF:
    s_add_u32 s60, s60, 1
    s_cmp_lt_u32 s60, 60
    s_cbranch_scc1 FPF_LOOP
FPS_LOOP:
    s_lshl_b32 s63, s60, 1
    s_add_u32 s63, s63, s39
    s_add_u32 s64, s60, 1
    s_mul_i32 s46, s63, 5120
    s_add_u32 s46, s46, 11534336
    s_mul_i32 s44, s63, 20480
    s_mul_i32 s43, s41, 5120
    s_add_u32 s44, s44, s43
    s_add_u32 s44, s44, 4194304
    s_add_u32 s45, s44, 4096
FPS_S1:
    buffer_load_dword v6, v12, s[32:35], s45 offen sc1
    s_waitcnt vmcnt(0)
    v_readfirstlane_b32 s43, v6
    s_cmp_lg_u32 s43, -1
    s_cbranch_scc1 FPS_S1X
    s_add_u32 s98, s98, 1
    s_cmp_ge_u32 s98, 0x40000
    s_cbranch_scc1 FPS_S1X
    s_sleep 2
    s_branch FPS_S1
FPS_S1X:
    s_cmp_ge_u32 s41, 2
    s_cbranch_scc1 FPS_NS
FPSA_S2:
    buffer_load_dwordx2 v[192:193], v11, s[32:35], s46 offen offset:0 sc1
    buffer_load_dwordx2 v[194:195], v11, s[32:35], s46 offen offset:128 sc1
    buffer_load_dwordx2 v[196:197], v11, s[32:35], s46 offen offset:256 sc1
    buffer_load_dwordx2 v[198:199], v11, s[32:35], s46 offen offset:384 sc1
    buffer_load_dwordx2 v[200:201], v11, s[32:35], s46 offen offset:512 sc1
    buffer_load_dwordx2 v[202:203], v11, s[32:35], s46 offen offset:640 sc1
    buffer_load_dwordx2 v[204:205], v11, s[32:35], s46 offen offset:768 sc1
    buffer_load_dwordx2 v[206:207], v11, s[32:35], s46 offen offset:896 sc1
    buffer_load_dwordx2 v[208:209], v11, s[32:35], s46 offen offset:1024 sc1
    buffer_load_dwordx2 v[210:211], v11, s[32:35], s46 offen offset:1152 sc1
    buffer_load_dwordx4 v[96:99], v15, s[32:35], s44 offen offset:0 sc1
    buffer_load_dwordx4 v[100:103], v15, s[32:35], s44 offen offset:1024 sc1
    buffer_load_dwordx4 v[104:107], v15, s[32:35], s44 offen offset:2048 sc1
    buffer_load_dwordx4 v[108:111], v15, s[32:35], s44 offen offset:3072 sc1
    buffer_load_dwordx4 v[112:115], v15, s[32:35], s45 offen offset:0 sc1
    s_waitcnt vmcnt(0)
    v_max_u32 v6, v96, v98
    v_max3_u32 v6, v6, v100, v102
    v_max3_u32 v6, v6, v104, v106
    v_max3_u32 v6, v6, v108, v110
    v_max3_u32 v6, v6, v112, v114
    v_max3_u32 v6, v6, v192, v194
    v_max3_u32 v6, v6, v196, v198
    v_max3_u32 v6, v6, v200, v202
    v_max3_u32 v6, v6, v204, v206
    v_max3_u32 v6, v6, v208, v210
    v_cmp_eq_u32 vcc, -1, v6
    s_add_u32 s98, s98, 1
    s_cmp_lt_u32 s98, 0x40000
    s_cselect_b64 s[90:91], vcc, 0
    s_cmp_lg_u64 s[90:91], 0
    s_cbranch_scc1 FPSA_S2
    s_branch FPS_NS2
FPS_NS:
FPSB_S2:
    buffer_load_dwordx4 v[96:99], v15, s[32:35], s44 offen offset:0 sc1
    buffer_load_dwordx4 v[100:103], v15, s[32:35], s44 offen offset:1024 sc1
    buffer_load_dwordx4 v[104:107], v15, s[32:35], s44 offen offset:2048 sc1
    buffer_load_dwordx4 v[108:111], v15, s[32:35], s44 offen offset:3072 sc1
    buffer_load_dwordx4 v[112:115], v15, s[32:35], s45 offen offset:0 sc1
    s_waitcnt vmcnt(0)
    v_max_u32 v6, v96, v98
    v_max3_u32 v6, v6, v100, v102
    v_max3_u32 v6, v6, v104, v106
    v_max3_u32 v6, v6, v108, v110
    v_max3_u32 v6, v6, v112, v114
    v_cmp_eq_u32 vcc, -1, v6
    s_add_u32 s98, s98, 1
    s_cmp_lt_u32 s98, 0x40000
    s_cselect_b64 s[90:91], vcc, 0
    s_cmp_lg_u64 s[90:91], 0
    s_cbranch_scc1 FPSB_S2
FPS_NS2:
    v_mfma_f32_16x16x32_bf16 v[116:119], v[16:19], v[96:99], 0
    v_mfma_f32_16x16x32_bf16 v[120:123], v[20:23], v[96:99], 0
    v_mfma_f32_16x16x32_bf16 v[124:127], v[24:27], v[96:99], 0
    v_mfma_f32_16x16x32_bf16 v[128:131], v[28:31], v[96:99], 0
    v_mfma_f32_16x16x32_bf16 v[116:119], v[32:35], v[100:103], v[116:119]
    v_mfma_f32_16x16x32_bf16 v[120:123], v[36:39], v[100:103], v[120:123]
    v_mfma_f32_16x16x32_bf16 v[124:127], v[40:43], v[100:103], v[124:127]
    v_mfma_f32_16x16x32_bf16 v[128:131], v[44:47], v[100:103], v[128:131]
    v_mfma_f32_16x16x32_bf16 v[116:119], v[48:51], v[104:107], v[116:119]
    v_mfma_f32_16x16x32_bf16 v[120:123], v[52:55], v[104:107], v[120:123]
    v_mfma_f32_16x16x32_bf16 v[124:127], v[56:59], v[104:107], v[124:127]
    v_mfma_f32_16x16x32_bf16 v[128:131], v[60:63], v[104:107], v[128:131]
    v_mfma_f32_16x16x32_bf16 v[116:119], v[64:67], v[108:111], v[116:119]
    v_mfma_f32_16x16x32_bf16 v[120:123], v[68:71], v[108:111], v[120:123]
    v_mfma_f32_16x16x32_bf16 v[124:127], v[72:75], v[108:111], v[124:127]
    v_mfma_f32_16x16x32_bf16 v[128:131], v[76:79], v[108:111], v[128:131]
    v_mfma_f32_16x16x32_bf16 v[116:119], v[80:83], v[112:115], v[116:119]
    v_mfma_f32_16x16x32_bf16 v[120:123], v[84:87], v[112:115], v[120:123]
    v_mfma_f32_16x16x32_bf16 v[124:127], v[88:91], v[112:115], v[124:127]
    v_mfma_f32_16x16x32_bf16 v[128:131], v[92:95], v[112:115], v[128:131]
    s_nop 7
    s_nop 1
    ds_write_b128 v7, v[116:119] offset:0
    ds_write_b128 v7, v[120:123] offset:1024
    ds_write_b128 v7, v[124:127] offset:2048
    ds_write_b128 v7, v[128:131] offset:3072
    s_waitcnt lgkmcnt(0)
    s_barrier
    s_cmp_ge_u32 s41, 2
    s_cbranch_scc1 FPS_B3
    ds_read_b128 v[160:163], v8 offset:0
    ds_read_b128 v[164:167], v8 offset:2048
    ds_read_b128 v[168:171], v8 offset:4096
    ds_read_b128 v[172:175], v8 offset:6144
    ds_read_b128 v[176:179], v8 offset:8192
    ds_read_b128 v[180:183], v8 offset:10240
    ds_read_b128 v[184:187], v8 offset:12288
    ds_read_b128 v[188:191], v8 offset:14336
    s_waitcnt lgkmcnt(4)
    v_add_f32 v116, v160, v168
    v_add_f32 v117, v161, v169
    v_add_f32 v118, v162, v170
    v_add_f32 v119, v163, v171
    v_add_f32 v120, v164, v172
    v_add_f32 v121, v165, v173
    v_add_f32 v122, v166, v174
    v_add_f32 v123, v167, v175
    s_waitcnt lgkmcnt(0)
    v_add_f32 v176, v176, v184
    v_add_f32 v177, v177, v185
    v_add_f32 v178, v178, v186
    v_add_f32 v179, v179, v187
    v_add_f32 v180, v180, v188
    v_add_f32 v181, v181, v189
    v_add_f32 v182, v182, v190
    v_add_f32 v183, v183, v191
    v_add_f32 v116, v116, v176
    v_add_f32 v117, v117, v177
    v_add_f32 v118, v118, v178
    v_add_f32 v119, v119, v179
    v_add_f32 v120, v120, v180
    v_add_f32 v121, v121, v181
    v_add_f32 v122, v122, v182
    v_add_f32 v123, v123, v183
    v_add_f32 v192, v192, v194
    v_add_f32 v193, v193, v195
    v_add_f32 v196, v196, v198
    v_add_f32 v197, v197, v199
    v_add_f32 v200, v200, v202
    v_add_f32 v201, v201, v203
    v_add_f32 v204, v204, v206
    v_add_f32 v205, v205, v207
    v_add_f32 v208, v208, v210
    v_add_f32 v209, v209, v211
    v_add_f32 v192, v192, v196
    v_add_f32 v193, v193, v197
    v_add_f32 v200, v200, v204
    v_add_f32 v201, v201, v205
    v_add_f32 v192, v192, v200
    v_add_f32 v193, v193, v201
    v_add_f32 v192, v192, v208
    v_add_f32 v193, v193, v209
    v_mov_b32 v196, v192
    s_nop 1
    v_permlane32_swap_b32 v192, v196
    s_nop 1
    v_add_f32 v192, v192, v196
    v_mov_b32 v196, v192
    s_nop 1
    v_permlane16_swap_b32 v192, v196
    s_nop 1
    v_add_f32 v192, v192, v196
    v_mov_b32 v196, v193
    s_nop 1
    v_permlane32_swap_b32 v193, v196
    s_nop 1
    v_add_f32 v193, v193, v196
    v_mov_b32 v196, v193
    s_nop 1
    v_permlane16_swap_b32 v193, v196
    s_nop 1
    v_add_f32 v193, v193, v196
    v_mul_f32 v192, s24, v192
    v_mul_f32 v193, s24, v193
    v_fma_f32 v193, -v192, v192, v193
    v_max_f32 v193, 0, v193
    v_add_f32 v193, s25, v193
    v_rsq_f32 v193, v193
    s_nop 0
    v_mul_f32 v192, v192, v193
    v_fma_f32 v148, -v192, v132, v140
    v_fma_f32 v116, v193, v116, v148
    v_fma_f32 v148, -v192, v133, v141
    v_fma_f32 v117, v193, v117, v148
    v_fma_f32 v148, -v192, v134, v142
    v_fma_f32 v118, v193, v118, v148
    v_fma_f32 v148, -v192, v135, v143
    v_fma_f32 v119, v193, v119, v148
    v_fma_f32 v148, -v192, v136, v144
    v_fma_f32 v120, v193, v120, v148
    v_fma_f32 v148, -v192, v137, v145
    v_fma_f32 v121, v193, v121, v148
    v_fma_f32 v148, -v192, v138, v146
    v_fma_f32 v122, v193, v122, v148
    v_fma_f32 v148, -v192, v139, v147
    v_fma_f32 v123, v193, v123, v148
    v_cvt_pk_bf16_f32 v148, v116, v120
    v_lshlrev_b32 v116, 16, v148
    v_and_b32 v120, 0xffff0000, v148
    v_mul_f32 v149, v116, v116
    v_mov_b32 v150, s26
    v_fmac_f32 v150, s27, v149
    v_mul_f32 v150, v150, v116
    v_exp_f32 v150, v150
    s_nop 0
    v_add_f32 v150, 1.0, v150
    v_rcp_f32 v150, v150
    s_nop 0
    v_mul_f32 v150, v150, v116
    v_cvt_pk_bf16_f32 v150, v150, v150
    v_lshlrev_b32 v150, 16, v150
    v_mul_f32 v116, v150, v120
    v_cvt_pk_bf16_f32 v148, v117, v121
    v_lshlrev_b32 v117, 16, v148
    v_and_b32 v121, 0xffff0000, v148
    v_mul_f32 v149, v117, v117
    v_mov_b32 v150, s26
    v_fmac_f32 v150, s27, v149
    v_mul_f32 v150, v150, v117
    v_exp_f32 v150, v150
    s_nop 0
    v_add_f32 v150, 1.0, v150
    v_rcp_f32 v150, v150
    s_nop 0
    v_mul_f32 v150, v150, v117
    v_cvt_pk_bf16_f32 v150, v150, v150
    v_lshlrev_b32 v150, 16, v150
    v_mul_f32 v117, v150, v121
    v_cvt_pk_bf16_f32 v148, v118, v122
    v_lshlrev_b32 v118, 16, v148
    v_and_b32 v122, 0xffff0000, v148
    v_mul_f32 v149, v118, v118
    v_mov_b32 v150, s26
    v_fmac_f32 v150, s27, v149
    v_mul_f32 v150, v150, v118
    v_exp_f32 v150, v150
    s_nop 0
    v_add_f32 v150, 1.0, v150
    v_rcp_f32 v150, v150
    s_nop 0
    v_mul_f32 v150, v150, v118
    v_cvt_pk_bf16_f32 v150, v150, v150
    v_lshlrev_b32 v150, 16, v150
    v_mul_f32 v118, v150, v122
    v_cvt_pk_bf16_f32 v148, v119, v123
    v_lshlrev_b32 v119, 16, v148
    v_and_b32 v123, 0xffff0000, v148
    v_mul_f32 v149, v119, v119
    v_mov_b32 v150, s26
    v_fmac_f32 v150, s27, v149
    v_mul_f32 v150, v150, v119
    v_exp_f32 v150, v150
    s_nop 0
    v_add_f32 v150, 1.0, v150
    v_rcp_f32 v150, v150
    s_nop 0
    v_mul_f32 v150, v150, v119
    v_cvt_pk_bf16_f32 v150, v150, v150
    v_lshlrev_b32 v150, 16, v150
    v_mul_f32 v119, v150, v123
    v_cvt_pk_bf16_f32 v148, v116, v117
    v_cvt_pk_bf16_f32 v149, v118, v119
    s_mul_i32 s42, s63, 49152
    s_add_u32 s42, s42, s62
    buffer_store_dwordx2 v[148:149], v15, s[32:35], s42 offen sc1
FPS_B3:
    s_barrier
    s_add_u32 s60, s60, 1
    s_cmp_lt_u32 s60, 64
    s_cbranch_scc1 FPS_LOOP
    s_branch WDONE
B_FBP:
    s_load_dwordx2 s[4:5], s[0:1], 80
    s_load_dwordx2 s[6:7], s[0:1], 104
    s_waitcnt lgkmcnt(0)
    s_mov_b32 s8, s4
    s_mov_b32 s9, s5
    s_mov_b32 s10, 1966080
    s_mov_b32 s11, 0x00020000
    s_mov_b32 s12, s6
    s_mov_b32 s13, s7
    s_mov_b32 s14, 2621440
    s_mov_b32 s15, 0x00020000
    v_lshlrev_b32 v15, 4, v1
    v_mov_b32 v12, 0
    v_lshrrev_b32 v4, 2, v1
    v_mul_u32_u24 v4, 1280, v4
    v_and_b32 v5, 3, v1
    v_lshl_add_u32 v4, v5, 4, v4
    s_mul_i32 s42, s40, 245760
    s_lshl_b32 s43, s56, 6
    s_add_u32 s42, s42, s43
    s_mul_i32 s44, s40, 12288
    s_add_u32 m0, s44, 0
    s_add_u32 s43, s42, 0
    buffer_load_dwordx4 v4, s[8:11], s43 offen lds
    s_add_u32 m0, s44, 1024
    s_add_u32 s43, s42, 20480
    buffer_load_dwordx4 v4, s[8:11], s43 offen lds
    s_add_u32 m0, s44, 2048
    s_add_u32 s43, s42, 40960
    buffer_load_dwordx4 v4, s[8:11], s43 offen lds
    s_add_u32 m0, s44, 3072
    s_add_u32 s43, s42, 61440
    buffer_load_dwordx4 v4, s[8:11], s43 offen lds
    s_add_u32 m0, s44, 4096
    s_add_u32 s43, s42, 81920
    buffer_load_dwordx4 v4, s[8:11], s43 offen lds
    s_add_u32 m0, s44, 5120
    s_add_u32 s43, s42, 102400
    buffer_load_dwordx4 v4, s[8:11], s43 offen lds
    s_add_u32 m0, s44, 6144
    s_add_u32 s43, s42, 122880
    buffer_load_dwordx4 v4, s[8:11], s43 offen lds
    s_add_u32 m0, s44, 7168
    s_add_u32 s43, s42, 143360
    buffer_load_dwordx4 v4, s[8:11], s43 offen lds
    s_add_u32 m0, s44, 8192
    s_add_u32 s43, s42, 163840
    buffer_load_dwordx4 v4, s[8:11], s43 offen lds
    s_add_u32 m0, s44, 9216
    s_add_u32 s43, s42, 184320
    buffer_load_dwordx4 v4, s[8:11], s43 offen lds
    s_add_u32 m0, s44, 10240
    s_add_u32 s43, s42, 204800
    buffer_load_dwordx4 v4, s[8:11], s43 offen lds
    s_add_u32 m0, s44, 11264
    s_add_u32 s43, s42, 225280
    buffer_load_dwordx4 v4, s[8:11], s43 offen lds
    s_and_b32 s45, s40, 1
    s_lshl_b32 s42, s56, 7
    s_lshl_b32 s43, s45, 6
    s_add_u32 s42, s42, s43
    s_add_u32 s42, s42, 12800
    v_lshlrev_b32 v5, 4, v3
    buffer_load_dwordx4 v[96:99], v5, s[32:35], s42 offen
    v_lshrrev_b32 v6, 2, v2
    v_lshl_add_u32 v6, v3, 2, v6
    v_lshlrev_b32 v6, 6, v6
    v_and_b32 v7, 3, v2
    v_lshl_add_u32 v6, v7, 3, v6
    v_add_u32 v6, s44, v6
    s_waitcnt vmcnt(0)
    ds_read_b64_tr_b16 v[16:17], v6 offset:0
    ds_read_b64_tr_b16 v[18:19], v6 offset:1024
    ds_read_b64_tr_b16 v[20:21], v6 offset:32
    ds_read_b64_tr_b16 v[22:23], v6 offset:1056
    ds_read_b64_tr_b16 v[24:25], v6 offset:2048
    ds_read_b64_tr_b16 v[26:27], v6 offset:3072
    ds_read_b64_tr_b16 v[28:29], v6 offset:2080
    ds_read_b64_tr_b16 v[30:31], v6 offset:3104
    s_waitcnt lgkmcnt(0)
    ds_read_b64_tr_b16 v[32:33], v6 offset:4096
    ds_read_b64_tr_b16 v[34:35], v6 offset:5120
    ds_read_b64_tr_b16 v[36:37], v6 offset:4128
    ds_read_b64_tr_b16 v[38:39], v6 offset:5152
    ds_read_b64_tr_b16 v[40:41], v6 offset:6144
    ds_read_b64_tr_b16 v[42:43], v6 offset:7168
    ds_read_b64_tr_b16 v[44:45], v6 offset:6176
    ds_read_b64_tr_b16 v[46:47], v6 offset:7200
    s_waitcnt lgkmcnt(0)
    ds_read_b64_tr_b16 v[48:49], v6 offset:8192
    ds_read_b64_tr_b16 v[50:51], v6 offset:9216
    ds_read_b64_tr_b16 v[52:53], v6 offset:8224
    ds_read_b64_tr_b16 v[54:55], v6 offset:9248
    ds_read_b64_tr_b16 v[56:57], v6 offset:10240
    ds_read_b64_tr_b16 v[58:59], v6 offset:11264
    ds_read_b64_tr_b16 v[60:61], v6 offset:10272
    ds_read_b64_tr_b16 v[62:63], v6 offset:11296
    s_waitcnt lgkmcnt(0)
    s_lshl_b32 s42, s40, 11
    s_add_u32 s42, s42, 98304
    v_add_u32 v7, s42, v15
    s_lshl_b32 s42, s45, 10
    s_add_u32 s42, s42, 98304
    v_add_u32 v8, s42, v15
    v_min_u32 v9, 47, v1
    v_lshlrev_b32 v9, 7, v9
    s_lshl_b32 s42, s56, 1
    s_add_u32 s42, s42, s57
    s_lshl_b32 s42, s42, 7
    v_mov_b32 v10, s42
    s_mov_b32 s59, 154624
    v_mul_u32_u24 v4, 1280, v2
    v_lshl_add_u32 v4, v3, 3, v4
    s_lshl_b32 s62, s56, 6
    s_lshl_b32 s43, s45, 5
    s_add_u32 s62, s62, s43
    s_lshl_b32 s61, s56, 10
    s_lshl_b32 s43, s45, 3
    s_add_u32 s61, s61, s43
    s_add_u32 s61, s61, 7340032
    s_mov_b32 s60, 44
    s_mov_b32 s70, 0
BPF_LOOP:
    s_lshl_b32 s63, s60, 1
    s_add_u32 s63, s63, s57
    s_add_u32 s64, s60, 1
    s_cmp_lg_u32 s40, 7
    s_cbranch_scc1 BPF_B1
    s_cmp_ge_u32 s70, s64
    s_cbranch_scc1 BPFW_P4
BPFW_P1:
    buffer_load_dword v6, v10, s[32:35], s59 offen sc1
    s_waitcnt vmcnt(0)
    v_readfirstlane_b32 s43, v6
    s_cmp_ge_u32 s43, s64
    s_cbranch_scc1 BPFW_P2
    s_add_u32 s98, s98, 1
    s_cmp_ge_u32 s98, 0x40000
    s_cbranch_scc1 BPFW_P3
    s_sleep 4
    s_branch BPFW_P1
BPFW_P2:
    buffer_load_dword v6, v9, s[32:35], s59 offen sc1
    s_waitcnt vmcnt(0)
    v_cmp_gt_u32 vcc, s64, v6
    s_cmp_eq_u64 vcc, 0
    s_cbranch_scc1 BPFW_P3
    s_add_u32 s98, s98, 1
    s_cmp_ge_u32 s98, 0x40000
    s_cbranch_scc1 BPFW_P3
    s_branch BPFW_P2
BPFW_P3:
    s_nop 1
    v_min_u32_dpp v6, v6, v6 row_ror:8 row_mask:0xf bank_mask:0xf
    s_nop 1
    v_min_u32_dpp v6, v6, v6 row_ror:4 row_mask:0xf bank_mask:0xf
    s_nop 1
    v_min_u32_dpp v6, v6, v6 row_ror:2 row_mask:0xf bank_mask:0xf
    s_nop 1
    v_min_u32_dpp v6, v6, v6 row_ror:1 row_mask:0xf bank_mask:0xf
    s_nop 1
    v_readlane_b32 s71, v6, 0
    v_readlane_b32 s72, v6, 16
    v_readlane_b32 s73, v6, 32
    v_readlane_b32 s74, v6, 48
    s_min_u32 s71, s71, s72
    s_min_u32 s73, s73, s74
    s_min_u32 s70, s71, s73
BPFW_P4:
BPF_B1:
    s_barrier
    s_mul_i32 s46, s63, 20480
    s_add_u32 s46, s46, s61
    s_mul_i32 s44, s63, 49152
    s_mul_i32 s43, s40, 6144
    s_add_u32 s44, s44, s43
    s_add_u32 s44, s44, 13631488
    s_add_u32 s45, s44, 4096
    s_cmp_ge_u32 s40, 2
    s_cbranch_scc1 BPF_NX
    buffer_load_dwordx2 v[100:101], v15, s[32:35], s46 offen
BPF_NX:
    buffer_load_dwordx4 v[64:67], v15, s[32:35], s44 offen offset:0
    buffer_load_dwordx4 v[68:71], v15, s[32:35], s44 offen offset:1024
    buffer_load_dwordx4 v[72:75], v15, s[32:35], s44 offen offset:2048
    buffer_load_dwordx4 v[76:79], v15, s[32:35], s44 offen offset:3072
    buffer_load_dwordx4 v[80:83], v15, s[32:35], s45 offen offset:0
    buffer_load_dwordx4 v[84:87], v15, s[32:35], s45 offen offset:1024
    s_waitcnt vmcnt(5)
    v_mfma_f32_16x16x32_bf16 v[88:91], v[16:19], v[64:67], 0
    v_mfma_f32_16x16x32_bf16 v[92:95], v[20:23], v[64:67], 0
    s_waitcnt vmcnt(4)
    v_mfma_f32_16x16x32_bf16 v[88:91], v[24:27], v[68:71], v[88:91]
    v_mfma_f32_16x16x32_bf16 v[92:95], v[28:31], v[68:71], v[92:95]
    s_waitcnt vmcnt(3)
    v_mfma_f32_16x16x32_bf16 v[88:91], v[32:35], v[72:75], v[88:91]
    v_mfma_f32_16x16x32_bf16 v[92:95], v[36:39], v[72:75], v[92:95]
    s_waitcnt vmcnt(2)
    v_mfma_f32_16x16x32_bf16 v[88:91], v[40:43], v[76:79], v[88:91]
    v_mfma_f32_16x16x32_bf16 v[92:95], v[44:47], v[76:79], v[92:95]
    s_waitcnt vmcnt(1)
    v_mfma_f32_16x16x32_bf16 v[88:91], v[48:51], v[80:83], v[88:91]
    v_mfma_f32_16x16x32_bf16 v[92:95], v[52:55], v[80:83], v[92:95]
    s_waitcnt vmcnt(0)
    v_mfma_f32_16x16x32_bf16 v[88:91], v[56:59], v[84:87], v[88:91]
    v_mfma_f32_16x16x32_bf16 v[92:95], v[60:63], v[84:87], v[92:95]
    s_nop 7
    s_nop 1
    ds_write_b128 v7, v[88:91] offset:0
    ds_write_b128 v7, v[92:95] offset:1024
    s_waitcnt lgkmcnt(0)
    s_barrier
    s_cmp_ge_u32 s40, 2
    s_cbranch_scc1 BPF_NE
    ds_read_b128 v[104:107], v8 offset:0
    ds_read_b128 v[108:111], v8 offset:2048
    ds_read_b128 v[112:115], v8 offset:4096
    ds_read_b128 v[116:119], v8 offset:6144
    ds_read_b128 v[120:123], v8 offset:8192
    ds_read_b128 v[124:127], v8 offset:10240
    ds_read_b128 v[128:131], v8 offset:12288
    ds_read_b128 v[132:135], v8 offset:14336
    s_waitcnt lgkmcnt(4)
    v_add_f32 v104, v104, v108
    v_add_f32 v112, v112, v116
    v_add_f32 v105, v105, v109
    v_add_f32 v113, v113, v117
    v_add_f32 v106, v106, v110
    v_add_f32 v114, v114, v118
    v_add_f32 v107, v107, v111
    v_add_f32 v115, v115, v119
    s_waitcnt lgkmcnt(0)
    v_add_f32 v120, v120, v124
    v_add_f32 v128, v128, v132
    v_add_f32 v121, v121, v125
    v_add_f32 v129, v129, v133
    v_add_f32 v122, v122, v126
    v_add_f32 v130, v130, v134
    v_add_f32 v123, v123, v127
    v_add_f32 v131, v131, v135
    v_add_f32 v104, v104, v112
    v_add_f32 v120, v120, v128
    v_add_f32 v105, v105, v113
    v_add_f32 v121, v121, v129
    v_add_f32 v106, v106, v114
    v_add_f32 v122, v122, v130
    v_add_f32 v107, v107, v115
    v_add_f32 v123, v123, v131
    v_add_f32 v104, v104, v120
    v_cvt_pk_bf16_f32 v104, v104, v104
    v_lshlrev_b32 v104, 16, v104
    v_mul_f32 v104, v104, v96
    v_cvt_pk_bf16_f32 v104, v104, v104
    v_lshlrev_b32 v104, 16, v104
    v_add_f32 v105, v105, v121
    v_cvt_pk_bf16_f32 v105, v105, v105
    v_lshlrev_b32 v105, 16, v105
    v_mul_f32 v105, v105, v97
    v_cvt_pk_bf16_f32 v105, v105, v105
    v_lshlrev_b32 v105, 16, v105
    v_add_f32 v106, v106, v122
    v_cvt_pk_bf16_f32 v106, v106, v106
    v_lshlrev_b32 v106, 16, v106
    v_mul_f32 v106, v106, v98
    v_cvt_pk_bf16_f32 v106, v106, v106
    v_lshlrev_b32 v106, 16, v106
    v_add_f32 v107, v107, v123
    v_cvt_pk_bf16_f32 v107, v107, v107
    v_lshlrev_b32 v107, 16, v107
    v_mul_f32 v107, v107, v99
    v_cvt_pk_bf16_f32 v107, v107, v107
    v_lshlrev_b32 v107, 16, v107
    v_lshlrev_b32 v108, 16, v100
    v_and_b32 v109, 0xffff0000, v100
    v_lshlrev_b32 v110, 16, v101
    v_and_b32 v111, 0xffff0000, v101
    v_add_f32 v104, v104, v108
    v_add_f32 v105, v105, v109
    v_add_f32 v106, v106, v110
    v_add_f32 v107, v107, v111
    v_cvt_pk_bf16_f32 v112, v104, v105
    v_cvt_pk_bf16_f32 v113, v106, v107
    s_mul_i32 s42, s63, 20480
    s_add_u32 s42, s42, s62
    buffer_store_dwordx2 v[112:113], v4, s[12:15], s42 offen
BPF_NE:
    s_barrier
    s_add_u32 s60, s60, 1
    s_cmp_lt_u32 s60, 60
    s_cbranch_scc1 BPF_LOOP
BPS_LOOP:
    s_lshl_b32 s63, s60, 1
    s_add_u32 s63, s63, s57
    s_add_u32 s64, s60, 1
    s_mul_i32 s46, s63, 20480
    s_add_u32 s46, s46, s61
    s_mul_i32 s44, s63, 49152
    s_mul_i32 s43, s40, 6144
    s_add_u32 s44, s44, s43
    s_add_u32 s44, s44, 13631488
    s_add_u32 s45, s44, 4096
BPS_S1:
    buffer_load_dword v6, v12, s[32:35], s45 offen sc1
    s_waitcnt vmcnt(0)
    v_readfirstlane_b32 s43, v6
    s_cmp_lg_u32 s43, -1
    s_cbranch_scc1 BPS_S1X
    s_add_u32 s98, s98, 1
    s_cmp_ge_u32 s98, 0x40000
    s_cbranch_scc1 BPS_S1X
    s_sleep 2
    s_branch BPS_S1
BPS_S1X:
    s_cmp_ge_u32 s40, 2
    s_cbranch_scc1 BPS_NX
BPSA_S2:
    buffer_load_dwordx2 v[100:101], v15, s[32:35], s46 offen sc1
    buffer_load_dwordx4 v[64:67], v15, s[32:35], s44 offen offset:0 sc1
    buffer_load_dwordx4 v[68:71], v15, s[32:35], s44 offen offset:1024 sc1
    buffer_load_dwordx4 v[72:75], v15, s[32:35], s44 offen offset:2048 sc1
    buffer_load_dwordx4 v[76:79], v15, s[32:35], s44 offen offset:3072 sc1
    buffer_load_dwordx4 v[80:83], v15, s[32:35], s45 offen offset:0 sc1
    buffer_load_dwordx4 v[84:87], v15, s[32:35], s45 offen offset:1024 sc1
    s_waitcnt vmcnt(0)
    v_max_u32 v6, v64, v66
    v_max3_u32 v6, v6, v68, v70
    v_max3_u32 v6, v6, v72, v74
    v_max3_u32 v6, v6, v76, v78
    v_max3_u32 v6, v6, v80, v82
    v_max3_u32 v6, v6, v84, v86
    v_max3_u32 v6, v6, v100, v100
    v_cmp_eq_u32 vcc, -1, v6
    s_add_u32 s98, s98, 1
    s_cmp_lt_u32 s98, 0x40000
    s_cselect_b64 s[90:91], vcc, 0
    s_cmp_lg_u64 s[90:91], 0
    s_cbranch_scc1 BPSA_S2
    s_branch BPS_NX2
BPS_NX:
BPSB_S2:
    buffer_load_dwordx4 v[64:67], v15, s[32:35], s44 offen offset:0 sc1
    buffer_load_dwordx4 v[68:71], v15, s[32:35], s44 offen offset:1024 sc1
    buffer_load_dwordx4 v[72:75], v15, s[32:35], s44 offen offset:2048 sc1
    buffer_load_dwordx4 v[76:79], v15, s[32:35], s44 offen offset:3072 sc1
    buffer_load_dwordx4 v[80:83], v15, s[32:35], s45 offen offset:0 sc1
    buffer_load_dwordx4 v[84:87], v15, s[32:35], s45 offen offset:1024 sc1
    s_waitcnt vmcnt(0)
    v_max_u32 v6, v64, v66
    v_max3_u32 v6, v6, v68, v70
    v_max3_u32 v6, v6, v72, v74
    v_max3_u32 v6, v6, v76, v78
    v_max3_u32 v6, v6, v80, v82
    v_max3_u32 v6, v6, v84, v86
    v_cmp_eq_u32 vcc, -1, v6
    s_add_u32 s98, s98, 1
    s_cmp_lt_u32 s98, 0x40000
    s_cselect_b64 s[90:91], vcc, 0
    s_cmp_lg_u64 s[90:91], 0
    s_cbranch_scc1 BPSB_S2
BPS_NX2:
    v_mfma_f32_16x16x32_bf16 v[88:91], v[16:19], v[64:67], 0
    v_mfma_f32_16x16x32_bf16 v[92:95], v[20:23], v[64:67], 0
    v_mfma_f32_16x16x32_bf16 v[88:91], v[24:27], v[68:71], v[88:91]
    v_mfma_f32_16x16x32_bf16 v[92:95], v[28:31], v[68:71], v[92:95]
    v_mfma_f32_16x16x32_bf16 v[88:91], v[32:35], v[72:75], v[88:91]
    v_mfma_f32_16x16x32_bf16 v[92:95], v[36:39], v[72:75], v[92:95]
    v_mfma_f32_16x16x32_bf16 v[88:91], v[40:43], v[76:79], v[88:91]
    v_mfma_f32_16x16x32_bf16 v[92:95], v[44:47], v[76:79], v[92:95]
    v_mfma_f32_16x16x32_bf16 v[88:91], v[48:51], v[80:83], v[88:91]
    v_mfma_f32_16x16x32_bf16 v[92:95], v[52:55], v[80:83], v[92:95]
    v_mfma_f32_16x16x32_bf16 v[88:91], v[56:59], v[84:87], v[88:91]
    v_mfma_f32_16x16x32_bf16 v[92:95], v[60:63], v[84:87], v[92:95]
    s_nop 7
    s_nop 1
    ds_write_b128 v7, v[88:91] offset:0
    ds_write_b128 v7, v[92:95] offset:1024
    s_waitcnt lgkmcnt(0)
    s_barrier
    s_cmp_ge_u32 s40, 2
    s_cbranch_scc1 BPS_NE
    ds_read_b128 v[104:107], v8 offset:0
    ds_read_b128 v[108:111], v8 offset:2048
    ds_read_b128 v[112:115], v8 offset:4096
    ds_read_b128 v[116:119], v8 offset:6144
    ds_read_b128 v[120:123], v8 offset:8192
    ds_read_b128 v[124:127], v8 offset:10240
    ds_read_b128 v[128:131], v8 offset:12288
    ds_read_b128 v[132:135], v8 offset:14336
    s_waitcnt lgkmcnt(4)
    v_add_f32 v104, v104, v108
    v_add_f32 v112, v112, v116
    v_add_f32 v105, v105, v109
    v_add_f32 v113, v113, v117
    v_add_f32 v106, v106, v110
    v_add_f32 v114, v114, v118
    v_add_f32 v107, v107, v111
    v_add_f32 v115, v115, v119
    s_waitcnt lgkmcnt(0)
    v_add_f32 v120, v120, v124
    v_add_f32 v128, v128, v132
    v_add_f32 v121, v121, v125
    v_add_f32 v129, v129, v133
    v_add_f32 v122, v122, v126
    v_add_f32 v130, v130, v134
    v_add_f32 v123, v123, v127
    v_add_f32 v131, v131, v135
    v_add_f32 v104, v104, v112
    v_add_f32 v120, v120, v128
    v_add_f32 v105, v105, v113
    v_add_f32 v121, v121, v129
    v_add_f32 v106, v106, v114
    v_add_f32 v122, v122, v130
    v_add_f32 v107, v107, v115
    v_add_f32 v123, v123, v131
    v_add_f32 v104, v104, v120
    v_cvt_pk_bf16_f32 v104, v104, v104
    v_lshlrev_b32 v104, 16, v104
    v_mul_f32 v104, v104, v96
    v_cvt_pk_bf16_f32 v104, v104, v104
    v_lshlrev_b32 v104, 16, v104
    v_add_f32 v105, v105, v121
    v_cvt_pk_bf16_f32 v105, v105, v105
    v_lshlrev_b32 v105, 16, v105
    v_mul_f32 v105, v105, v97
    v_cvt_pk_bf16_f32 v105, v105, v105
    v_lshlrev_b32 v105, 16, v105
    v_add_f32 v106, v106, v122
    v_cvt_pk_bf16_f32 v106, v106, v106
    v_lshlrev_b32 v106, 16, v106
    v_mul_f32 v106, v106, v98
    v_cvt_pk_bf16_f32 v106, v106, v106
    v_lshlrev_b32 v106, 16, v106
    v_add_f32 v107, v107, v123
    v_cvt_pk_bf16_f32 v107, v107, v107
    v_lshlrev_b32 v107, 16, v107
    v_mul_f32 v107, v107, v99
    v_cvt_pk_bf16_f32 v107, v107, v107
    v_lshlrev_b32 v107, 16, v107
    v_lshlrev_b32 v108, 16, v100
    v_and_b32 v109, 0xffff0000, v100
    v_lshlrev_b32 v110, 16, v101
    v_and_b32 v111, 0xffff0000, v101
    v_add_f32 v104, v104, v108
    v_add_f32 v105, v105, v109
    v_add_f32 v106, v106, v110
    v_add_f32 v107, v107, v111
    v_cvt_pk_bf16_f32 v112, v104, v105
    v_cvt_pk_bf16_f32 v113, v106, v107
    s_mul_i32 s42, s63, 20480
    s_add_u32 s42, s42, s62
    buffer_store_dwordx2 v[112:113], v4, s[12:15], s42 offen
BPS_NE:
    s_barrier
    s_add_u32 s60, s60, 1
    s_cmp_lt_u32 s60, 64
    s_cbranch_scc1 BPS_LOOP
    s_branch WDONE
WDONE:
    s_waitcnt vmcnt(0) lgkmcnt(0)
    s_barrier
    s_cmp_lg_u32 s85, 0
    s_cbranch_scc1 GD_GD
    s_mov_b32 s85, 1
    s_cmp_lg_u32 s40, 0
    s_cbranch_scc1 GD_G2
    s_load_dwordx2 s[76:77], s[0:1], 112
    v_and_b32 v5, 3, v1
    v_lshlrev_b32 v5, 6, v5
    s_mov_b32 s78, 0
    s_waitcnt vmcnt(0) lgkmcnt(0)
GD_G1:
    global_load_dword v6, v5, s[76:77] sc1
    s_waitcnt vmcnt(0)
    v_readlane_b32 s42, v6, 0
    v_readlane_b32 s43, v6, 1
    v_readlane_b32 s44, v6, 2
    v_readlane_b32 s45, v6, 3
    s_add_u32 s42, s42, s43
    s_add_u32 s44, s44, s45
    s_add_u32 s42, s42, s44
    s_add_u32 s78, s78, 1
    s_cmp_ge_u32 s78, 0x40000
    s_cbranch_scc1 GD_G3
    s_and_b32 s43, s42, 0xff
    s_cmp_eq_u32 s43, 0
    s_cbranch_scc0 GD_G1
GD_G3:
    s_lshr_b32 s42, s42, 16
    v_mov_b32 v6, s42
    v_mov_b32 v5, 155648
    ds_write_b32 v5, v6 offset:32
    s_waitcnt lgkmcnt(0)
GD_G2:
    s_barrier
    v_mov_b32 v5, 155648
    ds_read_b32 v6, v5 offset:32
    s_waitcnt lgkmcnt(0)
    v_readfirstlane_b32 s42, v6
    s_cmp_lg_u32 s42, 0
    s_cbranch_scc1 FALLBACK
GD_GD:
    s_cmp_lg_u32 s40, 0
    s_cbranch_scc1 WLOOP
    s_cmp_eq_u32 s101, 0
    s_cbranch_scc1 WLOOP
    s_mov_b64 exec, 1
    v_mov_b32 v4, s87
    v_mov_b32 v5, 0
    buffer_atomic_add v4, v5, s[32:35], s101 offen sc1
    s_mov_b64 exec, -1
    s_branch WLOOP
MG_END0:
MG_END:
    s_endpgm
.section .rodata,"a"
.p2align 6
.amdhsa_kernel mega_kernel
  .amdhsa_next_free_vgpr 256
  .amdhsa_next_free_sgpr 102
  .amdhsa_accum_offset 256
  .amdhsa_group_segment_fixed_size 0
  .amdhsa_kernarg_size 128
  .amdhsa_user_sgpr_count 2
  .amdhsa_user_sgpr_kernarg_segment_ptr 1
  .amdhsa_system_sgpr_workgroup_id_x 1
.end_amdhsa_kernel
```
